```python
import torch

def _softmax(x, axis=-1):
    return torch.softmax(x, dim=axis)
def _gelu(x):
    return torch.nn.functional.gelu(x, approximate="tanh")
def _silu(x):
    return torch.nn.functional.silu(x)
def _sigmoid(x):
    return torch.sigmoid(x)
def _layernorm(x, axis=-1, eps=1e-5):
    m = x.mean(dim=axis, keepdim=True)
    v = x.var(dim=axis, keepdim=True, unbiased=False)
    return (x - m) / torch.sqrt(v + eps)
def _scatter_add(tgt, idx, src, axis=0):
    return tgt.clone().index_add_(axis, idx, src)
def _segment_sum(src, seg, n):
    out = torch.zeros((n,) + src.shape[1:], dtype=src.dtype)
    return out.index_add_(0, seg, src)
def _pad(x, pw):
    flat = tuple(v for pair in reversed(pw) for v in pair)
    return torch.nn.functional.pad(x, flat)

kernel_name = 'sequential_preLN__compressed_kv_cla__dense_activation_relu__prompt'

def setup_inputs():

    _w = (lambda a: (lambda t: t.to(torch.bfloat16) if t.is_floating_point() else t)(torch.as_tensor(a)))
    def _A_setup():
        B, H, Sq, Sk, D, M = 1, 32, 2048, 2048, 128, 512
        Dc = 4 * D
        return {
            "x": _w((lambda *s: torch.randn(*s, dtype=torch.bfloat16) * 0.05)(B, Sq, M)),
            "c_kv": _w((lambda *s: torch.randn(*s, dtype=torch.bfloat16) * 0.4)(B, Sk, Dc)),
            "w_q": _w((lambda *s: torch.randn(*s, dtype=torch.bfloat16) * 3.2)(M, H, D) * (M ** -0.5)),
            "w_uk": _w((lambda *s: torch.randn(*s, dtype=torch.bfloat16) * 3.2)(Dc, H, D) * (Dc ** -0.5)),
            "w_uv": _w((lambda *s: torch.randn(*s, dtype=torch.bfloat16) * 0.4)(Dc, H, D) * (Dc ** -0.5)),
            "w_o": _w((lambda *s: torch.randn(*s, dtype=torch.bfloat16) * 0.4)(H, D, M) * ((H * D) ** -0.5)),
        }
    _A_in = _A_setup()

    def _B_setup():
        B, S, D, Dff = 1, 2048, 512, 1792
        return {
            "x": _w((lambda *s: torch.randn(*s, dtype=torch.bfloat16) * 0.05)(B, S, D)),
            "w1": _w((lambda *s: torch.randn(*s, dtype=torch.bfloat16) * 0.05)(D, Dff)),
            "w2": _w((lambda *s: torch.randn(*s, dtype=torch.bfloat16) * 0.05)(Dff, D)),
        }
    _B_in = _B_setup()

    return {
        "A_x": _A_in["x"],
        "A_c_kv": _A_in["c_kv"],
        "A_w_q": _A_in["w_q"],
        "A_w_uk": _A_in["w_uk"],
        "A_w_uv": _A_in["w_uv"],
        "A_w_o": _A_in["w_o"],
        "B_x": _B_in["x"],
        "B_w1": _B_in["w1"],
        "B_w2": _B_in["w2"],
    }

def reference(A_x, A_c_kv, A_w_q, A_w_uk, A_w_uv, A_w_o, B_x, B_w1, B_w2):
    def _A_ref(x, c_kv, w_q, w_uk, w_uv, w_o):
        B, Sq, M = x.shape[0], x.shape[1], x.shape[2]
        Sk = c_kv.shape[1]
        H, D = w_q.shape[1], w_q.shape[2]
        q = torch.einsum("bqm,mhd->bhqd", x, w_q)
        k = torch.einsum("bkc,chd->bhkd", c_kv, w_uk)
        v = torch.einsum("bkc,chd->bhkd", c_kv, w_uv)
        scores = torch.einsum("bhqd,bhkd->bhqk", q, k) * (D ** -0.5)
        off = Sk - Sq
        qi = torch.arange(Sq)[:, None]
        kj = torch.arange(Sk)[None, :]
        cmask = kj <= (qi + off)
        scores = torch.where(cmask[None, None], scores, -1e9)
        p = _softmax(scores, axis=-1)
        ctx = torch.einsum("bhqk,bhkd->bhqd", p, v)
        return torch.einsum("bhqd,hdm->bqm", ctx, w_o)

    def _B_ref(x, w1, w2):
        h = torch.einsum("bsd,df->bsf", x, w1)
        zero = torch.zeros_like(h)
        h = torch.maximum(h, zero)
        return torch.einsum("bsf,fd->bsd", h, w2)

    x = A_x
    h = x + _A_ref(_layernorm(x, axis=-1), A_c_kv, A_w_q, A_w_uk, A_w_uv, A_w_o)
    h2 = h + _B_ref(_layernorm(h, axis=-1), B_w1, B_w2)
    return h2
```

```asm
; @launch kernel=k1f_kernel grid=(256,1,1) block=(512,1,1) lds=163840
.amdgcn_target "amdgcn-amd-amdhsa--gfx950"
.text
.globl k1f_kernel
.p2align 8
.type k1f_kernel,@function
k1f_kernel:
    s_load_dwordx8 s[64:71], s[0:1], 0
    s_load_dwordx2 s[34:35], s[0:1], 32
    s_load_dwordx2 s[36:37], s[0:1], 88
    s_load_dwordx2 s[76:77], s[0:1], 80
    s_memrealtime s[72:73]
    s_cmp_ge_u32 s2, 256
    s_cbranch_scc1 k1f_kernel_end
    v_lshrrev_b32 v1, 6, v0
    v_and_b32 v118, 63, v0
    v_readfirstlane_b32 s3, v1
    s_lshr_b32 s6, s2, 3
    s_cmp_lg_u32 s6, 0
    s_cbranch_scc1 k1f_kernel_nc0
    s_getpc_b64 s[8:9]
k1f_kernel_cz:
    v_lshlrev_b32 v2, 7, v0
    v_min_u32 v2, k1f_kernel_fin-k1f_kernel_cz, v2
    v_mov_b32 v3, s9
    v_add_co_u32 v2, vcc, s8, v2
    s_nop 1
    v_addc_co_u32 v3, vcc, 0, v3, vcc
    global_load_dword v121, v[2:3], off
k1f_kernel_nc0:
    s_and_b32 s6, s2, 7
    s_lshl_b32 s6, s6, 2
    s_bfe_u32 s7, s2, 0x20003
    s_add_u32 s4, s6, s7
    s_lshr_b32 s5, s2, 5
    s_lshl_b32 s49, s2, 3
    s_add_u32 s49, s49, s3
    s_lshl_b32 s49, s49, 10
    v_and_b32 v125, 7, v118
    v_lshlrev_b32 v125, 7, v125
    v_lshrrev_b32 v2, 4, v118
    v_and_b32 v3, 7, v118
    v_xor_b32 v2, v2, v3
    v_lshlrev_b32 v2, 4, v2
    v_lshrrev_b32 v3, 3, v118
    v_lshl_add_u32 v104, v3, 10, v2
    v_xor_b32 v105, 64, v104
    v_lshrrev_b32 v2, 3, v118
    v_and_b32 v3, 7, v118
    v_bfe_u32 v4, v118, 4, 1
    v_lshlrev_b32 v4, 2, v4
    v_xor_b32 v3, v3, v4
    v_lshlrev_b32 v3, 4, v3
    v_lshl_add_u32 v106, v2, 13, v3
    v_lshlrev_b32 v117, 4, v118
    s_lshl_b32 s6, s5, 3
    s_add_u32 s39, s6, s3
    s_lshl_b32 s40, s39, 15
    s_lshl_b32 s7, s4, 8
    s_lshl_b32 s41, s3, 16
    s_add_u32 s41, s41, s7
    s_lshl_b32 s43, s3, 11
    s_mul_i32 s44, s3, 12288
    s_add_u32 s44, s44, 65536
    s_mov_b32 s14, 2097152
    s_mov_b32 s15, 0x20000
    s_mov_b32 s18, 4194304
    s_mov_b32 s19, 0x20000
    s_waitcnt lgkmcnt(0)
    s_mov_b32 s12, s66
    s_mov_b32 s13, s67
    s_mov_b32 s16, s70
    s_mov_b32 s17, s71
    buffer_load_dword v121, v125, s[12:15], s49 offen
    s_add_u32 m0, s43, 0
    s_add_u32 s55, s41, 0
    buffer_load_dwordx4 v106, s[16:19], s55 offen lds
    s_add_u32 m0, s43, 896
    s_nop 0
    buffer_load_dwordx4 v106, s[16:19], s55 offen offset:128 lds
    s_mov_b32 s8, s64
    s_mov_b32 s9, s65
    s_mov_b32 s10, 0x200000
    s_mov_b32 s11, 0x20000
    s_mov_b32 s20, s34
    s_mov_b32 s21, s35
    s_mov_b32 s22, 0x400000
    s_mov_b32 s23, 0x20000
    s_mov_b32 s24, s36
    s_mov_b32 s25, s37
    s_mov_b32 s26, 0x4400000
    s_mov_b32 s27, 0x20000
    s_mov_b32 s56, s68
    s_mov_b32 s57, s69
    s_mov_b32 s58, 0x400000
    s_mov_b32 s59, 0x20000
    s_load_dwordx2 s[66:67], s[0:1], 40
    s_load_dwordx4 s[68:71], s[0:1], 56
    s_add_u32 m0, s43, 16384
    s_add_u32 s55, s41, 524288
    buffer_load_dwordx4 v106, s[16:19], s55 offen lds
    s_add_u32 m0, s43, 17280
    s_nop 0
    buffer_load_dwordx4 v106, s[16:19], s55 offen offset:128 lds
    s_mov_b32 s78, 8
    s_mov_b32 s79, 0x20000
    s_or_b32 s6, s2, s3
    s_cmp_lg_u32 s6, 0
    s_cbranch_scc1 k1f_kernel_tok
    s_or_b32 s72, s72, 1
    v_mov_b32 v110, s72
    v_mov_b32 v111, s73
    buffer_store_dwordx2 v[110:111], v117, s[76:79], 0 offen sc1
k1f_kernel_tok:
    s_lshl_b32 s46, s4, 20
    s_lshr_b32 s7, s39, 1
    s_lshl_b32 s7, s7, 15
    s_add_u32 s46, s46, s7
    s_add_u32 s46, s46, 0x200000
    s_and_b32 s7, s39, 1
    s_lshl_b32 s38, s7, 11
    s_add_u32 s47, s46, s38
    s_add_u32 s47, s47, 16384
    s_lshl_b32 s38, s7, 13
    s_add_u32 s46, s46, s38
    s_lshl_b32 s6, s3, 17
    s_lshl_b32 s7, s4, 8
    s_add_u32 s52, s6, s7
    s_lshl_b32 s6, s39, 16
    s_add_u32 s54, s6, s7
    v_bfe_u32 v2, v118, 1, 3
    v_and_b32 v3, 1, v118
    v_lshlrev_b32 v3, 7, v3
    v_lshl_add_u32 v107, v2, 13, v3
    s_add_u32 m0, s43, 32768
    s_add_u32 s55, s41, 1048576
    buffer_load_dwordx4 v106, s[16:19], s55 offen lds
    s_add_u32 m0, s43, 33664
    s_nop 0
    buffer_load_dwordx4 v106, s[16:19], s55 offen offset:128 lds
    s_lshr_b32 s38, s2, 2
    s_lshl_b32 s38, s38, 15
    s_and_b32 s39, s2, 3
    s_lshl_b32 s39, s39, 7
    s_add_u32 s60, s38, s39
    s_lshl_b32 s38, s3, 12
    s_add_u32 s60, s60, s38
    v_lshrrev_b32 v2, 3, v118
    v_and_b32 v3, 7, v118
    v_lshlrev_b32 v4, 4, v3
    v_lshl_add_u32 v124, v2, 9, v4
    v_add_u32 v126, s44, v117
    v_mul_u32_u24 v3, 0x3000, v3
    v_lshl_add_u32 v3, v2, 4, v3
    s_lshl_b32 s38, s3, 7
    s_add_u32 s38, s38, 0x12000
    v_add_u32 v127, s38, v3
    s_lshr_b32 s6, s2, 3
    s_lshl_b32 s6, s6, 3
    s_add_u32 s6, s6, s3
    s_lshl_b32 s62, s6, 14
    s_and_b32 s7, s2, 7
    s_lshl_b32 s7, s7, 10
    s_add_u32 s62, s62, s7
    v_bfe_u32 v2, v118, 3, 1
    v_and_b32 v3, 7, v118
    v_lshlrev_b32 v3, 7, v3
    v_lshl_add_u32 v123, v2, 13, v3
    v_bfe_u32 v2, v118, 2, 2
    v_lshrrev_b32 v3, 5, v118
    v_bfe_u32 v5, v118, 4, 1
    v_lshlrev_b32 v5, 5, v5
    v_and_b32 v6, 3, v118
    v_lshl_add_u32 v5, v6, 3, v5
    v_lshl_add_u32 v5, v2, 7, v5
    v_bfe_u32 v6, v118, 3, 1
    v_lshl_add_u32 v5, v6, 6, v5
    v_lshl_add_u32 v112, v3, 10, v5
    v_add_u32 v119, 0x10000, v112
    v_add_u32 v120, 0x1c000, v112
    v_lshl_add_u32 v108, v3, 11, v5
    v_xor_b32 v109, 64, v108
    v_bfe_u32 v4, v118, 1, 3
    v_xor_b32 v4, v4, v3
    v_lshlrev_b32 v4, 4, v4
    v_and_b32 v5, 31, v118
    v_lshl_add_u32 v4, v5, 7, v4
    v_xor_b32 v5, 0, v4
    v_add_u32 v113, s44, v5
    v_xor_b32 v5, 32, v4
    v_add_u32 v114, s44, v5
    v_xor_b32 v5, 64, v4
    v_add_u32 v115, s44, v5
    v_xor_b32 v5, 96, v4
    v_add_u32 v116, s44, v5
    s_waitcnt vmcnt(6)
    s_add_u32 m0, s44, 0
    s_add_u32 s45, s40, 0
    buffer_load_dwordx4 v104, s[12:15], s45 offen offset:0 lds
    s_add_u32 s45, s40, 7168
    buffer_load_dwordx4 v105, s[12:15], s45 offen offset:1024 lds
    s_add_u32 s45, s40, 14336
    buffer_load_dwordx4 v104, s[12:15], s45 offen offset:2048 lds
    s_add_u32 s45, s40, 21504
    buffer_load_dwordx4 v105, s[12:15], s45 offen offset:3072 lds
    s_barrier
    s_add_u32 m0, s44, 4096
    s_add_u32 s45, s40, 128
    buffer_load_dwordx4 v104, s[12:15], s45 offen offset:0 lds
    s_add_u32 s45, s40, 7296
    buffer_load_dwordx4 v105, s[12:15], s45 offen offset:1024 lds
    s_add_u32 s45, s40, 14464
    buffer_load_dwordx4 v104, s[12:15], s45 offen offset:2048 lds
    s_add_u32 s45, s40, 21632
    buffer_load_dwordx4 v105, s[12:15], s45 offen offset:3072 lds
    s_add_u32 m0, s44, 8192
    s_add_u32 s45, s40, 256
    buffer_load_dwordx4 v104, s[12:15], s45 offen offset:0 lds
    s_add_u32 s45, s40, 7424
    buffer_load_dwordx4 v105, s[12:15], s45 offen offset:1024 lds
    s_add_u32 s45, s40, 14592
    buffer_load_dwordx4 v104, s[12:15], s45 offen offset:2048 lds
    s_add_u32 s45, s40, 21760
    buffer_load_dwordx4 v105, s[12:15], s45 offen offset:3072 lds
    s_waitcnt vmcnt(8)
    s_barrier
    ds_read_b128 v[128:131], v113 offset:0
    ds_read_b128 v[132:135], v114 offset:0
    ds_read_b128 v[136:139], v115 offset:0
    ds_read_b128 v[140:143], v116 offset:0
    ds_read_b64_tr_b16 v[80:81], v108 offset:0
    ds_read_b64_tr_b16 v[82:83], v108 offset:512
    ds_read_b64_tr_b16 v[84:85], v109 offset:0
    ds_read_b64_tr_b16 v[86:87], v109 offset:512
    ds_read_b64_tr_b16 v[88:89], v108 offset:1024
    ds_read_b64_tr_b16 v[90:91], v108 offset:1536
    ds_read_b64_tr_b16 v[92:93], v109 offset:1024
    ds_read_b64_tr_b16 v[94:95], v109 offset:1536
    ds_read_b64_tr_b16 v[96:97], v108 offset:4096
    ds_read_b64_tr_b16 v[98:99], v108 offset:4608
    s_waitcnt lgkmcnt(10)
    s_add_u32 m0, s44, 0
    s_add_u32 s45, s40, 384
    buffer_load_dwordx4 v104, s[12:15], s45 offen offset:0 lds
    s_add_u32 s45, s40, 7552
    buffer_load_dwordx4 v105, s[12:15], s45 offen offset:1024 lds
    s_add_u32 s45, s40, 14720
    buffer_load_dwordx4 v104, s[12:15], s45 offen offset:2048 lds
    s_add_u32 s45, s40, 21888
    buffer_load_dwordx4 v105, s[12:15], s45 offen offset:3072 lds
    s_waitcnt lgkmcnt(8)
    v_mfma_f32_32x32x16_bf16 v[0:15], v[80:83], v[128:131], 0
    ds_read_b64_tr_b16 v[100:101], v109 offset:4096
    ds_read_b64_tr_b16 v[102:103], v109 offset:4608
    s_waitcnt lgkmcnt(8)
    v_mfma_f32_32x32x16_bf16 v[16:31], v[84:87], v[128:131], 0
    ds_read_b64_tr_b16 v[80:81], v108 offset:5120
    ds_read_b64_tr_b16 v[82:83], v108 offset:5632
    s_waitcnt lgkmcnt(8)
    v_mfma_f32_32x32x16_bf16 v[32:47], v[88:91], v[128:131], 0
    ds_read_b64_tr_b16 v[84:85], v109 offset:5120
    ds_read_b64_tr_b16 v[86:87], v109 offset:5632
    s_waitcnt lgkmcnt(8)
    v_mfma_f32_32x32x16_bf16 v[48:63], v[92:95], v[128:131], 0
    ds_read_b64_tr_b16 v[88:89], v108 offset:8192
    ds_read_b64_tr_b16 v[90:91], v108 offset:8704
    s_waitcnt lgkmcnt(8)
    v_mfma_f32_32x32x16_bf16 v[0:15], v[96:99], v[132:135], v[0:15]
    ds_read_b64_tr_b16 v[92:93], v109 offset:8192
    ds_read_b64_tr_b16 v[94:95], v109 offset:8704
    s_waitcnt lgkmcnt(8)
    v_mfma_f32_32x32x16_bf16 v[16:31], v[100:103], v[132:135], v[16:31]
    ds_read_b64_tr_b16 v[96:97], v108 offset:9216
    ds_read_b64_tr_b16 v[98:99], v108 offset:9728
    s_waitcnt lgkmcnt(8)
    v_mfma_f32_32x32x16_bf16 v[32:47], v[80:83], v[132:135], v[32:47]
    ds_read_b64_tr_b16 v[100:101], v109 offset:9216
    ds_read_b64_tr_b16 v[102:103], v109 offset:9728
    s_waitcnt vmcnt(8)
    s_barrier
    ds_read_b128 v[144:147], v113 offset:4096
    ds_read_b128 v[148:151], v114 offset:4096
    ds_read_b128 v[152:155], v115 offset:4096
    ds_read_b128 v[156:159], v116 offset:4096
    s_waitcnt lgkmcnt(12)
    v_mfma_f32_32x32x16_bf16 v[48:63], v[84:87], v[132:135], v[48:63]
    ds_read_b64_tr_b16 v[80:81], v108 offset:12288
    ds_read_b64_tr_b16 v[82:83], v108 offset:12800
    s_add_u32 m0, s43, 49152
    s_add_u32 s55, s41, 1572864
    buffer_load_dwordx4 v106, s[16:19], s55 offen lds
    s_waitcnt lgkmcnt(12)
    v_mfma_f32_32x32x16_bf16 v[0:15], v[88:91], v[136:139], v[0:15]
    ds_read_b64_tr_b16 v[84:85], v109 offset:12288
    ds_read_b64_tr_b16 v[86:87], v109 offset:12800
    s_add_u32 m0, s43, 50048
    s_nop 0
    buffer_load_dwordx4 v106, s[16:19], s55 offen offset:128 lds
    s_waitcnt lgkmcnt(12)
    v_mfma_f32_32x32x16_bf16 v[16:31], v[92:95], v[136:139], v[16:31]
    ds_read_b64_tr_b16 v[88:89], v108 offset:13312
    ds_read_b64_tr_b16 v[90:91], v108 offset:13824
    buffer_load_dwordx4 v[64:67], v117, s[8:11], s49 offen
    s_waitcnt lgkmcnt(12)
    v_mfma_f32_32x32x16_bf16 v[32:47], v[96:99], v[136:139], v[32:47]
    ds_read_b64_tr_b16 v[92:93], v109 offset:13312
    ds_read_b64_tr_b16 v[94:95], v109 offset:13824
    s_waitcnt lgkmcnt(12)
    v_mfma_f32_32x32x16_bf16 v[48:63], v[100:103], v[136:139], v[48:63]
    ds_read_b64_tr_b16 v[96:97], v108 offset:16384
    ds_read_b64_tr_b16 v[98:99], v108 offset:16896
    s_waitcnt lgkmcnt(10)
    s_add_u32 m0, s44, 4096
    s_add_u32 s45, s40, 512
    buffer_load_dwordx4 v104, s[12:15], s45 offen offset:0 lds
    s_waitcnt lgkmcnt(8)
    v_mfma_f32_32x32x16_bf16 v[0:15], v[80:83], v[140:143], v[0:15]
    ds_read_b64_tr_b16 v[100:101], v109 offset:16384
    ds_read_b64_tr_b16 v[102:103], v109 offset:16896
    s_add_u32 s45, s40, 7680
    buffer_load_dwordx4 v105, s[12:15], s45 offen offset:1024 lds
    s_waitcnt lgkmcnt(8)
    v_mfma_f32_32x32x16_bf16 v[16:31], v[84:87], v[140:143], v[16:31]
    ds_read_b64_tr_b16 v[80:81], v108 offset:17408
    ds_read_b64_tr_b16 v[82:83], v108 offset:17920
    s_add_u32 s45, s40, 14848
    buffer_load_dwordx4 v104, s[12:15], s45 offen offset:2048 lds
    s_waitcnt lgkmcnt(8)
    v_mfma_f32_32x32x16_bf16 v[32:47], v[88:91], v[140:143], v[32:47]
    ds_read_b64_tr_b16 v[84:85], v109 offset:17408
    ds_read_b64_tr_b16 v[86:87], v109 offset:17920
    s_add_u32 s45, s40, 22016
    buffer_load_dwordx4 v105, s[12:15], s45 offen offset:3072 lds
    s_waitcnt lgkmcnt(8)
    v_mfma_f32_32x32x16_bf16 v[48:63], v[92:95], v[140:143], v[48:63]
    ds_read_b64_tr_b16 v[88:89], v108 offset:20480
    ds_read_b64_tr_b16 v[90:91], v108 offset:20992
    s_waitcnt lgkmcnt(8)
    v_mfma_f32_32x32x16_bf16 v[0:15], v[96:99], v[144:147], v[0:15]
    ds_read_b64_tr_b16 v[92:93], v109 offset:20480
    ds_read_b64_tr_b16 v[94:95], v109 offset:20992
    s_waitcnt lgkmcnt(8)
    v_mfma_f32_32x32x16_bf16 v[16:31], v[100:103], v[144:147], v[16:31]
    ds_read_b64_tr_b16 v[96:97], v108 offset:21504
    ds_read_b64_tr_b16 v[98:99], v108 offset:22016
    s_waitcnt lgkmcnt(8)
    v_mfma_f32_32x32x16_bf16 v[32:47], v[80:83], v[144:147], v[32:47]
    ds_read_b64_tr_b16 v[100:101], v109 offset:21504
    ds_read_b64_tr_b16 v[102:103], v109 offset:22016
    s_waitcnt lgkmcnt(8)
    v_mfma_f32_32x32x16_bf16 v[48:63], v[84:87], v[144:147], v[48:63]
    ds_read_b64_tr_b16 v[80:81], v108 offset:24576
    ds_read_b64_tr_b16 v[82:83], v108 offset:25088
    s_waitcnt lgkmcnt(8)
    v_mfma_f32_32x32x16_bf16 v[0:15], v[88:91], v[148:151], v[0:15]
    ds_read_b64_tr_b16 v[84:85], v109 offset:24576
    ds_read_b64_tr_b16 v[86:87], v109 offset:25088
    s_waitcnt lgkmcnt(8)
    v_mfma_f32_32x32x16_bf16 v[16:31], v[92:95], v[148:151], v[16:31]
    ds_read_b64_tr_b16 v[88:89], v108 offset:25600
    ds_read_b64_tr_b16 v[90:91], v108 offset:26112
    s_waitcnt lgkmcnt(8)
    v_mfma_f32_32x32x16_bf16 v[32:47], v[96:99], v[148:151], v[32:47]
    ds_read_b64_tr_b16 v[92:93], v109 offset:25600
    ds_read_b64_tr_b16 v[94:95], v109 offset:26112
    s_waitcnt vmcnt(11)
    s_barrier
    ds_read_b128 v[160:163], v113 offset:8192
    ds_read_b128 v[164:167], v114 offset:8192
    ds_read_b128 v[168:171], v115 offset:8192
    ds_read_b128 v[172:175], v116 offset:8192
    s_waitcnt lgkmcnt(12)
    v_mfma_f32_32x32x16_bf16 v[48:63], v[100:103], v[148:151], v[48:63]
    ds_read_b64_tr_b16 v[96:97], v108 offset:28672
    ds_read_b64_tr_b16 v[98:99], v108 offset:29184
    s_add_u32 m0, s43, 0
    s_add_u32 s55, s41, 2097152
    buffer_load_dwordx4 v106, s[16:19], s55 offen lds
    s_waitcnt lgkmcnt(12)
    v_mfma_f32_32x32x16_bf16 v[0:15], v[80:83], v[152:155], v[0:15]
    ds_read_b64_tr_b16 v[100:101], v109 offset:28672
    ds_read_b64_tr_b16 v[102:103], v109 offset:29184
    s_add_u32 m0, s43, 896
    s_nop 0
    buffer_load_dwordx4 v106, s[16:19], s55 offen offset:128 lds
    s_waitcnt lgkmcnt(12)
    v_mfma_f32_32x32x16_bf16 v[16:31], v[84:87], v[152:155], v[16:31]
    ds_read_b64_tr_b16 v[80:81], v108 offset:29696
    ds_read_b64_tr_b16 v[82:83], v108 offset:30208
    s_waitcnt lgkmcnt(12)
    v_mfma_f32_32x32x16_bf16 v[32:47], v[88:91], v[152:155], v[32:47]
    ds_read_b64_tr_b16 v[84:85], v109 offset:29696
    ds_read_b64_tr_b16 v[86:87], v109 offset:30208
    s_waitcnt lgkmcnt(12)
    v_mfma_f32_32x32x16_bf16 v[48:63], v[92:95], v[152:155], v[48:63]
    ds_read_b64_tr_b16 v[88:89], v108 offset:32768
    ds_read_b64_tr_b16 v[90:91], v108 offset:33280
    s_waitcnt lgkmcnt(10)
    s_add_u32 m0, s44, 8192
    s_add_u32 s45, s40, 640
    buffer_load_dwordx4 v104, s[12:15], s45 offen offset:0 lds
    s_waitcnt lgkmcnt(8)
    v_mfma_f32_32x32x16_bf16 v[0:15], v[96:99], v[156:159], v[0:15]
    ds_read_b64_tr_b16 v[92:93], v109 offset:32768
    ds_read_b64_tr_b16 v[94:95], v109 offset:33280
    s_add_u32 s45, s40, 7808
    buffer_load_dwordx4 v105, s[12:15], s45 offen offset:1024 lds
    s_waitcnt lgkmcnt(8)
    v_mfma_f32_32x32x16_bf16 v[16:31], v[100:103], v[156:159], v[16:31]
    ds_read_b64_tr_b16 v[96:97], v108 offset:33792
    ds_read_b64_tr_b16 v[98:99], v108 offset:34304
    s_add_u32 s45, s40, 14976
    buffer_load_dwordx4 v104, s[12:15], s45 offen offset:2048 lds
    s_waitcnt lgkmcnt(8)
    v_mfma_f32_32x32x16_bf16 v[32:47], v[80:83], v[156:159], v[32:47]
    ds_read_b64_tr_b16 v[100:101], v109 offset:33792
    ds_read_b64_tr_b16 v[102:103], v109 offset:34304
    s_add_u32 s45, s40, 22144
    buffer_load_dwordx4 v105, s[12:15], s45 offen offset:3072 lds
    s_waitcnt lgkmcnt(8)
    v_mfma_f32_32x32x16_bf16 v[48:63], v[84:87], v[156:159], v[48:63]
    ds_read_b64_tr_b16 v[80:81], v108 offset:36864
    ds_read_b64_tr_b16 v[82:83], v108 offset:37376
    s_waitcnt lgkmcnt(8)
    v_mfma_f32_32x32x16_bf16 v[0:15], v[88:91], v[160:163], v[0:15]
    ds_read_b64_tr_b16 v[84:85], v109 offset:36864
    ds_read_b64_tr_b16 v[86:87], v109 offset:37376
    s_waitcnt lgkmcnt(8)
    v_mfma_f32_32x32x16_bf16 v[16:31], v[92:95], v[160:163], v[16:31]
    ds_read_b64_tr_b16 v[88:89], v108 offset:37888
    ds_read_b64_tr_b16 v[90:91], v108 offset:38400
    s_waitcnt lgkmcnt(8)
    v_mfma_f32_32x32x16_bf16 v[32:47], v[96:99], v[160:163], v[32:47]
    ds_read_b64_tr_b16 v[92:93], v109 offset:37888
    ds_read_b64_tr_b16 v[94:95], v109 offset:38400
    s_waitcnt lgkmcnt(8)
    v_mfma_f32_32x32x16_bf16 v[48:63], v[100:103], v[160:163], v[48:63]
    ds_read_b64_tr_b16 v[96:97], v108 offset:40960
    ds_read_b64_tr_b16 v[98:99], v108 offset:41472
    s_waitcnt lgkmcnt(8)
    v_mfma_f32_32x32x16_bf16 v[0:15], v[80:83], v[164:167], v[0:15]
    ds_read_b64_tr_b16 v[100:101], v109 offset:40960
    ds_read_b64_tr_b16 v[102:103], v109 offset:41472
    s_waitcnt vmcnt(10)
    s_waitcnt lgkmcnt(8)
    v_mfma_f32_32x32x16_bf16 v[16:31], v[84:87], v[164:167], v[16:31]
    ds_read_b64_tr_b16 v[80:81], v108 offset:41984
    ds_read_b64_tr_b16 v[82:83], v108 offset:42496
    v_lshlrev_b32 v68, 16, v64
    v_and_b32 v69, 0xffff0000, v64
    s_waitcnt lgkmcnt(8)
    v_mfma_f32_32x32x16_bf16 v[32:47], v[88:91], v[164:167], v[32:47]
    ds_read_b64_tr_b16 v[84:85], v109 offset:41984
    ds_read_b64_tr_b16 v[86:87], v109 offset:42496
    s_barrier
    ds_read_b128 v[176:179], v113 offset:0
    ds_read_b128 v[180:183], v114 offset:0
    ds_read_b128 v[184:187], v115 offset:0
    ds_read_b128 v[188:191], v116 offset:0
    v_lshlrev_b32 v70, 16, v65
    v_and_b32 v71, 0xffff0000, v65
    s_waitcnt lgkmcnt(12)
    v_mfma_f32_32x32x16_bf16 v[48:63], v[92:95], v[164:167], v[48:63]
    ds_read_b64_tr_b16 v[88:89], v108 offset:45056
    ds_read_b64_tr_b16 v[90:91], v108 offset:45568
    s_add_u32 m0, s43, 16384
    s_add_u32 s55, s41, 2621440
    buffer_load_dwordx4 v106, s[16:19], s55 offen lds
    v_lshlrev_b32 v72, 16, v66
    v_and_b32 v73, 0xffff0000, v66
    s_waitcnt lgkmcnt(12)
    v_mfma_f32_32x32x16_bf16 v[0:15], v[96:99], v[168:171], v[0:15]
    ds_read_b64_tr_b16 v[92:93], v109 offset:45056
    ds_read_b64_tr_b16 v[94:95], v109 offset:45568
    s_add_u32 m0, s43, 17280
    s_nop 0
    buffer_load_dwordx4 v106, s[16:19], s55 offen offset:128 lds
    buffer_load_dword v121, v107, s[20:23], s54 offen
    v_lshlrev_b32 v74, 16, v67
    v_and_b32 v75, 0xffff0000, v67
    s_waitcnt lgkmcnt(12)
    v_mfma_f32_32x32x16_bf16 v[16:31], v[100:103], v[168:171], v[16:31]
    ds_read_b64_tr_b16 v[96:97], v108 offset:46080
    ds_read_b64_tr_b16 v[98:99], v108 offset:46592
    v_add_f32 v76, v68, v69
    v_add_f32 v77, v70, v71
    s_waitcnt lgkmcnt(12)
    v_mfma_f32_32x32x16_bf16 v[32:47], v[80:83], v[168:171], v[32:47]
    ds_read_b64_tr_b16 v[100:101], v109 offset:46080
    ds_read_b64_tr_b16 v[102:103], v109 offset:46592
    v_add_f32 v78, v72, v73
    v_add_f32 v79, v74, v75
    s_waitcnt lgkmcnt(12)
    v_mfma_f32_32x32x16_bf16 v[48:63], v[84:87], v[168:171], v[48:63]
    ds_read_b64_tr_b16 v[80:81], v108 offset:49152
    ds_read_b64_tr_b16 v[82:83], v108 offset:49664
    s_waitcnt lgkmcnt(10)
    s_add_u32 m0, s44, 0
    s_add_u32 s45, s40, 768
    buffer_load_dwordx4 v104, s[12:15], s45 offen offset:0 lds
    v_add_f32 v76, v76, v77
    v_add_f32 v78, v78, v79
    s_waitcnt lgkmcnt(8)
    v_mfma_f32_32x32x16_bf16 v[0:15], v[88:91], v[172:175], v[0:15]
    ds_read_b64_tr_b16 v[84:85], v109 offset:49152
    ds_read_b64_tr_b16 v[86:87], v109 offset:49664
    s_add_u32 s45, s40, 7936
    buffer_load_dwordx4 v105, s[12:15], s45 offen offset:1024 lds
    v_add_f32 v76, v76, v78
    s_waitcnt lgkmcnt(8)
    v_mfma_f32_32x32x16_bf16 v[16:31], v[92:95], v[172:175], v[16:31]
    ds_read_b64_tr_b16 v[88:89], v108 offset:50176
    ds_read_b64_tr_b16 v[90:91], v108 offset:50688
    s_add_u32 s45, s40, 15104
    buffer_load_dwordx4 v104, s[12:15], s45 offen offset:2048 lds
    v_add_f32_dpp v76, v76, v76 row_shr:1 row_mask:0xf bank_mask:0xf bound_ctrl:0
    s_waitcnt lgkmcnt(8)
    v_mfma_f32_32x32x16_bf16 v[32:47], v[96:99], v[172:175], v[32:47]
    ds_read_b64_tr_b16 v[92:93], v109 offset:50176
    ds_read_b64_tr_b16 v[94:95], v109 offset:50688
    s_add_u32 s45, s40, 22272
    buffer_load_dwordx4 v105, s[12:15], s45 offen offset:3072 lds
    v_add_f32_dpp v76, v76, v76 row_shr:2 row_mask:0xf bank_mask:0xf bound_ctrl:0
    s_waitcnt lgkmcnt(8)
    v_mfma_f32_32x32x16_bf16 v[48:63], v[100:103], v[172:175], v[48:63]
    ds_read_b64_tr_b16 v[96:97], v108 offset:53248
    ds_read_b64_tr_b16 v[98:99], v108 offset:53760
    v_add_f32_dpp v76, v76, v76 row_shr:4 row_mask:0xf bank_mask:0xf bound_ctrl:0
    s_waitcnt lgkmcnt(8)
    v_mfma_f32_32x32x16_bf16 v[0:15], v[80:83], v[176:179], v[0:15]
    ds_read_b64_tr_b16 v[100:101], v109 offset:53248
    ds_read_b64_tr_b16 v[102:103], v109 offset:53760
    v_add_f32_dpp v76, v76, v76 row_shr:8 row_mask:0xf bank_mask:0xf bound_ctrl:0
    s_waitcnt lgkmcnt(8)
    v_mfma_f32_32x32x16_bf16 v[16:31], v[84:87], v[176:179], v[16:31]
    ds_read_b64_tr_b16 v[80:81], v108 offset:54272
    ds_read_b64_tr_b16 v[82:83], v108 offset:54784
    v_add_f32_dpp v76, v76, v76 row_bcast:15 row_mask:0xa bank_mask:0xf
    s_waitcnt lgkmcnt(8)
    v_mfma_f32_32x32x16_bf16 v[32:47], v[88:91], v[176:179], v[32:47]
    ds_read_b64_tr_b16 v[84:85], v109 offset:54272
    ds_read_b64_tr_b16 v[86:87], v109 offset:54784
    v_add_f32_dpp v76, v76, v76 row_bcast:31 row_mask:0xc bank_mask:0xf
    s_waitcnt lgkmcnt(8)
    v_mfma_f32_32x32x16_bf16 v[48:63], v[92:95], v[176:179], v[48:63]
    ds_read_b64_tr_b16 v[88:89], v108 offset:57344
    ds_read_b64_tr_b16 v[90:91], v108 offset:57856
    v_mul_f32 v76, 0x3b000000, v76
    s_waitcnt lgkmcnt(8)
    v_mfma_f32_32x32x16_bf16 v[0:15], v[96:99], v[180:183], v[0:15]
    ds_read_b64_tr_b16 v[92:93], v109 offset:57344
    ds_read_b64_tr_b16 v[94:95], v109 offset:57856
    v_readlane_b32 s50, v76, 63
    s_waitcnt lgkmcnt(8)
    v_mfma_f32_32x32x16_bf16 v[16:31], v[100:103], v[180:183], v[16:31]
    ds_read_b64_tr_b16 v[96:97], v108 offset:58368
    ds_read_b64_tr_b16 v[98:99], v108 offset:58880
    v_subrev_f32 v76, s50, v68
    v_mul_f32 v78, v76, v76
    s_waitcnt lgkmcnt(8)
    v_mfma_f32_32x32x16_bf16 v[32:47], v[80:83], v[180:183], v[32:47]
    ds_read_b64_tr_b16 v[100:101], v109 offset:58368
    ds_read_b64_tr_b16 v[102:103], v109 offset:58880
    s_waitcnt vmcnt(11)
    s_barrier
    ds_read_b128 v[192:195], v113 offset:4096
    ds_read_b128 v[196:199], v114 offset:4096
    ds_read_b128 v[200:203], v115 offset:4096
    ds_read_b128 v[204:207], v116 offset:4096
    v_subrev_f32 v77, s50, v69
    v_fmac_f32 v78, v77, v77
    s_waitcnt lgkmcnt(12)
    v_mfma_f32_32x32x16_bf16 v[48:63], v[84:87], v[180:183], v[48:63]
    ds_read_b64_tr_b16 v[80:81], v108 offset:61440
    ds_read_b64_tr_b16 v[82:83], v108 offset:61952
    s_add_u32 m0, s43, 32768
    s_add_u32 s55, s41, 3145728
    buffer_load_dwordx4 v106, s[16:19], s55 offen lds
    v_subrev_f32 v76, s50, v70
    v_fmac_f32 v78, v76, v76
    s_waitcnt lgkmcnt(12)
    v_mfma_f32_32x32x16_bf16 v[0:15], v[88:91], v[184:187], v[0:15]
    ds_read_b64_tr_b16 v[84:85], v109 offset:61440
    ds_read_b64_tr_b16 v[86:87], v109 offset:61952
    s_add_u32 m0, s43, 33664
    s_nop 0
    buffer_load_dwordx4 v106, s[16:19], s55 offen offset:128 lds
    v_subrev_f32 v77, s50, v71
    v_fmac_f32 v78, v77, v77
    s_waitcnt lgkmcnt(12)
    v_mfma_f32_32x32x16_bf16 v[16:31], v[92:95], v[184:187], v[16:31]
    ds_read_b64_tr_b16 v[88:89], v108 offset:62464
    ds_read_b64_tr_b16 v[90:91], v108 offset:62976
    v_subrev_f32 v76, s50, v72
    v_fmac_f32 v78, v76, v76
    s_waitcnt lgkmcnt(12)
    v_mfma_f32_32x32x16_bf16 v[32:47], v[96:99], v[184:187], v[32:47]
    ds_read_b64_tr_b16 v[92:93], v109 offset:62464
    ds_read_b64_tr_b16 v[94:95], v109 offset:62976
    v_subrev_f32 v77, s50, v73
    v_fmac_f32 v78, v77, v77
    s_waitcnt lgkmcnt(12)
    v_mfma_f32_32x32x16_bf16 v[48:63], v[100:103], v[184:187], v[48:63]
    ds_read_b64_tr_b16 v[96:97], v108 offset:0
    ds_read_b64_tr_b16 v[98:99], v108 offset:512
    s_waitcnt lgkmcnt(10)
    s_add_u32 m0, s44, 4096
    s_add_u32 s45, s40, 896
    buffer_load_dwordx4 v104, s[12:15], s45 offen offset:0 lds
    v_subrev_f32 v76, s50, v74
    v_fmac_f32 v78, v76, v76
    s_waitcnt lgkmcnt(8)
    v_mfma_f32_32x32x16_bf16 v[0:15], v[80:83], v[188:191], v[0:15]
    ds_read_b64_tr_b16 v[100:101], v109 offset:0
    ds_read_b64_tr_b16 v[102:103], v109 offset:512
    s_add_u32 s45, s40, 8064
    buffer_load_dwordx4 v105, s[12:15], s45 offen offset:1024 lds
    v_subrev_f32 v77, s50, v75
    v_fmac_f32 v78, v77, v77
    s_waitcnt lgkmcnt(8)
    v_mfma_f32_32x32x16_bf16 v[16:31], v[84:87], v[188:191], v[16:31]
    ds_read_b64_tr_b16 v[80:81], v108 offset:1024
    ds_read_b64_tr_b16 v[82:83], v108 offset:1536
    s_add_u32 s45, s40, 15232
    buffer_load_dwordx4 v104, s[12:15], s45 offen offset:2048 lds
    v_add_f32_dpp v78, v78, v78 row_shr:1 row_mask:0xf bank_mask:0xf bound_ctrl:0
    s_waitcnt lgkmcnt(8)
    v_mfma_f32_32x32x16_bf16 v[32:47], v[88:91], v[188:191], v[32:47]
    ds_read_b64_tr_b16 v[84:85], v109 offset:1024
    ds_read_b64_tr_b16 v[86:87], v109 offset:1536
    s_add_u32 s45, s40, 22400
    buffer_load_dwordx4 v105, s[12:15], s45 offen offset:3072 lds
    v_add_f32_dpp v78, v78, v78 row_shr:2 row_mask:0xf bank_mask:0xf bound_ctrl:0
    s_waitcnt lgkmcnt(8)
    v_mfma_f32_32x32x16_bf16 v[48:63], v[92:95], v[188:191], v[48:63]
    ds_read_b64_tr_b16 v[88:89], v108 offset:4096
    ds_read_b64_tr_b16 v[90:91], v108 offset:4608
    v_add_f32_dpp v78, v78, v78 row_shr:4 row_mask:0xf bank_mask:0xf bound_ctrl:0
    s_waitcnt lgkmcnt(8)
    v_mfma_f32_32x32x16_bf16 v[0:15], v[96:99], v[192:195], v[0:15]
    ds_read_b64_tr_b16 v[92:93], v109 offset:4096
    ds_read_b64_tr_b16 v[94:95], v109 offset:4608
    v_add_f32_dpp v78, v78, v78 row_shr:8 row_mask:0xf bank_mask:0xf bound_ctrl:0
    s_waitcnt lgkmcnt(8)
    v_mfma_f32_32x32x16_bf16 v[16:31], v[100:103], v[192:195], v[16:31]
    ds_read_b64_tr_b16 v[96:97], v108 offset:5120
    ds_read_b64_tr_b16 v[98:99], v108 offset:5632
    v_add_f32_dpp v78, v78, v78 row_bcast:15 row_mask:0xa bank_mask:0xf
    s_waitcnt lgkmcnt(8)
    v_mfma_f32_32x32x16_bf16 v[32:47], v[80:83], v[192:195], v[32:47]
    ds_read_b64_tr_b16 v[100:101], v109 offset:5120
    ds_read_b64_tr_b16 v[102:103], v109 offset:5632
    v_add_f32_dpp v78, v78, v78 row_bcast:31 row_mask:0xc bank_mask:0xf
    s_waitcnt lgkmcnt(8)
    v_mfma_f32_32x32x16_bf16 v[48:63], v[84:87], v[192:195], v[48:63]
    ds_read_b64_tr_b16 v[80:81], v108 offset:8192
    ds_read_b64_tr_b16 v[82:83], v108 offset:8704
    v_mul_f32 v78, 0x3b000000, v78
    s_waitcnt lgkmcnt(8)
    v_mfma_f32_32x32x16_bf16 v[0:15], v[88:91], v[196:199], v[0:15]
    ds_read_b64_tr_b16 v[84:85], v109 offset:8192
    ds_read_b64_tr_b16 v[86:87], v109 offset:8704
    v_readlane_b32 s51, v78, 63
    s_waitcnt lgkmcnt(8)
    v_mfma_f32_32x32x16_bf16 v[16:31], v[92:95], v[196:199], v[16:31]
    ds_read_b64_tr_b16 v[88:89], v108 offset:9216
    ds_read_b64_tr_b16 v[90:91], v108 offset:9728
    v_cvt_pk_bf16_f32 v76, s50, s50
    v_lshlrev_b32 v76, 16, v76
    s_waitcnt lgkmcnt(8)
    v_mfma_f32_32x32x16_bf16 v[32:47], v[96:99], v[196:199], v[32:47]
    ds_read_b64_tr_b16 v[92:93], v109 offset:9216
    ds_read_b64_tr_b16 v[94:95], v109 offset:9728
    s_waitcnt vmcnt(11)
    s_barrier
    ds_read_b128 v[208:211], v113 offset:8192
    ds_read_b128 v[212:215], v114 offset:8192
    ds_read_b128 v[216:219], v115 offset:8192
    ds_read_b128 v[220:223], v116 offset:8192
    v_cvt_pk_bf16_f32 v78, s51, s51
    v_lshlrev_b32 v78, 16, v78
    s_waitcnt lgkmcnt(12)
    v_mfma_f32_32x32x16_bf16 v[48:63], v[100:103], v[196:199], v[48:63]
    ds_read_b64_tr_b16 v[96:97], v108 offset:12288
    ds_read_b64_tr_b16 v[98:99], v108 offset:12800
    s_add_u32 m0, s43, 49152
    s_add_u32 s55, s41, 3670016
    buffer_load_dwordx4 v106, s[16:19], s55 offen lds
    v_add_f32 v78, 0x3727c5ac, v78
    v_cvt_pk_bf16_f32 v78, v78, v78
    s_waitcnt lgkmcnt(12)
    v_mfma_f32_32x32x16_bf16 v[0:15], v[80:83], v[200:203], v[0:15]
    ds_read_b64_tr_b16 v[100:101], v109 offset:12288
    ds_read_b64_tr_b16 v[102:103], v109 offset:12800
    s_add_u32 m0, s43, 50048
    s_nop 0
    buffer_load_dwordx4 v106, s[16:19], s55 offen offset:128 lds
    v_lshlrev_b32 v78, 16, v78
    v_sqrt_f32 v78, v78
    s_waitcnt lgkmcnt(12)
    v_mfma_f32_32x32x16_bf16 v[16:31], v[84:87], v[200:203], v[16:31]
    ds_read_b64_tr_b16 v[80:81], v108 offset:13312
    ds_read_b64_tr_b16 v[82:83], v108 offset:13824
    v_sub_f32 v68, v68, v76
    v_sub_f32 v69, v69, v76
    s_waitcnt lgkmcnt(12)
    v_mfma_f32_32x32x16_bf16 v[32:47], v[88:91], v[200:203], v[32:47]
    ds_read_b64_tr_b16 v[84:85], v109 offset:13312
    ds_read_b64_tr_b16 v[86:87], v109 offset:13824
    v_sub_f32 v70, v70, v76
    v_sub_f32 v71, v71, v76
    s_waitcnt lgkmcnt(12)
    v_mfma_f32_32x32x16_bf16 v[48:63], v[92:95], v[200:203], v[48:63]
    ds_read_b64_tr_b16 v[88:89], v108 offset:16384
    ds_read_b64_tr_b16 v[90:91], v108 offset:16896
    v_sub_f32 v72, v72, v76
    v_sub_f32 v73, v73, v76
    s_waitcnt lgkmcnt(8)
    v_mfma_f32_32x32x16_bf16 v[0:15], v[96:99], v[204:207], v[0:15]
    ds_read_b64_tr_b16 v[92:93], v109 offset:16384
    ds_read_b64_tr_b16 v[94:95], v109 offset:16896
    v_sub_f32 v74, v74, v76
    v_sub_f32 v75, v75, v76
    s_waitcnt lgkmcnt(8)
    v_mfma_f32_32x32x16_bf16 v[16:31], v[100:103], v[204:207], v[16:31]
    ds_read_b64_tr_b16 v[96:97], v108 offset:17408
    ds_read_b64_tr_b16 v[98:99], v108 offset:17920
    v_cvt_pk_bf16_f32 v78, v78, v78
    v_lshlrev_b32 v78, 16, v78
    s_waitcnt lgkmcnt(8)
    v_mfma_f32_32x32x16_bf16 v[32:47], v[80:83], v[204:207], v[32:47]
    ds_read_b64_tr_b16 v[100:101], v109 offset:17408
    ds_read_b64_tr_b16 v[102:103], v109 offset:17920
    v_rcp_f32 v78, v78
    v_cvt_pk_bf16_f32 v64, v68, v69
    s_waitcnt lgkmcnt(8)
    v_mfma_f32_32x32x16_bf16 v[48:63], v[84:87], v[204:207], v[48:63]
    ds_read_b64_tr_b16 v[80:81], v108 offset:20480
    ds_read_b64_tr_b16 v[82:83], v108 offset:20992
    v_cvt_pk_bf16_f32 v65, v70, v71
    v_cvt_pk_bf16_f32 v66, v72, v73
    s_waitcnt lgkmcnt(8)
    v_mfma_f32_32x32x16_bf16 v[0:15], v[88:91], v[208:211], v[0:15]
    ds_read_b64_tr_b16 v[84:85], v109 offset:20480
    ds_read_b64_tr_b16 v[86:87], v109 offset:20992
    v_cvt_pk_bf16_f32 v67, v74, v75
    v_lshlrev_b32 v68, 16, v64
    s_waitcnt lgkmcnt(8)
    v_mfma_f32_32x32x16_bf16 v[16:31], v[92:95], v[208:211], v[16:31]
    ds_read_b64_tr_b16 v[88:89], v108 offset:21504
    ds_read_b64_tr_b16 v[90:91], v108 offset:22016
    v_and_b32 v69, 0xffff0000, v64
    v_lshlrev_b32 v70, 16, v65
    s_waitcnt lgkmcnt(8)
    v_mfma_f32_32x32x16_bf16 v[32:47], v[96:99], v[208:211], v[32:47]
    ds_read_b64_tr_b16 v[92:93], v109 offset:21504
    ds_read_b64_tr_b16 v[94:95], v109 offset:22016
    v_and_b32 v71, 0xffff0000, v65
    v_lshlrev_b32 v72, 16, v66
    s_waitcnt lgkmcnt(8)
    v_mfma_f32_32x32x16_bf16 v[48:63], v[100:103], v[208:211], v[48:63]
    ds_read_b64_tr_b16 v[96:97], v108 offset:24576
    ds_read_b64_tr_b16 v[98:99], v108 offset:25088
    v_and_b32 v73, 0xffff0000, v66
    v_lshlrev_b32 v74, 16, v67
    s_waitcnt lgkmcnt(8)
    v_mfma_f32_32x32x16_bf16 v[0:15], v[80:83], v[212:215], v[0:15]
    ds_read_b64_tr_b16 v[100:101], v109 offset:24576
    ds_read_b64_tr_b16 v[102:103], v109 offset:25088
    v_and_b32 v75, 0xffff0000, v67
    v_mul_f32 v68, v68, v78
    s_cmp_lg_u32 s3, 0
    s_cbranch_scc1 k1f_kernel_tkp
    buffer_load_dwordx2 v[110:111], off, s[76:79], 0 sc1
k1f_kernel_tkp:
    s_waitcnt lgkmcnt(8)
    v_mfma_f32_32x32x16_bf16 v[16:31], v[84:87], v[212:215], v[16:31]
    ds_read_b64_tr_b16 v[80:81], v108 offset:25600
    ds_read_b64_tr_b16 v[82:83], v108 offset:26112
    v_mul_f32 v69, v69, v78
    v_mul_f32 v70, v70, v78
    s_waitcnt lgkmcnt(8)
    v_mfma_f32_32x32x16_bf16 v[32:47], v[88:91], v[212:215], v[32:47]
    ds_read_b64_tr_b16 v[84:85], v109 offset:25600
    ds_read_b64_tr_b16 v[86:87], v109 offset:26112
    s_waitcnt vmcnt(6)
    s_barrier
    ds_read_b128 v[224:227], v113 offset:0
    ds_read_b128 v[228:231], v114 offset:0
    ds_read_b128 v[232:235], v115 offset:0
    ds_read_b128 v[236:239], v116 offset:0
    v_mul_f32 v71, v71, v78
    v_mul_f32 v72, v72, v78
    s_waitcnt lgkmcnt(12)
    v_mfma_f32_32x32x16_bf16 v[48:63], v[92:95], v[212:215], v[48:63]
    ds_read_b64_tr_b16 v[88:89], v108 offset:28672
    ds_read_b64_tr_b16 v[90:91], v108 offset:29184
    s_add_u32 m0, s43, 0
    s_add_u32 s55, s52, 0
    buffer_load_dwordx4 v106, s[20:23], s55 offen offset:0 lds
    v_mul_f32 v73, v73, v78
    v_mul_f32 v74, v74, v78
    s_waitcnt lgkmcnt(12)
    v_mfma_f32_32x32x16_bf16 v[0:15], v[96:99], v[216:219], v[0:15]
    ds_read_b64_tr_b16 v[92:93], v109 offset:28672
    ds_read_b64_tr_b16 v[94:95], v109 offset:29184
    s_add_u32 s55, s52, 64512
    buffer_load_dwordx4 v106, s[20:23], s55 offen offset:1024 lds
    v_mul_f32 v75, v75, v78
    v_cvt_pk_bf16_f32 v64, v68, v69
    s_waitcnt lgkmcnt(12)
    v_mfma_f32_32x32x16_bf16 v[16:31], v[100:103], v[216:219], v[16:31]
    ds_read_b64_tr_b16 v[96:97], v108 offset:29696
    ds_read_b64_tr_b16 v[98:99], v108 offset:30208
    v_cvt_pk_bf16_f32 v65, v70, v71
    v_cvt_pk_bf16_f32 v66, v72, v73
    s_waitcnt lgkmcnt(12)
    v_mfma_f32_32x32x16_bf16 v[32:47], v[80:83], v[216:219], v[32:47]
    ds_read_b64_tr_b16 v[100:101], v109 offset:29696
    ds_read_b64_tr_b16 v[102:103], v109 offset:30208
    s_waitcnt lgkmcnt(8)
    s_add_u32 m0, s44, 0
    s_add_u32 s55, s52, 1048576
    buffer_load_dwordx4 v106, s[20:23], s55 offen offset:0 lds
    v_cvt_pk_bf16_f32 v67, v74, v75
    v_mfma_f32_32x32x16_bf16 v[48:63], v[84:87], v[216:219], v[48:63]
    ds_read_b64_tr_b16 v[80:81], v108 offset:32768
    ds_read_b64_tr_b16 v[82:83], v108 offset:33280
    s_add_u32 s55, s52, 1113088
    buffer_load_dwordx4 v106, s[20:23], s55 offen offset:1024 lds
    s_waitcnt lgkmcnt(8)
    v_mfma_f32_32x32x16_bf16 v[0:15], v[88:91], v[220:223], v[0:15]
    ds_read_b64_tr_b16 v[84:85], v109 offset:32768
    ds_read_b64_tr_b16 v[86:87], v109 offset:33280
    s_add_u32 m0, s44, 2048
    s_add_u32 s55, s52, 2097152
    buffer_load_dwordx4 v106, s[20:23], s55 offen offset:0 lds
    s_waitcnt lgkmcnt(8)
    v_mfma_f32_32x32x16_bf16 v[16:31], v[92:95], v[220:223], v[16:31]
    ds_read_b64_tr_b16 v[88:89], v108 offset:33792
    ds_read_b64_tr_b16 v[90:91], v108 offset:34304
    s_add_u32 s55, s52, 2161664
    buffer_load_dwordx4 v106, s[20:23], s55 offen offset:1024 lds
    s_waitcnt lgkmcnt(8)
    v_mfma_f32_32x32x16_bf16 v[32:47], v[96:99], v[220:223], v[32:47]
    ds_read_b64_tr_b16 v[92:93], v109 offset:33792
    ds_read_b64_tr_b16 v[94:95], v109 offset:34304
    s_waitcnt lgkmcnt(8)
    v_mfma_f32_32x32x16_bf16 v[48:63], v[100:103], v[220:223], v[48:63]
    ds_read_b64_tr_b16 v[96:97], v108 offset:36864
    ds_read_b64_tr_b16 v[98:99], v108 offset:37376
    s_waitcnt lgkmcnt(8)
    v_mfma_f32_32x32x16_bf16 v[0:15], v[80:83], v[224:227], v[0:15]
    ds_read_b64_tr_b16 v[100:101], v109 offset:36864
    ds_read_b64_tr_b16 v[102:103], v109 offset:37376
    s_waitcnt lgkmcnt(8)
    v_mfma_f32_32x32x16_bf16 v[16:31], v[84:87], v[224:227], v[16:31]
    ds_read_b64_tr_b16 v[80:81], v108 offset:37888
    ds_read_b64_tr_b16 v[82:83], v108 offset:38400
    s_waitcnt lgkmcnt(8)
    v_mfma_f32_32x32x16_bf16 v[32:47], v[88:91], v[224:227], v[32:47]
    ds_read_b64_tr_b16 v[84:85], v109 offset:37888
    ds_read_b64_tr_b16 v[86:87], v109 offset:38400
    ds_write_b128 v126, v[64:67] offset:8192
    s_waitcnt lgkmcnt(9)
    v_mfma_f32_32x32x16_bf16 v[48:63], v[92:95], v[224:227], v[48:63]
    ds_read_b64_tr_b16 v[88:89], v108 offset:40960
    ds_read_b64_tr_b16 v[90:91], v108 offset:41472
    s_waitcnt lgkmcnt(9)
    v_mfma_f32_32x32x16_bf16 v[0:15], v[96:99], v[228:231], v[0:15]
    ds_read_b64_tr_b16 v[92:93], v109 offset:40960
    ds_read_b64_tr_b16 v[94:95], v109 offset:41472
    s_waitcnt lgkmcnt(9)
    v_mfma_f32_32x32x16_bf16 v[16:31], v[100:103], v[228:231], v[16:31]
    ds_read_b64_tr_b16 v[96:97], v108 offset:41984
    ds_read_b64_tr_b16 v[98:99], v108 offset:42496
    s_waitcnt lgkmcnt(9)
    v_mfma_f32_32x32x16_bf16 v[32:47], v[80:83], v[228:231], v[32:47]
    ds_read_b64_tr_b16 v[100:101], v109 offset:41984
    ds_read_b64_tr_b16 v[102:103], v109 offset:42496
    s_waitcnt lgkmcnt(8)
    s_waitcnt vmcnt(6)
    s_barrier
    ds_read_b128 v[240:243], v113 offset:4096
    ds_read_b128 v[244:247], v114 offset:4096
    ds_read_b128 v[248:251], v115 offset:4096
    ds_read_b128 v[252:255], v116 offset:4096
    v_mfma_f32_32x32x16_bf16 v[48:63], v[84:87], v[228:231], v[48:63]
    ds_read_b64_tr_b16 v[80:81], v108 offset:45056
    ds_read_b64_tr_b16 v[82:83], v108 offset:45568
    s_add_u32 m0, s43, 16384
    s_add_u32 s55, s52, 3145728
    buffer_load_dwordx4 v106, s[20:23], s55 offen offset:0 lds
    s_waitcnt lgkmcnt(12)
    v_mfma_f32_32x32x16_bf16 v[0:15], v[88:91], v[232:235], v[0:15]
    ds_read_b64_tr_b16 v[84:85], v109 offset:45056
    ds_read_b64_tr_b16 v[86:87], v109 offset:45568
    s_add_u32 s55, s52, 3210240
    buffer_load_dwordx4 v106, s[20:23], s55 offen offset:1024 lds
    s_waitcnt lgkmcnt(12)
    v_mfma_f32_32x32x16_bf16 v[16:31], v[92:95], v[232:235], v[16:31]
    ds_read_b64_tr_b16 v[88:89], v108 offset:46080
    ds_read_b64_tr_b16 v[90:91], v108 offset:46592
    ds_read_b128 v[64:67], v127
    s_waitcnt lgkmcnt(13)
    v_mfma_f32_32x32x16_bf16 v[32:47], v[96:99], v[232:235], v[32:47]
    ds_read_b64_tr_b16 v[92:93], v109 offset:46080
    ds_read_b64_tr_b16 v[94:95], v109 offset:46592
    s_waitcnt lgkmcnt(9)
    s_add_u32 m0, s44, 4096
    s_add_u32 s55, s52, 128
    buffer_load_dwordx4 v106, s[20:23], s55 offen offset:0 lds
    v_mfma_f32_32x32x16_bf16 v[48:63], v[100:103], v[232:235], v[48:63]
    ds_read_b64_tr_b16 v[96:97], v108 offset:49152
    ds_read_b64_tr_b16 v[98:99], v108 offset:49664
    s_add_u32 s55, s52, 64640
    buffer_load_dwordx4 v106, s[20:23], s55 offen offset:1024 lds
    s_waitcnt lgkmcnt(9)
    v_mfma_f32_32x32x16_bf16 v[0:15], v[80:83], v[236:239], v[0:15]
    ds_read_b64_tr_b16 v[100:101], v109 offset:49152
    ds_read_b64_tr_b16 v[102:103], v109 offset:49664
    s_add_u32 m0, s44, 6144
    s_add_u32 s55, s52, 1048704
    buffer_load_dwordx4 v106, s[20:23], s55 offen offset:0 lds
    s_waitcnt lgkmcnt(9)
    v_mfma_f32_32x32x16_bf16 v[16:31], v[84:87], v[236:239], v[16:31]
    ds_read_b64_tr_b16 v[80:81], v108 offset:50176
    ds_read_b64_tr_b16 v[82:83], v108 offset:50688
    s_add_u32 s55, s52, 1113216
    buffer_load_dwordx4 v106, s[20:23], s55 offen offset:1024 lds
    s_waitcnt lgkmcnt(9)
    v_mfma_f32_32x32x16_bf16 v[32:47], v[88:91], v[236:239], v[32:47]
    ds_read_b64_tr_b16 v[84:85], v109 offset:50176
    ds_read_b64_tr_b16 v[86:87], v109 offset:50688
    s_waitcnt lgkmcnt(10)
    buffer_store_dwordx4 v[64:67], v124, s[24:27], s60 offen sc1
    s_waitcnt lgkmcnt(8)
    v_mfma_f32_32x32x16_bf16 v[48:63], v[92:95], v[236:239], v[48:63]
    ds_read_b64_tr_b16 v[88:89], v108 offset:53248
    ds_read_b64_tr_b16 v[90:91], v108 offset:53760
    s_waitcnt lgkmcnt(8)
    v_mfma_f32_32x32x16_bf16 v[0:15], v[96:99], v[240:243], v[0:15]
    ds_read_b64_tr_b16 v[92:93], v109 offset:53248
    ds_read_b64_tr_b16 v[94:95], v109 offset:53760
    s_waitcnt lgkmcnt(8)
    v_mfma_f32_32x32x16_bf16 v[16:31], v[100:103], v[240:243], v[16:31]
    ds_read_b64_tr_b16 v[96:97], v108 offset:54272
    ds_read_b64_tr_b16 v[98:99], v108 offset:54784
    s_waitcnt lgkmcnt(8)
    v_mfma_f32_32x32x16_bf16 v[32:47], v[80:83], v[240:243], v[32:47]
    ds_read_b64_tr_b16 v[100:101], v109 offset:54272
    ds_read_b64_tr_b16 v[102:103], v109 offset:54784
    s_waitcnt lgkmcnt(8)
    v_mfma_f32_32x32x16_bf16 v[48:63], v[84:87], v[240:243], v[48:63]
    ds_read_b64_tr_b16 v[80:81], v108 offset:57344
    ds_read_b64_tr_b16 v[82:83], v108 offset:57856
    s_waitcnt lgkmcnt(8)
    v_mfma_f32_32x32x16_bf16 v[0:15], v[88:91], v[244:247], v[0:15]
    ds_read_b64_tr_b16 v[84:85], v109 offset:57344
    ds_read_b64_tr_b16 v[86:87], v109 offset:57856
    s_waitcnt lgkmcnt(8)
    v_mfma_f32_32x32x16_bf16 v[16:31], v[92:95], v[244:247], v[16:31]
    ds_read_b64_tr_b16 v[88:89], v108 offset:58368
    ds_read_b64_tr_b16 v[90:91], v108 offset:58880
    s_waitcnt lgkmcnt(8)
    v_mfma_f32_32x32x16_bf16 v[32:47], v[96:99], v[244:247], v[32:47]
    ds_read_b64_tr_b16 v[92:93], v109 offset:58368
    ds_read_b64_tr_b16 v[94:95], v109 offset:58880
    s_waitcnt vmcnt(5)
    s_barrier
    s_waitcnt lgkmcnt(8)
    v_mfma_f32_32x32x16_bf16 v[48:63], v[100:103], v[244:247], v[48:63]
    ds_read_b64_tr_b16 v[96:97], v108 offset:61440
    ds_read_b64_tr_b16 v[98:99], v108 offset:61952
    s_waitcnt lgkmcnt(8)
    v_mfma_f32_32x32x16_bf16 v[0:15], v[80:83], v[248:251], v[0:15]
    ds_read_b64_tr_b16 v[100:101], v109 offset:61440
    ds_read_b64_tr_b16 v[102:103], v109 offset:61952
    s_waitcnt lgkmcnt(8)
    v_mfma_f32_32x32x16_bf16 v[16:31], v[84:87], v[248:251], v[16:31]
    ds_read_b64_tr_b16 v[80:81], v108 offset:62464
    ds_read_b64_tr_b16 v[82:83], v108 offset:62976
    s_waitcnt lgkmcnt(8)
    v_mfma_f32_32x32x16_bf16 v[32:47], v[88:91], v[248:251], v[32:47]
    ds_read_b64_tr_b16 v[84:85], v109 offset:62464
    ds_read_b64_tr_b16 v[86:87], v109 offset:62976
    s_add_u32 m0, s44, 8192
    s_add_u32 s55, s52, 2097280
    buffer_load_dwordx4 v106, s[20:23], s55 offen offset:0 lds
    s_waitcnt lgkmcnt(8)
    v_mfma_f32_32x32x16_bf16 v[48:63], v[92:95], v[248:251], v[48:63]
    ds_read_b64_tr_b16 v[88:89], v112 offset:0
    ds_read_b64_tr_b16 v[90:91], v112 offset:512
    s_add_u32 s55, s52, 2161792
    buffer_load_dwordx4 v106, s[20:23], s55 offen offset:1024 lds
    s_waitcnt lgkmcnt(8)
    v_mfma_f32_32x32x16_bf16 v[0:15], v[96:99], v[252:255], v[0:15]
    ds_read_b64_tr_b16 v[92:93], v112 offset:2048
    ds_read_b64_tr_b16 v[94:95], v112 offset:2560
    s_add_u32 m0, s44, 10240
    s_add_u32 s55, s52, 3145856
    buffer_load_dwordx4 v106, s[20:23], s55 offen offset:0 lds
    s_waitcnt lgkmcnt(8)
    v_mfma_f32_32x32x16_bf16 v[16:31], v[100:103], v[252:255], v[16:31]
    ds_read_b64_tr_b16 v[96:97], v112 offset:4096
    ds_read_b64_tr_b16 v[98:99], v112 offset:4608
    s_add_u32 s55, s52, 3210368
    buffer_load_dwordx4 v106, s[20:23], s55 offen offset:1024 lds
    s_waitcnt lgkmcnt(8)
    v_mfma_f32_32x32x16_bf16 v[32:47], v[80:83], v[252:255], v[32:47]
    ds_read_b64_tr_b16 v[100:101], v112 offset:6144
    ds_read_b64_tr_b16 v[102:103], v112 offset:6656
    s_waitcnt lgkmcnt(8)
    v_mfma_f32_32x32x16_bf16 v[48:63], v[84:87], v[252:255], v[48:63]
    ds_read_b64_tr_b16 v[80:81], v112 offset:8192
    ds_read_b64_tr_b16 v[82:83], v112 offset:8704
    s_waitcnt lgkmcnt(8)
    v_mfma_f32_32x32x16_bf16 v[64:79], v[128:131], v[88:91], 0
    ds_read_b64_tr_b16 v[84:85], v112 offset:10240
    ds_read_b64_tr_b16 v[86:87], v112 offset:10752
    s_waitcnt lgkmcnt(8)
    v_mfma_f32_32x32x16_bf16 v[64:79], v[132:135], v[92:95], v[64:79]
    ds_read_b64_tr_b16 v[88:89], v112 offset:12288
    ds_read_b64_tr_b16 v[90:91], v112 offset:12800
    s_waitcnt lgkmcnt(8)
    v_mfma_f32_32x32x16_bf16 v[64:79], v[136:139], v[96:99], v[64:79]
    ds_read_b64_tr_b16 v[92:93], v112 offset:14336
    ds_read_b64_tr_b16 v[94:95], v112 offset:14848
    v_cvt_pk_bf16_f32 v0, v0, v1
    v_cvt_pk_bf16_f32 v1, v2, v3
    v_cvt_pk_bf16_f32 v2, v4, v5
    v_cvt_pk_bf16_f32 v3, v6, v7
    s_waitcnt lgkmcnt(8)
    v_mfma_f32_32x32x16_bf16 v[64:79], v[140:143], v[100:103], v[64:79]
    ds_read_b64_tr_b16 v[96:97], v119 offset:0
    ds_read_b64_tr_b16 v[98:99], v119 offset:512
    v_cvt_pk_bf16_f32 v4, v8, v9
    v_cvt_pk_bf16_f32 v5, v10, v11
    v_cvt_pk_bf16_f32 v6, v12, v13
    v_cvt_pk_bf16_f32 v7, v14, v15
    s_waitcnt lgkmcnt(8)
    v_mfma_f32_32x32x16_bf16 v[64:79], v[144:147], v[80:83], v[64:79]
    ds_read_b64_tr_b16 v[100:101], v119 offset:12288
    ds_read_b64_tr_b16 v[102:103], v119 offset:12800
    buffer_store_dwordx4 v[0:3], v117, s[24:27], s46 offen offset:0 sc1
    s_waitcnt lgkmcnt(8)
    v_mfma_f32_32x32x16_bf16 v[64:79], v[148:151], v[84:87], v[64:79]
    ds_read_b64_tr_b16 v[80:81], v119 offset:24576
    ds_read_b64_tr_b16 v[82:83], v119 offset:25088
    s_waitcnt lgkmcnt(8)
    v_mfma_f32_32x32x16_bf16 v[64:79], v[152:155], v[88:91], v[64:79]
    ds_read_b64_tr_b16 v[84:85], v119 offset:36864
    ds_read_b64_tr_b16 v[86:87], v119 offset:37376
    s_cmp_lg_u32 s3, 0
    s_cbranch_scc1 k1f_kernel_tkc
    v_readfirstlane_b32 s64, v110
    v_readfirstlane_b32 s65, v111
    s_cmp_lg_u32 s64, 0
    s_cbranch_scc0 k1f_kernel_tks
k1f_kernel_tkc:
    s_waitcnt vmcnt(5)
    s_barrier
    s_cmp_lg_u32 s3, 0
    s_cbranch_scc1 k1f_kernel_xp
    s_lshl_b32 s6, s2, 7
    s_add_u32 s6, s6, 0x3b80000
    v_bfe_u32 v125, v117, 1, 7
    v_mov_b32 v126, s64
    v_mov_b32 v127, s65
    buffer_store_dwordx2 v[126:127], v125, s[24:27], s6 offen sc1
k1f_kernel_xp:
    s_waitcnt lgkmcnt(8)
    v_mfma_f32_32x32x16_bf16 v[64:79], v[156:159], v[92:95], v[64:79]
    ds_read_b64_tr_b16 v[88:89], v120 offset:0
    ds_read_b64_tr_b16 v[90:91], v120 offset:512
    buffer_load_dwordx2 v[110:111], off, s[76:79], 0 sc1
    s_waitcnt lgkmcnt(8)
    v_mfma_f32_32x32x16_bf16 v[64:79], v[160:163], v[96:99], v[64:79]
    ds_read_b64_tr_b16 v[92:93], v120 offset:12288
    ds_read_b64_tr_b16 v[94:95], v120 offset:12800
    buffer_load_dword v121, v123, s[56:59], s62 offen
    s_waitcnt lgkmcnt(8)
    v_mfma_f32_32x32x16_bf16 v[64:79], v[164:167], v[100:103], v[64:79]
    ds_read_b64_tr_b16 v[96:97], v120 offset:24576
    ds_read_b64_tr_b16 v[98:99], v120 offset:25088
    s_waitcnt lgkmcnt(8)
    v_mfma_f32_32x32x16_bf16 v[64:79], v[168:171], v[80:83], v[64:79]
    ds_read_b64_tr_b16 v[100:101], v120 offset:36864
    ds_read_b64_tr_b16 v[102:103], v120 offset:37376
    s_lshl_b32 s6, s5, 2
    s_sub_u32 s7, 60, s6
    s_waitcnt lgkmcnt(8)
    v_mfma_f32_32x32x16_bf16 v[64:79], v[172:175], v[84:87], v[64:79]
    ds_read_b64_tr_b16 v[80:81], v119 offset:2048
    ds_read_b64_tr_b16 v[82:83], v119 offset:2560
    s_add_u32 s7, s7, s3
    s_add_u32 s6, s6, 7
    s_waitcnt lgkmcnt(8)
    v_mfma_f32_32x32x16_bf16 v[64:79], v[176:179], v[88:91], v[64:79]
    ds_read_b64_tr_b16 v[84:85], v119 offset:14336
    ds_read_b64_tr_b16 v[86:87], v119 offset:14848
    s_sub_u32 s6, s6, s3
    s_lshr_b32 s31, s3, 2
    s_waitcnt lgkmcnt(8)
    v_mfma_f32_32x32x16_bf16 v[64:79], v[180:183], v[92:95], v[64:79]
    ds_read_b64_tr_b16 v[88:89], v119 offset:26624
    ds_read_b64_tr_b16 v[90:91], v119 offset:27136
    s_cmp_eq_u32 s31, 0
    s_cselect_b32 s63, s7, s6
    s_lshl_b32 s53, s63, 15
    s_waitcnt lgkmcnt(8)
    v_mfma_f32_32x32x16_bf16 v[64:79], v[184:187], v[96:99], v[64:79]
    ds_read_b64_tr_b16 v[92:93], v119 offset:38912
    ds_read_b64_tr_b16 v[94:95], v119 offset:39424
    buffer_store_dwordx4 v[4:7], v117, s[24:27], s46 offen offset:1024 sc1
    s_lshl_b32 s6, s5, 1
    s_sub_u32 s28, 32, s6
    s_waitcnt lgkmcnt(8)
    v_mfma_f32_32x32x16_bf16 v[64:79], v[188:191], v[100:103], v[64:79]
    ds_read_b64_tr_b16 v[96:97], v120 offset:2048
    ds_read_b64_tr_b16 v[98:99], v120 offset:2560
    s_lshl_b32 s6, s4, 20
    s_add_u32 s6, s6, 0x200000
    s_waitcnt lgkmcnt(8)
    v_mfma_f32_32x32x16_bf16 v[64:79], v[192:195], v[80:83], v[64:79]
    ds_read_b64_tr_b16 v[100:101], v120 offset:14336
    ds_read_b64_tr_b16 v[102:103], v120 offset:14848
    s_add_u32 s72, s36, s6
    s_addc_u32 s73, s37, 0
    s_lshl_b32 s74, s28, 15
    s_waitcnt lgkmcnt(8)
    v_mfma_f32_32x32x16_bf16 v[64:79], v[196:199], v[84:87], v[64:79]
    ds_read_b64_tr_b16 v[80:81], v120 offset:26624
    ds_read_b64_tr_b16 v[82:83], v120 offset:27136
    s_mov_b32 s75, 0x20000
    s_lshr_b32 s29, s63, 1
    s_waitcnt lgkmcnt(8)
    v_mfma_f32_32x32x16_bf16 v[64:79], v[200:203], v[88:91], v[64:79]
    ds_read_b64_tr_b16 v[84:85], v120 offset:38912
    ds_read_b64_tr_b16 v[86:87], v120 offset:39424
    s_add_u32 s29, s29, 1
    s_and_b32 s6, s63, 1
    s_waitcnt lgkmcnt(8)
    v_mfma_f32_32x32x16_bf16 v[64:79], v[204:207], v[92:95], v[64:79]
    ds_read_b64_tr_b16 v[88:89], v112 offset:16384
    ds_read_b64_tr_b16 v[90:91], v112 offset:16896
    s_lshl_b32 s6, s6, 5
    v_and_b32 v115, 31, v118
    s_waitcnt lgkmcnt(8)
    v_mfma_f32_32x32x16_bf16 v[64:79], v[208:211], v[96:99], v[64:79]
    ds_read_b64_tr_b16 v[92:93], v112 offset:18432
    ds_read_b64_tr_b16 v[94:95], v112 offset:18944
    v_lshrrev_b32 v116, 5, v118
    v_lshlrev_b32 v116, 2, v116
    s_waitcnt lgkmcnt(8)
    v_mfma_f32_32x32x16_bf16 v[64:79], v[212:215], v[100:103], v[64:79]
    ds_read_b64_tr_b16 v[96:97], v112 offset:20480
    ds_read_b64_tr_b16 v[98:99], v112 offset:20992
    v_sub_u32 v115, v115, v116
    v_add_u32 v107, s6, v115
    s_waitcnt lgkmcnt(8)
    v_mfma_f32_32x32x16_bf16 v[64:79], v[216:219], v[80:83], v[64:79]
    ds_read_b64_tr_b16 v[100:101], v112 offset:22528
    ds_read_b64_tr_b16 v[102:103], v112 offset:23040
    v_cvt_pk_bf16_f32 v8, v16, v17
    v_cvt_pk_bf16_f32 v9, v18, v19
    v_cvt_pk_bf16_f32 v10, v20, v21
    v_cvt_pk_bf16_f32 v11, v22, v23
    s_cmp_eq_u32 s29, 1
    s_cselect_b32 s6, 0, 1000
    v_add_u32 v124, s6, v107
    s_waitcnt lgkmcnt(8)
    v_mfma_f32_32x32x16_bf16 v[64:79], v[220:223], v[84:87], v[64:79]
    ds_read_b64_tr_b16 v[80:81], v112 offset:24576
    ds_read_b64_tr_b16 v[82:83], v112 offset:25088
    v_cvt_pk_bf16_f32 v12, v24, v25
    v_cvt_pk_bf16_f32 v13, v26, v27
    v_cvt_pk_bf16_f32 v14, v28, v29
    v_cvt_pk_bf16_f32 v15, v30, v31
    v_mov_b32 v122, 0xf149f2ca
    s_mov_b32 s30, 0
    s_waitcnt lgkmcnt(8)
    v_mfma_f32_32x32x16_bf16 v[64:79], v[224:227], v[88:91], v[64:79]
    ds_read_b64_tr_b16 v[84:85], v112 offset:26624
    ds_read_b64_tr_b16 v[86:87], v112 offset:27136
    buffer_store_dwordx4 v[8:11], v117, s[24:27], s46 offen offset:2048 sc1
    s_mov_b32 s32, 0x10000
    s_and_b32 s6, s3, 3
    s_waitcnt lgkmcnt(8)
    v_mfma_f32_32x32x16_bf16 v[64:79], v[228:231], v[92:95], v[64:79]
    ds_read_b64_tr_b16 v[88:89], v112 offset:28672
    ds_read_b64_tr_b16 v[90:91], v112 offset:29184
    s_lshl_b32 s42, s6, 12
    s_add_u32 s40, s42, 131072
    s_waitcnt lgkmcnt(8)
    v_mfma_f32_32x32x16_bf16 v[64:79], v[232:235], v[96:99], v[64:79]
    ds_read_b64_tr_b16 v[92:93], v112 offset:30720
    ds_read_b64_tr_b16 v[94:95], v112 offset:31232
    s_mov_b32 s33, s40
    s_add_u32 s80, s42, 16384
    s_waitcnt lgkmcnt(8)
    v_mfma_f32_32x32x16_bf16 v[64:79], v[236:239], v[100:103], v[64:79]
    v_xor_b32 v112, 64, v112
    v_xor_b32 v119, 64, v119
    v_xor_b32 v120, 64, v120
    ds_read_b64_tr_b16 v[96:97], v112 offset:0
    ds_read_b64_tr_b16 v[98:99], v112 offset:512
    s_add_u32 s81, s42, 163840
    s_lshl_b32 s82, s63, 18
    s_waitcnt lgkmcnt(8)
    v_mfma_f32_32x32x16_bf16 v[64:79], v[240:243], v[80:83], v[64:79]
    ds_read_b64_tr_b16 v[100:101], v112 offset:2048
    ds_read_b64_tr_b16 v[102:103], v112 offset:2560
    s_lshl_b32 s6, s4, 13
    s_add_u32 s82, s82, s6
    s_waitcnt lgkmcnt(8)
    v_mfma_f32_32x32x16_bf16 v[64:79], v[244:247], v[84:87], v[64:79]
    ds_read_b64_tr_b16 v[80:81], v112 offset:4096
    ds_read_b64_tr_b16 v[82:83], v112 offset:4608
    s_add_u32 s82, s82, 0x2200000
    v_add_u32 v104, 131072, v117
    s_waitcnt lgkmcnt(8)
    v_mfma_f32_32x32x16_bf16 v[64:79], v[248:251], v[88:91], v[64:79]
    ds_read_b64_tr_b16 v[84:85], v112 offset:6144
    ds_read_b64_tr_b16 v[86:87], v112 offset:6656
    v_add_u32 v105, 98304, v117
    s_add_u32 s6, s28, 3
    s_waitcnt lgkmcnt(8)
    v_mfma_f32_32x32x16_bf16 v[64:79], v[252:255], v[92:95], v[64:79]
    ds_read_b64_tr_b16 v[88:89], v112 offset:8192
    ds_read_b64_tr_b16 v[90:91], v112 offset:8704
    s_lshr_b32 s6, s6, 2
    s_bfm_b32 s49, s6, 0
    s_waitcnt lgkmcnt(8)
    v_mfma_f32_32x32x16_bf16 v[16:31], v[128:131], v[96:99], 0
    ds_read_b64_tr_b16 v[92:93], v112 offset:10240
    ds_read_b64_tr_b16 v[94:95], v112 offset:10752
    s_waitcnt lgkmcnt(8)
    v_mfma_f32_32x32x16_bf16 v[16:31], v[132:135], v[100:103], v[16:31]
    ds_read_b64_tr_b16 v[96:97], v112 offset:12288
    ds_read_b64_tr_b16 v[98:99], v112 offset:12800
    s_waitcnt lgkmcnt(8)
    v_mfma_f32_32x32x16_bf16 v[16:31], v[136:139], v[80:83], v[16:31]
    ds_read_b64_tr_b16 v[100:101], v112 offset:14336
    ds_read_b64_tr_b16 v[102:103], v112 offset:14848
    buffer_store_dwordx4 v[12:15], v117, s[24:27], s46 offen offset:3072 sc1
    v_cvt_pk_bf16_f32 v0, v64, v65
    v_cvt_pk_bf16_f32 v1, v66, v67
    v_cvt_pk_bf16_f32 v2, v68, v69
    v_cvt_pk_bf16_f32 v3, v70, v71
    s_waitcnt lgkmcnt(8)
    v_mfma_f32_32x32x16_bf16 v[16:31], v[140:143], v[84:87], v[16:31]
    ds_read_b64_tr_b16 v[80:81], v119 offset:0
    ds_read_b64_tr_b16 v[82:83], v119 offset:512
    v_cvt_pk_bf16_f32 v4, v72, v73
    v_cvt_pk_bf16_f32 v5, v74, v75
    v_cvt_pk_bf16_f32 v6, v76, v77
    v_cvt_pk_bf16_f32 v7, v78, v79
    s_waitcnt lgkmcnt(8)
    v_mfma_f32_32x32x16_bf16 v[16:31], v[144:147], v[88:91], v[16:31]
    ds_read_b64_tr_b16 v[84:85], v119 offset:12288
    ds_read_b64_tr_b16 v[86:87], v119 offset:12800
    s_waitcnt lgkmcnt(8)
    v_mfma_f32_32x32x16_bf16 v[16:31], v[148:151], v[92:95], v[16:31]
    ds_read_b64_tr_b16 v[88:89], v119 offset:24576
    ds_read_b64_tr_b16 v[90:91], v119 offset:25088
    s_waitcnt lgkmcnt(8)
    v_mfma_f32_32x32x16_bf16 v[16:31], v[152:155], v[96:99], v[16:31]
    ds_read_b64_tr_b16 v[92:93], v119 offset:36864
    ds_read_b64_tr_b16 v[94:95], v119 offset:37376
    s_waitcnt lgkmcnt(8)
    v_mfma_f32_32x32x16_bf16 v[16:31], v[156:159], v[100:103], v[16:31]
    ds_read_b64_tr_b16 v[96:97], v120 offset:0
    ds_read_b64_tr_b16 v[98:99], v120 offset:512
    s_waitcnt lgkmcnt(8)
    v_mfma_f32_32x32x16_bf16 v[16:31], v[160:163], v[80:83], v[16:31]
    ds_read_b64_tr_b16 v[100:101], v120 offset:12288
    ds_read_b64_tr_b16 v[102:103], v120 offset:12800
    s_waitcnt lgkmcnt(8)
    v_mfma_f32_32x32x16_bf16 v[16:31], v[164:167], v[84:87], v[16:31]
    ds_read_b64_tr_b16 v[80:81], v120 offset:24576
    ds_read_b64_tr_b16 v[82:83], v120 offset:25088
    s_waitcnt lgkmcnt(8)
    v_mfma_f32_32x32x16_bf16 v[16:31], v[168:171], v[88:91], v[16:31]
    ds_read_b64_tr_b16 v[84:85], v120 offset:36864
    ds_read_b64_tr_b16 v[86:87], v120 offset:37376
    v_cvt_pk_bf16_f32 v32, v32, v33
    v_cvt_pk_bf16_f32 v33, v34, v35
    v_cvt_pk_bf16_f32 v34, v36, v37
    v_cvt_pk_bf16_f32 v35, v38, v39
    s_waitcnt lgkmcnt(8)
    v_mfma_f32_32x32x16_bf16 v[16:31], v[172:175], v[92:95], v[16:31]
    ds_read_b64_tr_b16 v[88:89], v119 offset:2048
    ds_read_b64_tr_b16 v[90:91], v119 offset:2560
    v_cvt_pk_bf16_f32 v36, v40, v41
    v_cvt_pk_bf16_f32 v37, v42, v43
    v_cvt_pk_bf16_f32 v38, v44, v45
    v_cvt_pk_bf16_f32 v39, v46, v47
    s_waitcnt lgkmcnt(8)
    v_mfma_f32_32x32x16_bf16 v[16:31], v[176:179], v[96:99], v[16:31]
    ds_read_b64_tr_b16 v[92:93], v119 offset:14336
    ds_read_b64_tr_b16 v[94:95], v119 offset:14848
    s_add_u32 s48, s46, 4096
    buffer_store_dwordx4 v[32:35], v117, s[24:27], s48 offen offset:0 sc1
    s_waitcnt lgkmcnt(8)
    v_mfma_f32_32x32x16_bf16 v[16:31], v[180:183], v[100:103], v[16:31]
    ds_read_b64_tr_b16 v[96:97], v119 offset:26624
    ds_read_b64_tr_b16 v[98:99], v119 offset:27136
    s_waitcnt lgkmcnt(8)
    v_mfma_f32_32x32x16_bf16 v[16:31], v[184:187], v[80:83], v[16:31]
    ds_read_b64_tr_b16 v[100:101], v119 offset:38912
    ds_read_b64_tr_b16 v[102:103], v119 offset:39424
    s_waitcnt lgkmcnt(8)
    v_mfma_f32_32x32x16_bf16 v[16:31], v[188:191], v[84:87], v[16:31]
    ds_read_b64_tr_b16 v[80:81], v120 offset:2048
    ds_read_b64_tr_b16 v[82:83], v120 offset:2560
    s_waitcnt lgkmcnt(8)
    v_mfma_f32_32x32x16_bf16 v[16:31], v[192:195], v[88:91], v[16:31]
    ds_read_b64_tr_b16 v[84:85], v120 offset:14336
    ds_read_b64_tr_b16 v[86:87], v120 offset:14848
    s_waitcnt lgkmcnt(8)
    v_mfma_f32_32x32x16_bf16 v[16:31], v[196:199], v[92:95], v[16:31]
    ds_read_b64_tr_b16 v[88:89], v120 offset:26624
    ds_read_b64_tr_b16 v[90:91], v120 offset:27136
    s_waitcnt lgkmcnt(8)
    v_mfma_f32_32x32x16_bf16 v[16:31], v[200:203], v[96:99], v[16:31]
    ds_read_b64_tr_b16 v[92:93], v120 offset:38912
    ds_read_b64_tr_b16 v[94:95], v120 offset:39424
    s_waitcnt lgkmcnt(8)
    v_mfma_f32_32x32x16_bf16 v[16:31], v[204:207], v[100:103], v[16:31]
    ds_read_b64_tr_b16 v[96:97], v112 offset:16384
    ds_read_b64_tr_b16 v[98:99], v112 offset:16896
    s_waitcnt lgkmcnt(8)
    v_mfma_f32_32x32x16_bf16 v[16:31], v[208:211], v[80:83], v[16:31]
    ds_read_b64_tr_b16 v[100:101], v112 offset:18432
    ds_read_b64_tr_b16 v[102:103], v112 offset:18944
    s_waitcnt lgkmcnt(8)
    v_mfma_f32_32x32x16_bf16 v[16:31], v[212:215], v[84:87], v[16:31]
    ds_read_b64_tr_b16 v[80:81], v112 offset:20480
    ds_read_b64_tr_b16 v[82:83], v112 offset:20992
    s_waitcnt lgkmcnt(8)
    v_mfma_f32_32x32x16_bf16 v[16:31], v[216:219], v[88:91], v[16:31]
    ds_read_b64_tr_b16 v[84:85], v112 offset:22528
    ds_read_b64_tr_b16 v[86:87], v112 offset:23040
    s_waitcnt vmcnt(5)
    s_barrier
    s_add_u32 s48, s46, 4096
    buffer_store_dwordx4 v[36:39], v117, s[24:27], s48 offen offset:1024 sc1
    s_waitcnt lgkmcnt(8)
    v_mfma_f32_32x32x16_bf16 v[16:31], v[220:223], v[92:95], v[16:31]
    ds_read_b64_tr_b16 v[88:89], v112 offset:24576
    ds_read_b64_tr_b16 v[90:91], v112 offset:25088
    v_readfirstlane_b32 s64, v110
    v_readfirstlane_b32 s65, v111
    s_waitcnt lgkmcnt(8)
    v_mfma_f32_32x32x16_bf16 v[16:31], v[224:227], v[96:99], v[16:31]
    ds_read_b64_tr_b16 v[92:93], v112 offset:26624
    ds_read_b64_tr_b16 v[94:95], v112 offset:27136
    s_add_u32 m0, s43, 32768
    s_add_u32 s55, s41, 0
    buffer_load_dwordx4 v106, s[56:59], s55 offen lds
    s_waitcnt lgkmcnt(8)
    v_mfma_f32_32x32x16_bf16 v[16:31], v[228:231], v[100:103], v[16:31]
    ds_read_b64_tr_b16 v[96:97], v112 offset:28672
    ds_read_b64_tr_b16 v[98:99], v112 offset:29184
    s_add_u32 m0, s43, 33664
    s_nop 0
    buffer_load_dwordx4 v106, s[56:59], s55 offen offset:128 lds
    s_waitcnt lgkmcnt(8)
    v_mfma_f32_32x32x16_bf16 v[16:31], v[232:235], v[80:83], v[16:31]
    ds_read_b64_tr_b16 v[100:101], v112 offset:30720
    ds_read_b64_tr_b16 v[102:103], v112 offset:31232
    s_add_u32 m0, s43, 49152
    s_add_u32 s55, s41, 524288
    buffer_load_dwordx4 v106, s[56:59], s55 offen lds
    s_waitcnt lgkmcnt(8)
    v_mfma_f32_32x32x16_bf16 v[16:31], v[236:239], v[84:87], v[16:31]
    v_xor_b32 v112, 64, v112
    v_xor_b32 v119, 64, v119
    v_xor_b32 v120, 64, v120
    ds_read_b64_tr_b16 v[80:81], v119 offset:4096
    ds_read_b64_tr_b16 v[82:83], v119 offset:4608
    s_add_u32 m0, s43, 50048
    s_nop 0
    buffer_load_dwordx4 v106, s[56:59], s55 offen offset:128 lds
    s_waitcnt lgkmcnt(8)
    v_mfma_f32_32x32x16_bf16 v[16:31], v[240:243], v[88:91], v[16:31]
    ds_read_b64_tr_b16 v[84:85], v119 offset:16384
    ds_read_b64_tr_b16 v[86:87], v119 offset:16896
    s_waitcnt lgkmcnt(8)
    v_mfma_f32_32x32x16_bf16 v[16:31], v[244:247], v[92:95], v[16:31]
    ds_read_b64_tr_b16 v[88:89], v119 offset:28672
    ds_read_b64_tr_b16 v[90:91], v119 offset:29184
    s_waitcnt lgkmcnt(8)
    v_mfma_f32_32x32x16_bf16 v[16:31], v[248:251], v[96:99], v[16:31]
    ds_read_b64_tr_b16 v[92:93], v119 offset:40960
    ds_read_b64_tr_b16 v[94:95], v119 offset:41472
    v_cvt_pk_bf16_f32 v40, v48, v49
    v_cvt_pk_bf16_f32 v41, v50, v51
    v_cvt_pk_bf16_f32 v42, v52, v53
    v_cvt_pk_bf16_f32 v43, v54, v55
    s_waitcnt lgkmcnt(8)
    v_mfma_f32_32x32x16_bf16 v[16:31], v[252:255], v[100:103], v[16:31]
    ds_read_b64_tr_b16 v[96:97], v120 offset:4096
    ds_read_b64_tr_b16 v[98:99], v120 offset:4608
    v_cvt_pk_bf16_f32 v44, v56, v57
    v_cvt_pk_bf16_f32 v45, v58, v59
    v_cvt_pk_bf16_f32 v46, v60, v61
    v_cvt_pk_bf16_f32 v47, v62, v63
    s_waitcnt lgkmcnt(8)
    v_mfma_f32_32x32x16_bf16 v[64:79], v[128:131], v[80:83], 0
    ds_read_b64_tr_b16 v[100:101], v120 offset:16384
    ds_read_b64_tr_b16 v[102:103], v120 offset:16896
    s_add_u32 s48, s46, 4096
    buffer_store_dwordx4 v[40:43], v117, s[24:27], s48 offen offset:2048 sc1
    s_waitcnt lgkmcnt(8)
    v_mfma_f32_32x32x16_bf16 v[64:79], v[132:135], v[84:87], v[64:79]
    ds_read_b64_tr_b16 v[80:81], v120 offset:28672
    ds_read_b64_tr_b16 v[82:83], v120 offset:29184
    s_waitcnt lgkmcnt(8)
    v_mfma_f32_32x32x16_bf16 v[64:79], v[136:139], v[88:91], v[64:79]
    ds_read_b64_tr_b16 v[84:85], v120 offset:40960
    ds_read_b64_tr_b16 v[86:87], v120 offset:41472
    v_cvt_pk_bf16_f32 v8, v16, v17
    v_cvt_pk_bf16_f32 v9, v18, v19
    v_cvt_pk_bf16_f32 v10, v20, v21
    v_cvt_pk_bf16_f32 v11, v22, v23
    s_waitcnt lgkmcnt(8)
    v_mfma_f32_32x32x16_bf16 v[64:79], v[140:143], v[92:95], v[64:79]
    ds_read_b64_tr_b16 v[88:89], v119 offset:6144
    ds_read_b64_tr_b16 v[90:91], v119 offset:6656
    v_cvt_pk_bf16_f32 v12, v24, v25
    v_cvt_pk_bf16_f32 v13, v26, v27
    v_cvt_pk_bf16_f32 v14, v28, v29
    v_cvt_pk_bf16_f32 v15, v30, v31
    s_waitcnt lgkmcnt(8)
    v_mfma_f32_32x32x16_bf16 v[64:79], v[144:147], v[96:99], v[64:79]
    ds_read_b64_tr_b16 v[92:93], v119 offset:18432
    ds_read_b64_tr_b16 v[94:95], v119 offset:18944
    s_waitcnt lgkmcnt(8)
    v_mfma_f32_32x32x16_bf16 v[64:79], v[148:151], v[100:103], v[64:79]
    ds_read_b64_tr_b16 v[96:97], v119 offset:30720
    ds_read_b64_tr_b16 v[98:99], v119 offset:31232
    s_waitcnt lgkmcnt(8)
    v_mfma_f32_32x32x16_bf16 v[64:79], v[152:155], v[80:83], v[64:79]
    ds_read_b64_tr_b16 v[100:101], v119 offset:43008
    ds_read_b64_tr_b16 v[102:103], v119 offset:43520
    s_waitcnt lgkmcnt(8)
    v_mfma_f32_32x32x16_bf16 v[64:79], v[156:159], v[84:87], v[64:79]
    ds_read_b64_tr_b16 v[80:81], v120 offset:6144
    ds_read_b64_tr_b16 v[82:83], v120 offset:6656
    s_waitcnt lgkmcnt(8)
    v_mfma_f32_32x32x16_bf16 v[64:79], v[160:163], v[88:91], v[64:79]
    ds_read_b64_tr_b16 v[84:85], v120 offset:18432
    ds_read_b64_tr_b16 v[86:87], v120 offset:18944
    s_waitcnt lgkmcnt(8)
    v_mfma_f32_32x32x16_bf16 v[64:79], v[164:167], v[92:95], v[64:79]
    ds_read_b64_tr_b16 v[88:89], v120 offset:30720
    ds_read_b64_tr_b16 v[90:91], v120 offset:31232
    s_waitcnt lgkmcnt(8)
    v_mfma_f32_32x32x16_bf16 v[64:79], v[168:171], v[96:99], v[64:79]
    ds_read_b64_tr_b16 v[92:93], v120 offset:43008
    ds_read_b64_tr_b16 v[94:95], v120 offset:43520
    s_add_u32 s48, s46, 4096
    buffer_store_dwordx4 v[44:47], v117, s[24:27], s48 offen offset:3072 sc1
    s_waitcnt lgkmcnt(8)
    v_mfma_f32_32x32x16_bf16 v[64:79], v[172:175], v[100:103], v[64:79]
    ds_read_b64_tr_b16 v[96:97], v119 offset:8192
    ds_read_b64_tr_b16 v[98:99], v119 offset:8704
    s_waitcnt lgkmcnt(8)
    v_mfma_f32_32x32x16_bf16 v[64:79], v[176:179], v[80:83], v[64:79]
    ds_read_b64_tr_b16 v[100:101], v119 offset:20480
    ds_read_b64_tr_b16 v[102:103], v119 offset:20992
    s_waitcnt lgkmcnt(8)
    v_mfma_f32_32x32x16_bf16 v[64:79], v[180:183], v[84:87], v[64:79]
    ds_read_b64_tr_b16 v[80:81], v119 offset:32768
    ds_read_b64_tr_b16 v[82:83], v119 offset:33280
    s_waitcnt lgkmcnt(8)
    v_mfma_f32_32x32x16_bf16 v[64:79], v[184:187], v[88:91], v[64:79]
    ds_read_b64_tr_b16 v[84:85], v119 offset:45056
    ds_read_b64_tr_b16 v[86:87], v119 offset:45568
    s_waitcnt lgkmcnt(8)
    v_mfma_f32_32x32x16_bf16 v[64:79], v[188:191], v[92:95], v[64:79]
    ds_read_b64_tr_b16 v[88:89], v120 offset:8192
    ds_read_b64_tr_b16 v[90:91], v120 offset:8704
    s_waitcnt lgkmcnt(8)
    v_mfma_f32_32x32x16_bf16 v[64:79], v[192:195], v[96:99], v[64:79]
    ds_read_b64_tr_b16 v[92:93], v120 offset:20480
    ds_read_b64_tr_b16 v[94:95], v120 offset:20992
    s_cmp_lg_u32 s3, 0
    s_cbranch_scc1 k1f_kernel_xcp
    s_lshl_b32 s6, s5, 11
    s_sub_u32 s7, 30720, s6
    v_mov_b32 v110, s6
    v_mov_b32 v111, s7
    v_and_b32 v125, 16, v118
    v_cmp_eq_u32 vcc, 0, v125
    s_nop 1
    v_cndmask_b32 v110, v110, v111, vcc
    v_and_b32 v125, 15, v118
    v_lshl_add_u32 v125, v125, 7, v110
    s_mov_b32 s6, 0x3b80000
    buffer_load_dwordx2 v[110:111], v125, s[24:27], s6 offen sc1
k1f_kernel_xcp:
    s_waitcnt lgkmcnt(8)
    v_mfma_f32_32x32x16_bf16 v[64:79], v[196:199], v[100:103], v[64:79]
    ds_read_b64_tr_b16 v[96:97], v120 offset:32768
    ds_read_b64_tr_b16 v[98:99], v120 offset:33280
    s_waitcnt lgkmcnt(8)
    v_mfma_f32_32x32x16_bf16 v[64:79], v[200:203], v[80:83], v[64:79]
    ds_read_b64_tr_b16 v[100:101], v120 offset:45056
    ds_read_b64_tr_b16 v[102:103], v120 offset:45568
    s_waitcnt lgkmcnt(8)
    v_mfma_f32_32x32x16_bf16 v[64:79], v[204:207], v[84:87], v[64:79]
    ds_read_b64_tr_b16 v[80:81], v119 offset:10240
    ds_read_b64_tr_b16 v[82:83], v119 offset:10752
    s_waitcnt lgkmcnt(8)
    v_mfma_f32_32x32x16_bf16 v[64:79], v[208:211], v[88:91], v[64:79]
    ds_read_b64_tr_b16 v[84:85], v119 offset:22528
    ds_read_b64_tr_b16 v[86:87], v119 offset:23040
    buffer_store_dwordx4 v[0:3], v117, s[24:27], s47 offen offset:0 sc1
    s_waitcnt lgkmcnt(8)
    v_mfma_f32_32x32x16_bf16 v[64:79], v[212:215], v[92:95], v[64:79]
    ds_read_b64_tr_b16 v[88:89], v119 offset:34816
    ds_read_b64_tr_b16 v[90:91], v119 offset:35328
    s_waitcnt lgkmcnt(8)
    v_mfma_f32_32x32x16_bf16 v[64:79], v[216:219], v[96:99], v[64:79]
    ds_read_b64_tr_b16 v[92:93], v119 offset:47104
    ds_read_b64_tr_b16 v[94:95], v119 offset:47616
    s_waitcnt lgkmcnt(8)
    v_mfma_f32_32x32x16_bf16 v[64:79], v[220:223], v[100:103], v[64:79]
    ds_read_b64_tr_b16 v[96:97], v120 offset:10240
    ds_read_b64_tr_b16 v[98:99], v120 offset:10752
    s_waitcnt lgkmcnt(8)
    v_mfma_f32_32x32x16_bf16 v[64:79], v[224:227], v[80:83], v[64:79]
    ds_read_b64_tr_b16 v[100:101], v120 offset:22528
    ds_read_b64_tr_b16 v[102:103], v120 offset:23040
    s_waitcnt lgkmcnt(8)
    v_mfma_f32_32x32x16_bf16 v[64:79], v[228:231], v[84:87], v[64:79]
    ds_read_b64_tr_b16 v[80:81], v120 offset:34816
    ds_read_b64_tr_b16 v[82:83], v120 offset:35328
    s_waitcnt lgkmcnt(8)
    v_mfma_f32_32x32x16_bf16 v[64:79], v[232:235], v[88:91], v[64:79]
    ds_read_b64_tr_b16 v[84:85], v120 offset:47104
    ds_read_b64_tr_b16 v[86:87], v120 offset:47616
    s_waitcnt lgkmcnt(8)
    v_mfma_f32_32x32x16_bf16 v[64:79], v[236:239], v[92:95], v[64:79]
    v_xor_b32 v112, 64, v112
    v_xor_b32 v119, 64, v119
    v_xor_b32 v120, 64, v120
    ds_read_b64_tr_b16 v[88:89], v119 offset:4096
    ds_read_b64_tr_b16 v[90:91], v119 offset:4608
    s_waitcnt lgkmcnt(8)
    v_mfma_f32_32x32x16_bf16 v[64:79], v[240:243], v[96:99], v[64:79]
    ds_read_b64_tr_b16 v[92:93], v119 offset:16384
    ds_read_b64_tr_b16 v[94:95], v119 offset:16896
    s_waitcnt lgkmcnt(8)
    v_mfma_f32_32x32x16_bf16 v[64:79], v[244:247], v[100:103], v[64:79]
    ds_read_b64_tr_b16 v[96:97], v119 offset:28672
    ds_read_b64_tr_b16 v[98:99], v119 offset:29184
    s_waitcnt lgkmcnt(8)
    v_mfma_f32_32x32x16_bf16 v[64:79], v[248:251], v[80:83], v[64:79]
    ds_read_b64_tr_b16 v[100:101], v119 offset:40960
    ds_read_b64_tr_b16 v[102:103], v119 offset:41472
    s_cmp_lg_u32 s3, 0
    s_cbranch_scc1 k1f_kernel_xcc
    s_waitcnt vmcnt(1)
    v_cmp_eq_u64 vcc, s[64:65], v[110:111]
    s_cmp_eq_u64 vcc, -1
    s_cbranch_scc0 k1f_kernel_xcs
k1f_kernel_xcc:
    buffer_store_dwordx4 v[4:7], v117, s[24:27], s47 offen offset:1024 sc1
    s_waitcnt vmcnt(2)
    s_barrier
    s_cmp_lg_u32 s3, 0
    s_cbranch_scc1 k1f_kernel_kp
    s_lshl_b32 s6, s2, 7
    s_add_u32 s6, s6, 0x3b88000
    v_bfe_u32 v125, v117, 1, 7
    v_mov_b32 v126, s64
    v_mov_b32 v127, s65
    buffer_store_dwordx2 v[126:127], v125, s[24:27], s6 offen sc1
k1f_kernel_kp:
    s_waitcnt lgkmcnt(8)
    v_mfma_f32_32x32x16_bf16 v[64:79], v[252:255], v[84:87], v[64:79]
    ds_read_b64_tr_b16 v[80:81], v120 offset:4096
    ds_read_b64_tr_b16 v[82:83], v120 offset:4608
    s_add_u32 m0, s43, 0
    s_add_u32 s55, s41, 1048576
    buffer_load_dwordx4 v106, s[56:59], s55 offen lds
    s_waitcnt lgkmcnt(8)
    v_mfma_f32_32x32x16_bf16 v[48:63], v[128:131], v[88:91], 0
    ds_read_b64_tr_b16 v[84:85], v120 offset:16384
    ds_read_b64_tr_b16 v[86:87], v120 offset:16896
    s_add_u32 m0, s43, 896
    s_nop 0
    buffer_load_dwordx4 v106, s[56:59], s55 offen offset:128 lds
    s_waitcnt lgkmcnt(8)
    v_mfma_f32_32x32x16_bf16 v[48:63], v[132:135], v[92:95], v[48:63]
    ds_read_b64_tr_b16 v[88:89], v120 offset:28672
    ds_read_b64_tr_b16 v[90:91], v120 offset:29184
    s_add_u32 m0, s43, 16384
    s_add_u32 s55, s41, 1572864
    buffer_load_dwordx4 v106, s[56:59], s55 offen lds
    buffer_load_dwordx4 v[128:131], v117, s[24:27], s53 offen offset:0 sc1
    s_waitcnt lgkmcnt(8)
    v_mfma_f32_32x32x16_bf16 v[48:63], v[136:139], v[96:99], v[48:63]
    ds_read_b64_tr_b16 v[92:93], v120 offset:40960
    ds_read_b64_tr_b16 v[94:95], v120 offset:41472
    v_cvt_pk_bf16_f32 v64, v64, v65
    v_cvt_pk_bf16_f32 v65, v66, v67
    v_cvt_pk_bf16_f32 v66, v68, v69
    v_cvt_pk_bf16_f32 v67, v70, v71
    s_add_u32 m0, s43, 17280
    s_nop 0
    buffer_load_dwordx4 v106, s[56:59], s55 offen offset:128 lds
    buffer_load_dwordx4 v[132:135], v117, s[24:27], s53 offen offset:1024 sc1
    s_waitcnt lgkmcnt(8)
    v_mfma_f32_32x32x16_bf16 v[48:63], v[140:143], v[100:103], v[48:63]
    ds_read_b64_tr_b16 v[96:97], v119 offset:6144
    ds_read_b64_tr_b16 v[98:99], v119 offset:6656
    v_cvt_pk_bf16_f32 v68, v72, v73
    v_cvt_pk_bf16_f32 v69, v74, v75
    v_cvt_pk_bf16_f32 v70, v76, v77
    v_cvt_pk_bf16_f32 v71, v78, v79
    buffer_load_dwordx4 v[136:139], v117, s[24:27], s53 offen offset:2048 sc1
    s_waitcnt lgkmcnt(8)
    v_mfma_f32_32x32x16_bf16 v[48:63], v[144:147], v[80:83], v[48:63]
    ds_read_b64_tr_b16 v[100:101], v119 offset:18432
    ds_read_b64_tr_b16 v[102:103], v119 offset:18944
    buffer_load_dwordx4 v[140:143], v117, s[24:27], s53 offen offset:3072 sc1
    s_add_u32 s53, s53, 4096
    s_waitcnt lgkmcnt(8)
    v_mfma_f32_32x32x16_bf16 v[48:63], v[148:151], v[84:87], v[48:63]
    ds_read_b64_tr_b16 v[80:81], v119 offset:30720
    ds_read_b64_tr_b16 v[82:83], v119 offset:31232
    s_waitcnt lgkmcnt(8)
    v_mfma_f32_32x32x16_bf16 v[48:63], v[152:155], v[88:91], v[48:63]
    ds_read_b64_tr_b16 v[84:85], v119 offset:43008
    ds_read_b64_tr_b16 v[86:87], v119 offset:43520
    s_waitcnt lgkmcnt(8)
    v_mfma_f32_32x32x16_bf16 v[48:63], v[156:159], v[92:95], v[48:63]
    ds_read_b64_tr_b16 v[88:89], v120 offset:6144
    ds_read_b64_tr_b16 v[90:91], v120 offset:6656
    s_waitcnt lgkmcnt(8)
    v_mfma_f32_32x32x16_bf16 v[48:63], v[160:163], v[96:99], v[48:63]
    ds_read_b64_tr_b16 v[92:93], v120 offset:18432
    ds_read_b64_tr_b16 v[94:95], v120 offset:18944
    s_add_u32 s48, s47, 4096
    buffer_store_dwordx4 v[8:11], v117, s[24:27], s48 offen offset:0 sc1
    s_waitcnt lgkmcnt(8)
    v_mfma_f32_32x32x16_bf16 v[48:63], v[164:167], v[100:103], v[48:63]
    ds_read_b64_tr_b16 v[96:97], v120 offset:30720
    ds_read_b64_tr_b16 v[98:99], v120 offset:31232
    s_waitcnt lgkmcnt(8)
    v_mfma_f32_32x32x16_bf16 v[48:63], v[168:171], v[80:83], v[48:63]
    ds_read_b64_tr_b16 v[100:101], v120 offset:43008
    ds_read_b64_tr_b16 v[102:103], v120 offset:43520
    s_waitcnt lgkmcnt(8)
    v_mfma_f32_32x32x16_bf16 v[48:63], v[172:175], v[84:87], v[48:63]
    ds_read_b64_tr_b16 v[80:81], v119 offset:8192
    ds_read_b64_tr_b16 v[82:83], v119 offset:8704
    s_waitcnt lgkmcnt(8)
    v_mfma_f32_32x32x16_bf16 v[48:63], v[176:179], v[88:91], v[48:63]
    ds_read_b64_tr_b16 v[84:85], v119 offset:20480
    ds_read_b64_tr_b16 v[86:87], v119 offset:20992
    s_waitcnt lgkmcnt(8)
    v_mfma_f32_32x32x16_bf16 v[48:63], v[180:183], v[92:95], v[48:63]
    ds_read_b64_tr_b16 v[88:89], v119 offset:32768
    ds_read_b64_tr_b16 v[90:91], v119 offset:33280
    s_waitcnt lgkmcnt(8)
    v_mfma_f32_32x32x16_bf16 v[48:63], v[184:187], v[96:99], v[48:63]
    ds_read_b64_tr_b16 v[92:93], v119 offset:45056
    ds_read_b64_tr_b16 v[94:95], v119 offset:45568
    s_waitcnt lgkmcnt(8)
    v_mfma_f32_32x32x16_bf16 v[48:63], v[188:191], v[100:103], v[48:63]
    ds_read_b64_tr_b16 v[96:97], v120 offset:8192
    ds_read_b64_tr_b16 v[98:99], v120 offset:8704
    s_waitcnt lgkmcnt(8)
    v_mfma_f32_32x32x16_bf16 v[48:63], v[192:195], v[80:83], v[48:63]
    ds_read_b64_tr_b16 v[100:101], v120 offset:20480
    ds_read_b64_tr_b16 v[102:103], v120 offset:20992
    s_waitcnt lgkmcnt(8)
    v_mfma_f32_32x32x16_bf16 v[48:63], v[196:199], v[84:87], v[48:63]
    ds_read_b64_tr_b16 v[80:81], v120 offset:32768
    ds_read_b64_tr_b16 v[82:83], v120 offset:33280
    s_waitcnt lgkmcnt(8)
    v_mfma_f32_32x32x16_bf16 v[48:63], v[200:203], v[88:91], v[48:63]
    ds_read_b64_tr_b16 v[84:85], v120 offset:45056
    ds_read_b64_tr_b16 v[86:87], v120 offset:45568
    s_add_u32 s48, s47, 4096
    buffer_store_dwordx4 v[12:15], v117, s[24:27], s48 offen offset:1024 sc1
    s_waitcnt lgkmcnt(8)
    v_mfma_f32_32x32x16_bf16 v[48:63], v[204:207], v[92:95], v[48:63]
    ds_read_b64_tr_b16 v[88:89], v119 offset:10240
    ds_read_b64_tr_b16 v[90:91], v119 offset:10752
    s_waitcnt lgkmcnt(8)
    v_mfma_f32_32x32x16_bf16 v[48:63], v[208:211], v[96:99], v[48:63]
    ds_read_b64_tr_b16 v[92:93], v119 offset:22528
    ds_read_b64_tr_b16 v[94:95], v119 offset:23040
    s_waitcnt lgkmcnt(8)
    v_mfma_f32_32x32x16_bf16 v[48:63], v[212:215], v[100:103], v[48:63]
    ds_read_b64_tr_b16 v[96:97], v119 offset:34816
    ds_read_b64_tr_b16 v[98:99], v119 offset:35328
    s_waitcnt lgkmcnt(8)
    v_mfma_f32_32x32x16_bf16 v[48:63], v[216:219], v[80:83], v[48:63]
    ds_read_b64_tr_b16 v[100:101], v119 offset:47104
    ds_read_b64_tr_b16 v[102:103], v119 offset:47616
    s_waitcnt lgkmcnt(8)
    v_mfma_f32_32x32x16_bf16 v[48:63], v[220:223], v[84:87], v[48:63]
    ds_read_b64_tr_b16 v[80:81], v120 offset:10240
    ds_read_b64_tr_b16 v[82:83], v120 offset:10752
    s_waitcnt lgkmcnt(8)
    v_mfma_f32_32x32x16_bf16 v[48:63], v[224:227], v[88:91], v[48:63]
    ds_read_b64_tr_b16 v[84:85], v120 offset:22528
    ds_read_b64_tr_b16 v[86:87], v120 offset:23040
    s_waitcnt lgkmcnt(8)
    v_mfma_f32_32x32x16_bf16 v[48:63], v[228:231], v[92:95], v[48:63]
    ds_read_b64_tr_b16 v[88:89], v120 offset:34816
    ds_read_b64_tr_b16 v[90:91], v120 offset:35328
    buffer_load_dwordx4 v[144:147], v117, s[24:27], s53 offen offset:0 sc1
    s_waitcnt lgkmcnt(8)
    v_mfma_f32_32x32x16_bf16 v[48:63], v[232:235], v[96:99], v[48:63]
    ds_read_b64_tr_b16 v[92:93], v120 offset:47104
    ds_read_b64_tr_b16 v[94:95], v120 offset:47616
    buffer_load_dwordx4 v[148:151], v117, s[24:27], s53 offen offset:1024 sc1
    s_waitcnt lgkmcnt(8)
    v_mfma_f32_32x32x16_bf16 v[48:63], v[236:239], v[100:103], v[48:63]
    ds_read_b64_tr_b16 v[96:97], v108 offset:32768
    ds_read_b64_tr_b16 v[98:99], v108 offset:33280
    buffer_load_dwordx4 v[152:155], v117, s[24:27], s53 offen offset:2048 sc1
    s_waitcnt lgkmcnt(8)
    v_mfma_f32_32x32x16_bf16 v[48:63], v[240:243], v[80:83], v[48:63]
    ds_read_b64_tr_b16 v[100:101], v109 offset:32768
    ds_read_b64_tr_b16 v[102:103], v109 offset:33280
    s_add_u32 s48, s47, 8192
    buffer_store_dwordx4 v[64:67], v117, s[24:27], s48 offen offset:0 sc1
    buffer_load_dwordx4 v[156:159], v117, s[24:27], s53 offen offset:3072 sc1
    s_add_u32 s53, s53, 4096
    s_waitcnt lgkmcnt(8)
    v_mfma_f32_32x32x16_bf16 v[48:63], v[244:247], v[84:87], v[48:63]
    ds_read_b64_tr_b16 v[80:81], v108 offset:33792
    ds_read_b64_tr_b16 v[82:83], v108 offset:34304
    s_waitcnt lgkmcnt(8)
    v_mfma_f32_32x32x16_bf16 v[48:63], v[248:251], v[88:91], v[48:63]
    ds_read_b64_tr_b16 v[84:85], v109 offset:33792
    ds_read_b64_tr_b16 v[86:87], v109 offset:34304
    s_waitcnt lgkmcnt(8)
    v_mfma_f32_32x32x16_bf16 v[48:63], v[252:255], v[92:95], v[48:63]
    ds_read_b64_tr_b16 v[88:89], v108 offset:36864
    ds_read_b64_tr_b16 v[90:91], v108 offset:37376
    s_waitcnt vmcnt(7)
    s_waitcnt lgkmcnt(8)
    v_mfma_f32_32x32x16_bf16 v[0:15], v[96:99], v[128:131], 0
    ds_read_b64_tr_b16 v[92:93], v109 offset:36864
    ds_read_b64_tr_b16 v[94:95], v109 offset:37376
    s_waitcnt lgkmcnt(8)
    v_mfma_f32_32x32x16_bf16 v[16:31], v[100:103], v[128:131], 0
    ds_read_b64_tr_b16 v[96:97], v108 offset:37888
    ds_read_b64_tr_b16 v[98:99], v108 offset:38400
    s_nop 0
    v_cvt_pk_bf16_f32 v72, v48, v49
    v_cvt_pk_bf16_f32 v73, v50, v51
    v_cvt_pk_bf16_f32 v74, v52, v53
    v_cvt_pk_bf16_f32 v75, v54, v55
    s_waitcnt lgkmcnt(8)
    v_mfma_f32_32x32x16_bf16 v[32:47], v[80:83], v[128:131], 0
    ds_read_b64_tr_b16 v[100:101], v109 offset:37888
    ds_read_b64_tr_b16 v[102:103], v109 offset:38400
    v_cvt_pk_bf16_f32 v76, v56, v57
    v_cvt_pk_bf16_f32 v77, v58, v59
    v_cvt_pk_bf16_f32 v78, v60, v61
    v_cvt_pk_bf16_f32 v79, v62, v63
    s_waitcnt lgkmcnt(8)
    v_mfma_f32_32x32x16_bf16 v[48:63], v[84:87], v[128:131], 0
    ds_read_b64_tr_b16 v[80:81], v108 offset:40960
    ds_read_b64_tr_b16 v[82:83], v108 offset:41472
    s_waitcnt lgkmcnt(8)
    v_mfma_f32_32x32x16_bf16 v[0:15], v[88:91], v[132:135], v[0:15]
    ds_read_b64_tr_b16 v[84:85], v109 offset:40960
    ds_read_b64_tr_b16 v[86:87], v109 offset:41472
    s_waitcnt lgkmcnt(8)
    v_mfma_f32_32x32x16_bf16 v[16:31], v[92:95], v[132:135], v[16:31]
    ds_read_b64_tr_b16 v[88:89], v108 offset:41984
    ds_read_b64_tr_b16 v[90:91], v108 offset:42496
    s_waitcnt lgkmcnt(8)
    v_mfma_f32_32x32x16_bf16 v[32:47], v[96:99], v[132:135], v[32:47]
    ds_read_b64_tr_b16 v[92:93], v109 offset:41984
    ds_read_b64_tr_b16 v[94:95], v109 offset:42496
    s_add_u32 s48, s47, 8192
    buffer_store_dwordx4 v[68:71], v117, s[24:27], s48 offen offset:1024 sc1
    s_barrier
    s_waitcnt lgkmcnt(8)
    v_mfma_f32_32x32x16_bf16 v[48:63], v[100:103], v[132:135], v[48:63]
    ds_read_b64_tr_b16 v[96:97], v108 offset:45056
    ds_read_b64_tr_b16 v[98:99], v108 offset:45568
    s_waitcnt lgkmcnt(8)
    v_mfma_f32_32x32x16_bf16 v[0:15], v[80:83], v[136:139], v[0:15]
    ds_read_b64_tr_b16 v[100:101], v109 offset:45056
    ds_read_b64_tr_b16 v[102:103], v109 offset:45568
    s_waitcnt lgkmcnt(8)
    v_mfma_f32_32x32x16_bf16 v[16:31], v[84:87], v[136:139], v[16:31]
    ds_read_b64_tr_b16 v[80:81], v108 offset:46080
    ds_read_b64_tr_b16 v[82:83], v108 offset:46592
    buffer_load_dwordx4 v[160:163], v117, s[24:27], s53 offen offset:0 sc1
    s_waitcnt lgkmcnt(8)
    v_mfma_f32_32x32x16_bf16 v[32:47], v[88:91], v[136:139], v[32:47]
    ds_read_b64_tr_b16 v[84:85], v109 offset:46080
    ds_read_b64_tr_b16 v[86:87], v109 offset:46592
    buffer_load_dwordx4 v[164:167], v117, s[24:27], s53 offen offset:1024 sc1
    s_waitcnt lgkmcnt(8)
    v_mfma_f32_32x32x16_bf16 v[48:63], v[92:95], v[136:139], v[48:63]
    ds_read_b64_tr_b16 v[88:89], v108 offset:49152
    ds_read_b64_tr_b16 v[90:91], v108 offset:49664
    buffer_load_dwordx4 v[168:171], v117, s[24:27], s53 offen offset:2048 sc1
    s_waitcnt lgkmcnt(8)
    v_mfma_f32_32x32x16_bf16 v[0:15], v[96:99], v[140:143], v[0:15]
    ds_read_b64_tr_b16 v[92:93], v109 offset:49152
    ds_read_b64_tr_b16 v[94:95], v109 offset:49664
    buffer_load_dwordx4 v[172:175], v117, s[24:27], s53 offen offset:3072 sc1
    s_add_u32 s53, s53, 4096
    s_waitcnt lgkmcnt(8)
    v_mfma_f32_32x32x16_bf16 v[16:31], v[100:103], v[140:143], v[16:31]
    ds_read_b64_tr_b16 v[96:97], v108 offset:50176
    ds_read_b64_tr_b16 v[98:99], v108 offset:50688
    s_waitcnt lgkmcnt(8)
    v_mfma_f32_32x32x16_bf16 v[32:47], v[80:83], v[140:143], v[32:47]
    ds_read_b64_tr_b16 v[100:101], v109 offset:50176
    ds_read_b64_tr_b16 v[102:103], v109 offset:50688
    s_waitcnt lgkmcnt(8)
    v_mfma_f32_32x32x16_bf16 v[48:63], v[84:87], v[140:143], v[48:63]
    ds_read_b64_tr_b16 v[80:81], v108 offset:53248
    ds_read_b64_tr_b16 v[82:83], v108 offset:53760
    s_waitcnt vmcnt(5)
    s_waitcnt lgkmcnt(8)
    v_mfma_f32_32x32x16_bf16 v[0:15], v[88:91], v[144:147], v[0:15]
    ds_read_b64_tr_b16 v[84:85], v109 offset:53248
    ds_read_b64_tr_b16 v[86:87], v109 offset:53760
    s_add_u32 s48, s47, 12288
    buffer_store_dwordx4 v[72:75], v117, s[24:27], s48 offen offset:0 sc1
    s_waitcnt lgkmcnt(8)
    v_mfma_f32_32x32x16_bf16 v[16:31], v[92:95], v[144:147], v[16:31]
    ds_read_b64_tr_b16 v[88:89], v108 offset:54272
    ds_read_b64_tr_b16 v[90:91], v108 offset:54784
    s_waitcnt lgkmcnt(8)
    v_mfma_f32_32x32x16_bf16 v[32:47], v[96:99], v[144:147], v[32:47]
    ds_read_b64_tr_b16 v[92:93], v109 offset:54272
    ds_read_b64_tr_b16 v[94:95], v109 offset:54784
    s_waitcnt lgkmcnt(8)
    v_mfma_f32_32x32x16_bf16 v[48:63], v[100:103], v[144:147], v[48:63]
    ds_read_b64_tr_b16 v[96:97], v108 offset:57344
    ds_read_b64_tr_b16 v[98:99], v108 offset:57856
    s_waitcnt lgkmcnt(8)
    v_mfma_f32_32x32x16_bf16 v[0:15], v[80:83], v[148:151], v[0:15]
    ds_read_b64_tr_b16 v[100:101], v109 offset:57344
    ds_read_b64_tr_b16 v[102:103], v109 offset:57856
    s_waitcnt lgkmcnt(8)
    v_mfma_f32_32x32x16_bf16 v[16:31], v[84:87], v[148:151], v[16:31]
    ds_read_b64_tr_b16 v[80:81], v108 offset:58368
    ds_read_b64_tr_b16 v[82:83], v108 offset:58880
    s_waitcnt lgkmcnt(8)
    v_mfma_f32_32x32x16_bf16 v[32:47], v[88:91], v[148:151], v[32:47]
    ds_read_b64_tr_b16 v[84:85], v109 offset:58368
    ds_read_b64_tr_b16 v[86:87], v109 offset:58880
    s_barrier
    s_waitcnt lgkmcnt(8)
    v_mfma_f32_32x32x16_bf16 v[48:63], v[92:95], v[148:151], v[48:63]
    ds_read_b64_tr_b16 v[88:89], v108 offset:61440
    ds_read_b64_tr_b16 v[90:91], v108 offset:61952
    s_add_u32 m0, s43, 32768
    s_add_u32 s55, s41, 2097152
    buffer_load_dwordx4 v106, s[56:59], s55 offen lds
    s_waitcnt lgkmcnt(8)
    v_mfma_f32_32x32x16_bf16 v[0:15], v[96:99], v[152:155], v[0:15]
    ds_read_b64_tr_b16 v[92:93], v109 offset:61440
    ds_read_b64_tr_b16 v[94:95], v109 offset:61952
    s_add_u32 m0, s43, 33664
    s_nop 0
    buffer_load_dwordx4 v106, s[56:59], s55 offen offset:128 lds
    s_cmp_lg_u32 s3, 0
    s_cbranch_scc1 k1f_kernel_k1p
    s_and_b32 s6, s2, 31
    s_lshl_b32 s6, s6, 7
    s_add_u32 s6, s6, 0x3b88000
    v_and_b32 v125, 7, v118
    v_lshlrev_b32 v125, 12, v125
    buffer_load_dwordx2 v[110:111], v125, s[24:27], s6 offen sc1
k1f_kernel_k1p:
    s_waitcnt lgkmcnt(8)
    v_mfma_f32_32x32x16_bf16 v[16:31], v[100:103], v[152:155], v[16:31]
    ds_read_b64_tr_b16 v[96:97], v108 offset:62464
    ds_read_b64_tr_b16 v[98:99], v108 offset:62976
    buffer_load_dwordx4 v[176:179], v117, s[24:27], s53 offen offset:0 sc1
    s_waitcnt lgkmcnt(8)
    v_mfma_f32_32x32x16_bf16 v[32:47], v[80:83], v[152:155], v[32:47]
    ds_read_b64_tr_b16 v[100:101], v109 offset:62464
    ds_read_b64_tr_b16 v[102:103], v109 offset:62976
    s_add_u32 s48, s47, 12288
    buffer_store_dwordx4 v[76:79], v117, s[24:27], s48 offen offset:1024 sc1
    buffer_load_dwordx4 v[180:183], v117, s[24:27], s53 offen offset:1024 sc1
    s_waitcnt lgkmcnt(8)
    v_mfma_f32_32x32x16_bf16 v[48:63], v[84:87], v[152:155], v[48:63]
    ds_read_b64_tr_b16 v[80:81], v108 offset:0
    ds_read_b64_tr_b16 v[82:83], v108 offset:512
    buffer_load_dwordx4 v[184:187], v117, s[24:27], s53 offen offset:2048 sc1
    s_waitcnt lgkmcnt(8)
    v_mfma_f32_32x32x16_bf16 v[0:15], v[88:91], v[156:159], v[0:15]
    ds_read_b64_tr_b16 v[84:85], v109 offset:0
    ds_read_b64_tr_b16 v[86:87], v109 offset:512
    buffer_load_dwordx4 v[188:191], v117, s[24:27], s53 offen offset:3072 sc1
    s_add_u32 s53, s53, 4096
    s_waitcnt lgkmcnt(8)
    v_mfma_f32_32x32x16_bf16 v[16:31], v[92:95], v[156:159], v[16:31]
    ds_read_b64_tr_b16 v[88:89], v108 offset:1024
    ds_read_b64_tr_b16 v[90:91], v108 offset:1536
    s_waitcnt lgkmcnt(8)
    v_mfma_f32_32x32x16_bf16 v[32:47], v[96:99], v[156:159], v[32:47]
    ds_read_b64_tr_b16 v[92:93], v109 offset:1024
    ds_read_b64_tr_b16 v[94:95], v109 offset:1536
    s_waitcnt lgkmcnt(8)
    v_mfma_f32_32x32x16_bf16 v[48:63], v[100:103], v[156:159], v[48:63]
    ds_read_b64_tr_b16 v[96:97], v108 offset:4096
    ds_read_b64_tr_b16 v[98:99], v108 offset:4608
    s_waitcnt vmcnt(8)
    s_waitcnt lgkmcnt(8)
    v_mfma_f32_32x32x16_bf16 v[0:15], v[80:83], v[160:163], v[0:15]
    ds_read_b64_tr_b16 v[100:101], v109 offset:4096
    ds_read_b64_tr_b16 v[102:103], v109 offset:4608
    s_waitcnt lgkmcnt(8)
    v_mfma_f32_32x32x16_bf16 v[16:31], v[84:87], v[160:163], v[16:31]
    ds_read_b64_tr_b16 v[80:81], v108 offset:5120
    ds_read_b64_tr_b16 v[82:83], v108 offset:5632
    s_waitcnt lgkmcnt(8)
    v_mfma_f32_32x32x16_bf16 v[32:47], v[88:91], v[160:163], v[32:47]
    ds_read_b64_tr_b16 v[84:85], v109 offset:5120
    ds_read_b64_tr_b16 v[86:87], v109 offset:5632
    s_waitcnt lgkmcnt(8)
    v_mfma_f32_32x32x16_bf16 v[48:63], v[92:95], v[160:163], v[48:63]
    ds_read_b64_tr_b16 v[88:89], v108 offset:8192
    ds_read_b64_tr_b16 v[90:91], v108 offset:8704
    s_waitcnt lgkmcnt(8)
    v_mfma_f32_32x32x16_bf16 v[0:15], v[96:99], v[164:167], v[0:15]
    ds_read_b64_tr_b16 v[92:93], v109 offset:8192
    ds_read_b64_tr_b16 v[94:95], v109 offset:8704
    s_waitcnt lgkmcnt(8)
    v_mfma_f32_32x32x16_bf16 v[16:31], v[100:103], v[164:167], v[16:31]
    ds_read_b64_tr_b16 v[96:97], v108 offset:9216
    ds_read_b64_tr_b16 v[98:99], v108 offset:9728
    s_waitcnt lgkmcnt(8)
    v_mfma_f32_32x32x16_bf16 v[32:47], v[80:83], v[164:167], v[32:47]
    ds_read_b64_tr_b16 v[100:101], v109 offset:9216
    ds_read_b64_tr_b16 v[102:103], v109 offset:9728
    s_cmp_lg_u32 s3, 0
    s_cbranch_scc1 k1f_kernel_k1c
    s_waitcnt vmcnt(5)
    v_cmp_eq_u64 vcc, s[64:65], v[110:111]
    s_and_b32 s7, vcc_lo, 3
    s_cmp_eq_u32 s7, 3
    s_cbranch_scc0 k1f_kernel_k1s
k1f_kernel_k1c:
    s_barrier
    s_waitcnt lgkmcnt(8)
    v_mfma_f32_32x32x16_bf16 v[48:63], v[84:87], v[164:167], v[48:63]
    ds_read_b64_tr_b16 v[80:81], v108 offset:12288
    ds_read_b64_tr_b16 v[82:83], v108 offset:12800
    s_add_u32 m0, s43, 49152
    s_add_u32 s55, s41, 2621440
    buffer_load_dwordx4 v106, s[56:59], s55 offen lds
    s_waitcnt lgkmcnt(8)
    v_mfma_f32_32x32x16_bf16 v[0:15], v[88:91], v[168:171], v[0:15]
    ds_read_b64_tr_b16 v[84:85], v109 offset:12288
    ds_read_b64_tr_b16 v[86:87], v109 offset:12800
    s_add_u32 m0, s43, 50048
    s_nop 0
    buffer_load_dwordx4 v106, s[56:59], s55 offen offset:128 lds
    s_waitcnt lgkmcnt(8)
    v_mfma_f32_32x32x16_bf16 v[16:31], v[92:95], v[168:171], v[16:31]
    ds_read_b64_tr_b16 v[88:89], v108 offset:13312
    ds_read_b64_tr_b16 v[90:91], v108 offset:13824
    buffer_load_dwordx4 v[192:195], v117, s[24:27], s53 offen offset:0 sc1
    s_add_u32 m0, s43, 131072
    s_add_u32 s55, s43, 0
    buffer_load_dwordx4 v117, s[72:75], s55 offen sc1 lds
    s_waitcnt lgkmcnt(8)
    v_mfma_f32_32x32x16_bf16 v[32:47], v[96:99], v[168:171], v[32:47]
    ds_read_b64_tr_b16 v[92:93], v109 offset:13312
    ds_read_b64_tr_b16 v[94:95], v109 offset:13824
    buffer_load_dwordx4 v[196:199], v117, s[24:27], s53 offen offset:1024 sc1
    buffer_load_dwordx4 v117, s[72:75], s55 offen offset:1024 sc1 lds
    s_waitcnt lgkmcnt(8)
    v_mfma_f32_32x32x16_bf16 v[48:63], v[100:103], v[168:171], v[48:63]
    ds_read_b64_tr_b16 v[96:97], v108 offset:16384
    ds_read_b64_tr_b16 v[98:99], v108 offset:16896
    buffer_load_dwordx4 v[200:203], v117, s[24:27], s53 offen offset:2048 sc1
    s_add_u32 m0, s43, 98304
    s_add_u32 s55, s43, 32768
    buffer_load_dwordx4 v117, s[72:75], s55 offen sc1 lds
    s_waitcnt lgkmcnt(8)
    v_mfma_f32_32x32x16_bf16 v[0:15], v[80:83], v[172:175], v[0:15]
    ds_read_b64_tr_b16 v[100:101], v109 offset:16384
    ds_read_b64_tr_b16 v[102:103], v109 offset:16896
    s_sub_u32 s8, s2, 128
    s_min_u32 s8, s8, 119
    s_lshl_b32 s8, s8, 2
    s_and_b32 s9, s3, 3
    s_add_u32 s8, s8, s9
    buffer_load_dwordx4 v[204:207], v117, s[24:27], s53 offen offset:3072 sc1
    s_add_u32 s53, s53, 4096
    buffer_load_dwordx4 v117, s[72:75], s55 offen offset:1024 sc1 lds
    s_waitcnt lgkmcnt(8)
    v_mfma_f32_32x32x16_bf16 v[16:31], v[84:87], v[172:175], v[16:31]
    ds_read_b64_tr_b16 v[80:81], v108 offset:17408
    ds_read_b64_tr_b16 v[82:83], v108 offset:17920
    s_lshr_b32 s9, s8, 1
    s_and_b32 s10, s8, 1
    s_mov_b64 s[16:17], s[66:67]
    s_mov_b32 s11, 1024
    s_add_u32 m0, s43, 65536
    s_add_u32 s55, s43, 65536
    buffer_load_dwordx4 v117, s[72:75], s55 offen sc1 lds
    s_waitcnt lgkmcnt(8)
    v_mfma_f32_32x32x16_bf16 v[32:47], v[88:91], v[172:175], v[32:47]
    ds_read_b64_tr_b16 v[84:85], v109 offset:17408
    ds_read_b64_tr_b16 v[86:87], v109 offset:17920
    s_cmp_ge_u32 s8, 256
    s_cselect_b64 s[16:17], s[70:71], s[16:17]
    s_cselect_b32 s18, 128, 0
    s_sub_u32 s9, s9, s18
    buffer_load_dwordx4 v117, s[72:75], s55 offen offset:1024 sc1 lds
    s_waitcnt lgkmcnt(8)
    v_mfma_f32_32x32x16_bf16 v[48:63], v[92:95], v[172:175], v[48:63]
    ds_read_b64_tr_b16 v[88:89], v108 offset:20480
    ds_read_b64_tr_b16 v[90:91], v108 offset:20992
    s_sub_u32 s18, s8, 368
    s_and_b32 s19, s18, 15
    s_lshr_b32 s18, s18, 4
    s_cmp_ge_u32 s8, 368
    s_cselect_b64 s[16:17], s[68:69], s[16:17]
    s_cselect_b32 s11, 3584, s11
    s_cselect_b32 s9, s19, s9
    s_cselect_b32 s10, s18, s10
    s_waitcnt vmcnt(12)
    s_waitcnt lgkmcnt(8)
    v_mfma_f32_32x32x16_bf16 v[0:15], v[96:99], v[176:179], v[0:15]
    ds_read_b64_tr_b16 v[92:93], v109 offset:20480
    ds_read_b64_tr_b16 v[94:95], v109 offset:20992
    s_lshl_b32 s9, s9, 1
    s_lshr_b32 s8, s3, 2
    s_add_u32 s9, s9, s8
    s_lshl_b32 s9, s9, 4
    s_lshl_b32 s10, s10, 9
    s_waitcnt lgkmcnt(8)
    v_mfma_f32_32x32x16_bf16 v[16:31], v[100:103], v[176:179], v[16:31]
    ds_read_b64_tr_b16 v[96:97], v108 offset:21504
    ds_read_b64_tr_b16 v[98:99], v108 offset:22016
    s_mul_i32 s9, s9, s11
    s_add_u32 s10, s10, s9
    s_lshr_b32 s11, s11, 2
    s_sub_u32 s9, 128, s11
    v_and_b32 v123, 3, v118
    v_mul_lo_u32 v123, v123, s9
    s_waitcnt lgkmcnt(8)
    v_mfma_f32_32x32x16_bf16 v[32:47], v[80:83], v[176:179], v[32:47]
    ds_read_b64_tr_b16 v[100:101], v109 offset:21504
    ds_read_b64_tr_b16 v[102:103], v109 offset:22016
    v_mad_u32_u24 v123, v118, s11, v123
    v_add_u32 v123, s10, v123
    s_waitcnt lgkmcnt(8)
    v_mfma_f32_32x32x16_bf16 v[48:63], v[84:87], v[176:179], v[48:63]
    ds_read_b64_tr_b16 v[80:81], v108 offset:24576
    ds_read_b64_tr_b16 v[82:83], v108 offset:25088
    s_waitcnt lgkmcnt(8)
    v_mfma_f32_32x32x16_bf16 v[0:15], v[88:91], v[180:183], v[0:15]
    ds_read_b64_tr_b16 v[84:85], v109 offset:24576
    ds_read_b64_tr_b16 v[86:87], v109 offset:25088
    s_waitcnt lgkmcnt(8)
    v_mfma_f32_32x32x16_bf16 v[16:31], v[92:95], v[180:183], v[16:31]
    ds_read_b64_tr_b16 v[88:89], v108 offset:25600
    ds_read_b64_tr_b16 v[90:91], v108 offset:26112
    s_waitcnt lgkmcnt(8)
    v_mfma_f32_32x32x16_bf16 v[32:47], v[96:99], v[180:183], v[32:47]
    ds_read_b64_tr_b16 v[92:93], v109 offset:25600
    ds_read_b64_tr_b16 v[94:95], v109 offset:26112
    s_barrier
    s_cmp_lg_u32 s3, 0
    s_cbranch_scc1 k1f_kernel_vp
    s_lshl_b32 s6, s2, 7
    s_add_u32 s6, s6, 0x3b90000
    v_bfe_u32 v125, v117, 1, 7
    v_mov_b32 v126, s64
    v_mov_b32 v127, s65
    buffer_store_dwordx2 v[126:127], v125, s[24:27], s6 offen sc1
k1f_kernel_vp:
    s_waitcnt lgkmcnt(8)
    v_mfma_f32_32x32x16_bf16 v[48:63], v[100:103], v[180:183], v[48:63]
    ds_read_b64_tr_b16 v[96:97], v108 offset:28672
    ds_read_b64_tr_b16 v[98:99], v108 offset:29184
    s_add_u32 m0, s43, 0
    s_add_u32 s55, s41, 3145728
    buffer_load_dwordx4 v106, s[56:59], s55 offen lds
    s_waitcnt lgkmcnt(8)
    v_mfma_f32_32x32x16_bf16 v[0:15], v[80:83], v[184:187], v[0:15]
    ds_read_b64_tr_b16 v[100:101], v109 offset:28672
    ds_read_b64_tr_b16 v[102:103], v109 offset:29184
    s_add_u32 m0, s43, 896
    s_nop 0
    buffer_load_dwordx4 v106, s[56:59], s55 offen offset:128 lds
    s_waitcnt lgkmcnt(8)
    v_mfma_f32_32x32x16_bf16 v[16:31], v[84:87], v[184:187], v[16:31]
    ds_read_b64_tr_b16 v[80:81], v108 offset:29696
    ds_read_b64_tr_b16 v[82:83], v108 offset:30208
    buffer_load_dwordx4 v[208:211], v117, s[24:27], s53 offen offset:0 sc1
    s_waitcnt lgkmcnt(8)
    v_mfma_f32_32x32x16_bf16 v[32:47], v[88:91], v[184:187], v[32:47]
    ds_read_b64_tr_b16 v[84:85], v109 offset:29696
    ds_read_b64_tr_b16 v[86:87], v109 offset:30208
    buffer_load_dwordx4 v[212:215], v117, s[24:27], s53 offen offset:1024 sc1
    s_waitcnt lgkmcnt(8)
    v_mfma_f32_32x32x16_bf16 v[48:63], v[92:95], v[184:187], v[48:63]
    ds_read_b64_tr_b16 v[88:89], v108 offset:32768
    ds_read_b64_tr_b16 v[90:91], v108 offset:33280
    buffer_load_dwordx4 v[216:219], v117, s[24:27], s53 offen offset:2048 sc1
    s_waitcnt lgkmcnt(8)
    v_mfma_f32_32x32x16_bf16 v[0:15], v[96:99], v[188:191], v[0:15]
    ds_read_b64_tr_b16 v[92:93], v109 offset:32768
    ds_read_b64_tr_b16 v[94:95], v109 offset:33280
    buffer_load_dwordx4 v[220:223], v117, s[24:27], s53 offen offset:3072 sc1
    s_add_u32 s53, s53, 4096
    s_waitcnt lgkmcnt(8)
    v_mfma_f32_32x32x16_bf16 v[16:31], v[100:103], v[188:191], v[16:31]
    ds_read_b64_tr_b16 v[96:97], v108 offset:33792
    ds_read_b64_tr_b16 v[98:99], v108 offset:34304
    s_waitcnt lgkmcnt(8)
    v_mfma_f32_32x32x16_bf16 v[32:47], v[80:83], v[188:191], v[32:47]
    ds_read_b64_tr_b16 v[100:101], v109 offset:33792
    ds_read_b64_tr_b16 v[102:103], v109 offset:34304
    s_waitcnt lgkmcnt(8)
    v_mfma_f32_32x32x16_bf16 v[48:63], v[84:87], v[188:191], v[48:63]
    ds_read_b64_tr_b16 v[80:81], v108 offset:36864
    ds_read_b64_tr_b16 v[82:83], v108 offset:37376
    s_waitcnt vmcnt(9)
    s_waitcnt lgkmcnt(8)
    v_mfma_f32_32x32x16_bf16 v[0:15], v[88:91], v[192:195], v[0:15]
    ds_read_b64_tr_b16 v[84:85], v109 offset:36864
    ds_read_b64_tr_b16 v[86:87], v109 offset:37376
    s_waitcnt lgkmcnt(8)
    v_mfma_f32_32x32x16_bf16 v[16:31], v[92:95], v[192:195], v[16:31]
    ds_read_b64_tr_b16 v[88:89], v108 offset:37888
    ds_read_b64_tr_b16 v[90:91], v108 offset:38400
    s_waitcnt lgkmcnt(8)
    v_mfma_f32_32x32x16_bf16 v[32:47], v[96:99], v[192:195], v[32:47]
    ds_read_b64_tr_b16 v[92:93], v109 offset:37888
    ds_read_b64_tr_b16 v[94:95], v109 offset:38400
    s_waitcnt lgkmcnt(8)
    v_mfma_f32_32x32x16_bf16 v[48:63], v[100:103], v[192:195], v[48:63]
    ds_read_b64_tr_b16 v[96:97], v108 offset:40960
    ds_read_b64_tr_b16 v[98:99], v108 offset:41472
    s_waitcnt lgkmcnt(8)
    v_mfma_f32_32x32x16_bf16 v[0:15], v[80:83], v[196:199], v[0:15]
    ds_read_b64_tr_b16 v[100:101], v109 offset:40960
    ds_read_b64_tr_b16 v[102:103], v109 offset:41472
    s_waitcnt lgkmcnt(8)
    v_mfma_f32_32x32x16_bf16 v[16:31], v[84:87], v[196:199], v[16:31]
    ds_read_b64_tr_b16 v[80:81], v108 offset:41984
    ds_read_b64_tr_b16 v[82:83], v108 offset:42496
    s_waitcnt lgkmcnt(8)
    v_mfma_f32_32x32x16_bf16 v[32:47], v[88:91], v[196:199], v[32:47]
    ds_read_b64_tr_b16 v[84:85], v109 offset:41984
    ds_read_b64_tr_b16 v[86:87], v109 offset:42496
    s_barrier
    s_waitcnt lgkmcnt(8)
    v_mfma_f32_32x32x16_bf16 v[48:63], v[92:95], v[196:199], v[48:63]
    ds_read_b64_tr_b16 v[88:89], v108 offset:45056
    ds_read_b64_tr_b16 v[90:91], v108 offset:45568
    s_add_u32 m0, s43, 16384
    s_add_u32 s55, s41, 3670016
    buffer_load_dwordx4 v106, s[56:59], s55 offen lds
    s_waitcnt lgkmcnt(8)
    v_mfma_f32_32x32x16_bf16 v[0:15], v[96:99], v[200:203], v[0:15]
    ds_read_b64_tr_b16 v[92:93], v109 offset:45056
    ds_read_b64_tr_b16 v[94:95], v109 offset:45568
    s_add_u32 m0, s43, 17280
    s_nop 0
    buffer_load_dwordx4 v106, s[56:59], s55 offen offset:128 lds
    s_waitcnt lgkmcnt(8)
    v_mfma_f32_32x32x16_bf16 v[16:31], v[100:103], v[200:203], v[16:31]
    ds_read_b64_tr_b16 v[96:97], v108 offset:46080
    ds_read_b64_tr_b16 v[98:99], v108 offset:46592
    buffer_load_dwordx4 v[224:227], v117, s[24:27], s53 offen offset:0 sc1
    s_waitcnt lgkmcnt(8)
    v_mfma_f32_32x32x16_bf16 v[32:47], v[80:83], v[200:203], v[32:47]
    ds_read_b64_tr_b16 v[100:101], v109 offset:46080
    ds_read_b64_tr_b16 v[102:103], v109 offset:46592
    buffer_load_dwordx4 v[228:231], v117, s[24:27], s53 offen offset:1024 sc1
    s_waitcnt lgkmcnt(8)
    v_mfma_f32_32x32x16_bf16 v[48:63], v[84:87], v[200:203], v[48:63]
    ds_read_b64_tr_b16 v[80:81], v108 offset:49152
    ds_read_b64_tr_b16 v[82:83], v108 offset:49664
    buffer_load_dwordx4 v[232:235], v117, s[24:27], s53 offen offset:2048 sc1
    s_waitcnt lgkmcnt(8)
    v_mfma_f32_32x32x16_bf16 v[0:15], v[88:91], v[204:207], v[0:15]
    ds_read_b64_tr_b16 v[84:85], v109 offset:49152
    ds_read_b64_tr_b16 v[86:87], v109 offset:49664
    buffer_load_dwordx4 v[236:239], v117, s[24:27], s53 offen offset:3072 sc1
    s_add_u32 s53, s53, 4096
    s_waitcnt lgkmcnt(8)
    v_mfma_f32_32x32x16_bf16 v[16:31], v[92:95], v[204:207], v[16:31]
    ds_read_b64_tr_b16 v[88:89], v108 offset:50176
    ds_read_b64_tr_b16 v[90:91], v108 offset:50688
    s_waitcnt lgkmcnt(8)
    v_mfma_f32_32x32x16_bf16 v[32:47], v[96:99], v[204:207], v[32:47]
    ds_read_b64_tr_b16 v[92:93], v109 offset:50176
    ds_read_b64_tr_b16 v[94:95], v109 offset:50688
    s_waitcnt lgkmcnt(8)
    v_mfma_f32_32x32x16_bf16 v[48:63], v[100:103], v[204:207], v[48:63]
    ds_read_b64_tr_b16 v[96:97], v108 offset:53248
    ds_read_b64_tr_b16 v[98:99], v108 offset:53760
    s_waitcnt vmcnt(6)
    s_waitcnt lgkmcnt(8)
    v_mfma_f32_32x32x16_bf16 v[0:15], v[80:83], v[208:211], v[0:15]
    ds_read_b64_tr_b16 v[100:101], v109 offset:53248
    ds_read_b64_tr_b16 v[102:103], v109 offset:53760
    s_waitcnt lgkmcnt(8)
    v_mfma_f32_32x32x16_bf16 v[16:31], v[84:87], v[208:211], v[16:31]
    ds_read_b64_tr_b16 v[80:81], v108 offset:54272
    ds_read_b64_tr_b16 v[82:83], v108 offset:54784
    s_waitcnt lgkmcnt(8)
    v_mfma_f32_32x32x16_bf16 v[32:47], v[88:91], v[208:211], v[32:47]
    ds_read_b64_tr_b16 v[84:85], v109 offset:54272
    ds_read_b64_tr_b16 v[86:87], v109 offset:54784
    s_waitcnt lgkmcnt(8)
    v_mfma_f32_32x32x16_bf16 v[48:63], v[92:95], v[208:211], v[48:63]
    ds_read_b64_tr_b16 v[88:89], v108 offset:57344
    ds_read_b64_tr_b16 v[90:91], v108 offset:57856
    s_waitcnt lgkmcnt(8)
    v_mfma_f32_32x32x16_bf16 v[0:15], v[96:99], v[212:215], v[0:15]
    ds_read_b64_tr_b16 v[92:93], v109 offset:57344
    ds_read_b64_tr_b16 v[94:95], v109 offset:57856
    s_waitcnt lgkmcnt(8)
    v_mfma_f32_32x32x16_bf16 v[16:31], v[100:103], v[212:215], v[16:31]
    ds_read_b64_tr_b16 v[96:97], v108 offset:58368
    ds_read_b64_tr_b16 v[98:99], v108 offset:58880
    s_waitcnt lgkmcnt(8)
    v_mfma_f32_32x32x16_bf16 v[32:47], v[80:83], v[212:215], v[32:47]
    ds_read_b64_tr_b16 v[100:101], v109 offset:58368
    ds_read_b64_tr_b16 v[102:103], v109 offset:58880
    s_barrier
    s_waitcnt lgkmcnt(8)
    v_mfma_f32_32x32x16_bf16 v[48:63], v[84:87], v[212:215], v[48:63]
    ds_read_b64_tr_b16 v[80:81], v108 offset:61440
    ds_read_b64_tr_b16 v[82:83], v108 offset:61952
    s_add_u32 m0, s43, 32768
    s_add_u32 s55, s43, 98304
    buffer_load_dwordx4 v117, s[72:75], s55 offen sc1 lds
    s_waitcnt lgkmcnt(8)
    v_mfma_f32_32x32x16_bf16 v[0:15], v[88:91], v[216:219], v[0:15]
    ds_read_b64_tr_b16 v[84:85], v109 offset:61440
    ds_read_b64_tr_b16 v[86:87], v109 offset:61952
    buffer_load_dwordx4 v117, s[72:75], s55 offen offset:1024 sc1 lds
    s_cmp_lg_u32 s3, 0
    s_cbranch_scc1 k1f_kernel_k2p
    s_and_b32 s6, s2, 31
    s_lshl_b32 s6, s6, 7
    s_add_u32 s6, s6, 0x3b90000
    v_and_b32 v125, 7, v118
    v_lshlrev_b32 v125, 12, v125
    buffer_load_dwordx2 v[110:111], v125, s[24:27], s6 offen sc1
k1f_kernel_k2p:
    s_waitcnt lgkmcnt(8)
    v_mfma_f32_32x32x16_bf16 v[16:31], v[92:95], v[216:219], v[16:31]
    ds_read_b64_tr_b16 v[88:89], v108 offset:62464
    ds_read_b64_tr_b16 v[90:91], v108 offset:62976
    buffer_load_dwordx4 v[240:243], v117, s[24:27], s53 offen offset:0 sc1
    s_waitcnt lgkmcnt(8)
    v_mfma_f32_32x32x16_bf16 v[32:47], v[96:99], v[216:219], v[32:47]
    ds_read_b64_tr_b16 v[92:93], v109 offset:62464
    ds_read_b64_tr_b16 v[94:95], v109 offset:62976
    buffer_load_dwordx4 v[244:247], v117, s[24:27], s53 offen offset:1024 sc1
    s_waitcnt lgkmcnt(8)
    v_mfma_f32_32x32x16_bf16 v[48:63], v[100:103], v[216:219], v[48:63]
    ds_read_b64_tr_b16 v[96:97], v108 offset:0
    ds_read_b64_tr_b16 v[98:99], v108 offset:512
    buffer_load_dwordx4 v[248:251], v117, s[24:27], s53 offen offset:2048 sc1
    s_waitcnt lgkmcnt(8)
    v_mfma_f32_32x32x16_bf16 v[0:15], v[80:83], v[220:223], v[0:15]
    ds_read_b64_tr_b16 v[100:101], v109 offset:0
    ds_read_b64_tr_b16 v[102:103], v109 offset:512
    buffer_load_dwordx4 v[252:255], v117, s[24:27], s53 offen offset:3072 sc1
    s_add_u32 s53, s53, 4096
    s_waitcnt lgkmcnt(8)
    v_mfma_f32_32x32x16_bf16 v[16:31], v[84:87], v[220:223], v[16:31]
    ds_read_b64_tr_b16 v[80:81], v108 offset:1024
    ds_read_b64_tr_b16 v[82:83], v108 offset:1536
    s_waitcnt lgkmcnt(8)
    v_mfma_f32_32x32x16_bf16 v[32:47], v[88:91], v[220:223], v[32:47]
    ds_read_b64_tr_b16 v[84:85], v109 offset:1024
    ds_read_b64_tr_b16 v[86:87], v109 offset:1536
    s_waitcnt lgkmcnt(8)
    v_mfma_f32_32x32x16_bf16 v[48:63], v[92:95], v[220:223], v[48:63]
    ds_read_b64_tr_b16 v[88:89], v108 offset:4096
    ds_read_b64_tr_b16 v[90:91], v108 offset:4608
    s_waitcnt vmcnt(6)
    s_waitcnt lgkmcnt(8)
    v_mfma_f32_32x32x16_bf16 v[0:15], v[96:99], v[224:227], v[0:15]
    ds_read_b64_tr_b16 v[212:213], v109 offset:4096
    ds_read_b64_tr_b16 v[214:215], v109 offset:4608
    s_waitcnt lgkmcnt(8)
    v_mfma_f32_32x32x16_bf16 v[16:31], v[100:103], v[224:227], v[16:31]
    ds_read_b64_tr_b16 v[216:217], v108 offset:5120
    ds_read_b64_tr_b16 v[218:219], v108 offset:5632
    s_waitcnt lgkmcnt(8)
    v_mfma_f32_32x32x16_bf16 v[32:47], v[80:83], v[224:227], v[32:47]
    ds_read_b64_tr_b16 v[220:221], v109 offset:5120
    ds_read_b64_tr_b16 v[222:223], v109 offset:5632
    s_waitcnt lgkmcnt(8)
    v_mfma_f32_32x32x16_bf16 v[48:63], v[84:87], v[224:227], v[48:63]
    ds_read_b64_tr_b16 v[192:193], v108 offset:8192
    ds_read_b64_tr_b16 v[194:195], v108 offset:8704
    s_waitcnt lgkmcnt(8)
    v_mfma_f32_32x32x16_bf16 v[0:15], v[88:91], v[228:231], v[0:15]
    ds_read_b64_tr_b16 v[196:197], v109 offset:8192
    ds_read_b64_tr_b16 v[198:199], v109 offset:8704
    s_waitcnt lgkmcnt(8)
    v_mfma_f32_32x32x16_bf16 v[16:31], v[212:215], v[228:231], v[16:31]
    ds_read_b64_tr_b16 v[200:201], v108 offset:9216
    ds_read_b64_tr_b16 v[202:203], v108 offset:9728
    s_waitcnt lgkmcnt(8)
    v_mfma_f32_32x32x16_bf16 v[32:47], v[216:219], v[228:231], v[32:47]
    ds_read_b64_tr_b16 v[204:205], v109 offset:9216
    ds_read_b64_tr_b16 v[206:207], v109 offset:9728
    s_cmp_lg_u32 s3, 0
    s_cbranch_scc1 k1f_kernel_k2c
    s_waitcnt vmcnt(4)
    v_cmp_eq_u64 vcc, s[64:65], v[110:111]
    s_and_b32 s7, vcc_lo, s49
    s_cmp_eq_u32 s7, s49
    s_cbranch_scc0 k1f_kernel_k2s
k1f_kernel_k2c:
    s_barrier
    v_cmp_gt_i32_e64 s[8:9], 0, v124
    v_cmp_gt_i32_e64 s[10:11], 1, v124
    v_cmp_gt_i32_e64 s[12:13], 2, v124
    v_cmp_gt_i32_e64 s[14:15], 3, v124
    s_waitcnt lgkmcnt(8)
    v_mfma_f32_32x32x16_bf16 v[48:63], v[220:223], v[228:231], v[48:63]
    ds_read_b64_tr_b16 v[208:209], v108 offset:12288
    ds_read_b64_tr_b16 v[210:211], v108 offset:12800
    s_add_u32 m0, s43, 147456
    s_add_u32 s55, s43, 16384
    buffer_load_dwordx4 v117, s[72:75], s55 offen sc1 lds
    v_cndmask_b32_e64 v64, 0, v122, s[8:9]
    v_cndmask_b32_e64 v65, 0, v122, s[10:11]
    v_cndmask_b32_e64 v66, 0, v122, s[12:13]
    v_cndmask_b32_e64 v67, 0, v122, s[14:15]
    s_waitcnt lgkmcnt(8)
    v_mfma_f32_32x32x16_bf16 v[0:15], v[192:195], v[232:235], v[0:15]
    ds_read_b64_tr_b16 v[212:213], v109 offset:12288
    ds_read_b64_tr_b16 v[214:215], v109 offset:12800
    buffer_load_dwordx4 v117, s[72:75], s55 offen offset:1024 sc1 lds
    v_cmp_gt_i32_e64 s[8:9], 8, v124
    v_cmp_gt_i32_e64 s[10:11], 9, v124
    v_cmp_gt_i32_e64 s[12:13], 10, v124
    v_cmp_gt_i32_e64 s[14:15], 11, v124
    s_waitcnt lgkmcnt(8)
    v_mfma_f32_32x32x16_bf16 v[16:31], v[196:199], v[232:235], v[16:31]
    ds_read_b64_tr_b16 v[216:217], v108 offset:13312
    ds_read_b64_tr_b16 v[218:219], v108 offset:13824
    s_add_u32 m0, s43, 114688
    s_add_u32 s55, s43, 49152
    buffer_load_dwordx4 v117, s[72:75], s55 offen sc1 lds
    v_cndmask_b32_e64 v68, 0, v122, s[8:9]
    v_cndmask_b32_e64 v69, 0, v122, s[10:11]
    v_cndmask_b32_e64 v70, 0, v122, s[12:13]
    v_cndmask_b32_e64 v71, 0, v122, s[14:15]
    s_waitcnt lgkmcnt(8)
    v_mfma_f32_32x32x16_bf16 v[32:47], v[200:203], v[232:235], v[32:47]
    ds_read_b64_tr_b16 v[220:221], v109 offset:13312
    ds_read_b64_tr_b16 v[222:223], v109 offset:13824
    buffer_load_dwordx4 v117, s[72:75], s55 offen offset:1024 sc1 lds
    v_cmp_gt_i32_e64 s[8:9], 16, v124
    v_cmp_gt_i32_e64 s[10:11], 17, v124
    v_cmp_gt_i32_e64 s[12:13], 18, v124
    v_cmp_gt_i32_e64 s[14:15], 19, v124
    s_waitcnt lgkmcnt(8)
    v_mfma_f32_32x32x16_bf16 v[48:63], v[204:207], v[232:235], v[48:63]
    ds_read_b64_tr_b16 v[192:193], v108 offset:16384
    ds_read_b64_tr_b16 v[194:195], v108 offset:16896
    s_add_u32 m0, s43, 81920
    s_add_u32 s55, s43, 81920
    buffer_load_dwordx4 v117, s[72:75], s55 offen sc1 lds
    v_cndmask_b32_e64 v72, 0, v122, s[8:9]
    v_cndmask_b32_e64 v73, 0, v122, s[10:11]
    v_cndmask_b32_e64 v74, 0, v122, s[12:13]
    v_cndmask_b32_e64 v75, 0, v122, s[14:15]
    s_waitcnt lgkmcnt(8)
    v_mfma_f32_32x32x16_bf16 v[0:15], v[208:211], v[236:239], v[0:15]
    ds_read_b64_tr_b16 v[196:197], v108 offset:20480
    ds_read_b64_tr_b16 v[198:199], v108 offset:20992
    buffer_load_dwordx4 v117, s[72:75], s55 offen offset:1024 sc1 lds
    v_cmp_gt_i32_e64 s[8:9], 24, v124
    v_cmp_gt_i32_e64 s[10:11], 25, v124
    v_cmp_gt_i32_e64 s[12:13], 26, v124
    v_cmp_gt_i32_e64 s[14:15], 27, v124
    s_waitcnt lgkmcnt(8)
    v_mfma_f32_32x32x16_bf16 v[16:31], v[212:215], v[236:239], v[16:31]
    ds_read_b64_tr_b16 v[200:201], v108 offset:24576
    ds_read_b64_tr_b16 v[202:203], v108 offset:25088
    s_add_u32 m0, s43, 49152
    s_add_u32 s55, s43, 114688
    buffer_load_dwordx4 v117, s[72:75], s55 offen sc1 lds
    v_cndmask_b32_e64 v76, 0, v122, s[8:9]
    v_cndmask_b32_e64 v77, 0, v122, s[10:11]
    v_cndmask_b32_e64 v78, 0, v122, s[12:13]
    v_cndmask_b32_e64 v79, 0, v122, s[14:15]
    s_waitcnt lgkmcnt(8)
    v_mfma_f32_32x32x16_bf16 v[32:47], v[216:219], v[236:239], v[32:47]
    ds_read_b64_tr_b16 v[204:205], v108 offset:28672
    ds_read_b64_tr_b16 v[206:207], v108 offset:29184
    buffer_load_dwordx4 v117, s[72:75], s55 offen offset:1024 sc1 lds
    v_cmp_gt_i32_e64 s[8:9], 32, v124
    v_cmp_gt_i32_e64 s[10:11], 33, v124
    v_cmp_gt_i32_e64 s[12:13], 34, v124
    v_cmp_gt_i32_e64 s[14:15], 35, v124
    s_waitcnt lgkmcnt(8)
    v_mfma_f32_32x32x16_bf16 v[48:63], v[220:223], v[236:239], v[48:63]
    ds_read_b64_tr_b16 v[208:209], v109 offset:16384
    ds_read_b64_tr_b16 v[210:211], v109 offset:16896
    v_cndmask_b32_e64 v80, 0, v122, s[8:9]
    v_cndmask_b32_e64 v81, 0, v122, s[10:11]
    v_cndmask_b32_e64 v82, 0, v122, s[12:13]
    v_cndmask_b32_e64 v83, 0, v122, s[14:15]
    s_waitcnt vmcnt(8)
    s_waitcnt lgkmcnt(8)
    v_mfma_f32_32x32x16_bf16 v[0:15], v[192:195], v[240:243], v[0:15]
    ds_read_b64_tr_b16 v[212:213], v109 offset:20480
    ds_read_b64_tr_b16 v[214:215], v109 offset:20992
    v_cmp_gt_i32_e64 s[8:9], 40, v124
    v_cmp_gt_i32_e64 s[10:11], 41, v124
    v_cmp_gt_i32_e64 s[12:13], 42, v124
    v_cmp_gt_i32_e64 s[14:15], 43, v124
    s_waitcnt lgkmcnt(8)
    v_mfma_f32_32x32x16_bf16 v[0:15], v[196:199], v[244:247], v[0:15]
    ds_read_b64_tr_b16 v[216:217], v109 offset:24576
    ds_read_b64_tr_b16 v[218:219], v109 offset:25088
    v_cndmask_b32_e64 v84, 0, v122, s[8:9]
    v_cndmask_b32_e64 v85, 0, v122, s[10:11]
    v_cndmask_b32_e64 v86, 0, v122, s[12:13]
    v_cndmask_b32_e64 v87, 0, v122, s[14:15]
    s_waitcnt lgkmcnt(8)
    v_mfma_f32_32x32x16_bf16 v[0:15], v[200:203], v[248:251], v[0:15]
    ds_read_b64_tr_b16 v[220:221], v109 offset:28672
    ds_read_b64_tr_b16 v[222:223], v109 offset:29184
    v_cmp_gt_i32_e64 s[8:9], 48, v124
    v_cmp_gt_i32_e64 s[10:11], 49, v124
    v_cmp_gt_i32_e64 s[12:13], 50, v124
    v_cmp_gt_i32_e64 s[14:15], 51, v124
    s_waitcnt lgkmcnt(8)
    v_mfma_f32_32x32x16_bf16 v[0:15], v[204:207], v[252:255], v[0:15]
    ds_read_b64_tr_b16 v[192:193], v108 offset:17408
    ds_read_b64_tr_b16 v[194:195], v108 offset:17920
    v_cndmask_b32_e64 v88, 0, v122, s[8:9]
    v_cndmask_b32_e64 v89, 0, v122, s[10:11]
    v_cndmask_b32_e64 v90, 0, v122, s[12:13]
    v_cndmask_b32_e64 v91, 0, v122, s[14:15]
    s_waitcnt lgkmcnt(8)
    v_mfma_f32_32x32x16_bf16 v[16:31], v[208:211], v[240:243], v[16:31]
    ds_read_b64_tr_b16 v[196:197], v108 offset:21504
    ds_read_b64_tr_b16 v[198:199], v108 offset:22016
    v_cmp_gt_i32_e64 s[8:9], 56, v124
    v_cmp_gt_i32_e64 s[10:11], 57, v124
    v_cmp_gt_i32_e64 s[12:13], 58, v124
    v_cmp_gt_i32_e64 s[14:15], 59, v124
    s_waitcnt lgkmcnt(8)
    v_mfma_f32_32x32x16_bf16 v[16:31], v[212:215], v[244:247], v[16:31]
    ds_read_b64_tr_b16 v[200:201], v108 offset:25600
    ds_read_b64_tr_b16 v[202:203], v108 offset:26112
    v_cndmask_b32_e64 v92, 0, v122, s[8:9]
    v_cndmask_b32_e64 v93, 0, v122, s[10:11]
    v_cndmask_b32_e64 v94, 0, v122, s[12:13]
    v_cndmask_b32_e64 v95, 0, v122, s[14:15]
    v_mul_f32 v0, 0x3e0293ee, v0
    v_mul_f32 v1, 0x3e0293ee, v1
    v_mul_f32 v2, 0x3e0293ee, v2
    v_mul_f32 v3, 0x3e0293ee, v3
    v_mul_f32 v4, 0x3e0293ee, v4
    v_mul_f32 v5, 0x3e0293ee, v5
    s_waitcnt lgkmcnt(8)
    v_mfma_f32_32x32x16_bf16 v[16:31], v[216:219], v[248:251], v[16:31]
    ds_read_b64_tr_b16 v[204:205], v108 offset:29696
    ds_read_b64_tr_b16 v[206:207], v108 offset:30208
    v_mul_f32 v6, 0x3e0293ee, v6
    v_mul_f32 v7, 0x3e0293ee, v7
    v_cvt_pk_bf16_f32 v144, v0, v1
    v_cvt_pk_bf16_f32 v145, v2, v3
    v_cvt_pk_bf16_f32 v146, v4, v5
    v_cvt_pk_bf16_f32 v147, v6, v7
    s_waitcnt lgkmcnt(8)
    v_mfma_f32_32x32x16_bf16 v[16:31], v[220:223], v[252:255], v[16:31]
    ds_read_b64_tr_b16 v[208:209], v109 offset:17408
    ds_read_b64_tr_b16 v[210:211], v109 offset:17920
    v_mul_f32 v8, 0x3e0293ee, v8
    v_mul_f32 v9, 0x3e0293ee, v9
    v_mul_f32 v10, 0x3e0293ee, v10
    v_mul_f32 v11, 0x3e0293ee, v11
    v_mul_f32 v12, 0x3e0293ee, v12
    v_mul_f32 v13, 0x3e0293ee, v13
    s_waitcnt lgkmcnt(8)
    v_mfma_f32_32x32x16_bf16 v[32:47], v[192:195], v[240:243], v[32:47]
    ds_read_b64_tr_b16 v[212:213], v109 offset:21504
    ds_read_b64_tr_b16 v[214:215], v109 offset:22016
    v_mul_f32 v14, 0x3e0293ee, v14
    v_mul_f32 v15, 0x3e0293ee, v15
    v_cvt_pk_bf16_f32 v148, v8, v9
    v_cvt_pk_bf16_f32 v149, v10, v11
    v_cvt_pk_bf16_f32 v150, v12, v13
    v_cvt_pk_bf16_f32 v151, v14, v15
    s_waitcnt lgkmcnt(8)
    v_mfma_f32_32x32x16_bf16 v[32:47], v[196:199], v[244:247], v[32:47]
    ds_read_b64_tr_b16 v[216:217], v109 offset:25600
    ds_read_b64_tr_b16 v[218:219], v109 offset:26112
    v_mul_f32 v16, 0x3e0293ee, v16
    v_mul_f32 v17, 0x3e0293ee, v17
    v_mul_f32 v18, 0x3e0293ee, v18
    v_mul_f32 v19, 0x3e0293ee, v19
    v_mul_f32 v20, 0x3e0293ee, v20
    v_mul_f32 v21, 0x3e0293ee, v21
    s_waitcnt lgkmcnt(8)
    v_mfma_f32_32x32x16_bf16 v[32:47], v[200:203], v[248:251], v[32:47]
    ds_read_b64_tr_b16 v[220:221], v109 offset:29696
    ds_read_b64_tr_b16 v[222:223], v109 offset:30208
    s_barrier
    v_mul_f32 v22, 0x3e0293ee, v22
    v_mul_f32 v23, 0x3e0293ee, v23
    v_cvt_pk_bf16_f32 v152, v16, v17
    v_cvt_pk_bf16_f32 v153, v18, v19
    v_cvt_pk_bf16_f32 v154, v20, v21
    v_cvt_pk_bf16_f32 v155, v22, v23
    s_waitcnt lgkmcnt(8)
    v_mfma_f32_32x32x16_bf16 v[32:47], v[204:207], v[252:255], v[32:47]
    ds_read_b128 v[192:195], v104 offset:0
    s_add_u32 m0, s43, 0
    s_add_u32 s55, s43, 131072
    buffer_load_dwordx4 v117, s[72:75], s55 offen sc1 lds
    v_mul_f32 v24, 0x3e0293ee, v24
    v_mul_f32 v25, 0x3e0293ee, v25
    v_mul_f32 v26, 0x3e0293ee, v26
    v_mul_f32 v27, 0x3e0293ee, v27
    v_mul_f32 v28, 0x3e0293ee, v28
    v_mul_f32 v29, 0x3e0293ee, v29
    s_waitcnt lgkmcnt(7)
    v_mfma_f32_32x32x16_bf16 v[48:63], v[208:211], v[240:243], v[48:63]
    ds_read_b128 v[196:199], v104 offset:8192
    buffer_load_dwordx4 v117, s[72:75], s55 offen offset:1024 sc1 lds
    v_mul_f32 v30, 0x3e0293ee, v30
    v_mul_f32 v31, 0x3e0293ee, v31
    v_cvt_pk_bf16_f32 v156, v24, v25
    v_cvt_pk_bf16_f32 v157, v26, v27
    v_cvt_pk_bf16_f32 v158, v28, v29
    v_cvt_pk_bf16_f32 v159, v30, v31
    s_waitcnt lgkmcnt(6)
    v_mfma_f32_32x32x16_bf16 v[48:63], v[212:215], v[244:247], v[48:63]
    ds_read_b128 v[200:203], v104 offset:1024
    v_mul_f32 v32, 0x3e0293ee, v32
    v_mul_f32 v33, 0x3e0293ee, v33
    v_mul_f32 v34, 0x3e0293ee, v34
    v_mul_f32 v35, 0x3e0293ee, v35
    v_mul_f32 v36, 0x3e0293ee, v36
    v_mul_f32 v37, 0x3e0293ee, v37
    s_waitcnt lgkmcnt(5)
    v_mfma_f32_32x32x16_bf16 v[48:63], v[216:219], v[248:251], v[48:63]
    ds_read_b128 v[204:207], v104 offset:9216
    v_mul_f32 v38, 0x3e0293ee, v38
    v_mul_f32 v39, 0x3e0293ee, v39
    v_cvt_pk_bf16_f32 v160, v32, v33
    v_cvt_pk_bf16_f32 v161, v34, v35
    v_cvt_pk_bf16_f32 v162, v36, v37
    v_cvt_pk_bf16_f32 v163, v38, v39
    s_waitcnt lgkmcnt(4)
    v_mfma_f32_32x32x16_bf16 v[48:63], v[220:223], v[252:255], v[48:63]
    ds_read_b128 v[208:211], v104 offset:2048
    v_mul_f32 v40, 0x3e0293ee, v40
    v_mul_f32 v41, 0x3e0293ee, v41
    v_mul_f32 v42, 0x3e0293ee, v42
    v_mul_f32 v43, 0x3e0293ee, v43
    v_mul_f32 v44, 0x3e0293ee, v44
    v_mul_f32 v45, 0x3e0293ee, v45
    s_waitcnt lgkmcnt(4)
    v_mfma_f32_32x32x16_bf16 v[64:79], v[192:195], v[144:147], v[64:79]
    ds_read_b128 v[212:215], v104 offset:10240
    v_mul_f32 v46, 0x3e0293ee, v46
    v_mul_f32 v47, 0x3e0293ee, v47
    v_cvt_pk_bf16_f32 v164, v40, v41
    v_cvt_pk_bf16_f32 v165, v42, v43
    v_cvt_pk_bf16_f32 v166, v44, v45
    v_cvt_pk_bf16_f32 v167, v46, v47
    s_waitcnt lgkmcnt(4)
    v_mfma_f32_32x32x16_bf16 v[80:95], v[196:199], v[144:147], v[80:95]
    ds_read_b128 v[216:219], v104 offset:3072
    v_mul_f32 v48, 0x3e0293ee, v48
    v_mul_f32 v49, 0x3e0293ee, v49
    v_mul_f32 v50, 0x3e0293ee, v50
    v_mul_f32 v51, 0x3e0293ee, v51
    v_mul_f32 v52, 0x3e0293ee, v52
    v_mul_f32 v53, 0x3e0293ee, v53
    s_waitcnt lgkmcnt(4)
    v_mfma_f32_32x32x16_bf16 v[64:79], v[200:203], v[148:151], v[64:79]
    ds_read_b128 v[220:223], v104 offset:11264
    v_mul_f32 v54, 0x3e0293ee, v54
    v_mul_f32 v55, 0x3e0293ee, v55
    v_cvt_pk_bf16_f32 v168, v48, v49
    v_cvt_pk_bf16_f32 v169, v50, v51
    v_cvt_pk_bf16_f32 v170, v52, v53
    v_cvt_pk_bf16_f32 v171, v54, v55
    s_waitcnt lgkmcnt(4)
    v_mfma_f32_32x32x16_bf16 v[80:95], v[204:207], v[148:151], v[80:95]
    ds_read_b128 v[192:195], v104 offset:4096
    v_mul_f32 v56, 0x3e0293ee, v56
    v_mul_f32 v57, 0x3e0293ee, v57
    v_mul_f32 v58, 0x3e0293ee, v58
    v_mul_f32 v59, 0x3e0293ee, v59
    v_mul_f32 v60, 0x3e0293ee, v60
    v_mul_f32 v61, 0x3e0293ee, v61
    s_waitcnt lgkmcnt(4)
    v_mfma_f32_32x32x16_bf16 v[64:79], v[208:211], v[152:155], v[64:79]
    ds_read_b128 v[196:199], v104 offset:12288
    v_mul_f32 v62, 0x3e0293ee, v62
    v_mul_f32 v63, 0x3e0293ee, v63
    v_cvt_pk_bf16_f32 v172, v56, v57
    v_cvt_pk_bf16_f32 v173, v58, v59
    v_cvt_pk_bf16_f32 v174, v60, v61
    v_cvt_pk_bf16_f32 v175, v62, v63
    s_waitcnt lgkmcnt(4)
    v_mfma_f32_32x32x16_bf16 v[80:95], v[212:215], v[152:155], v[80:95]
    ds_read_b128 v[200:203], v104 offset:5120
    s_waitcnt lgkmcnt(4)
    v_mfma_f32_32x32x16_bf16 v[64:79], v[216:219], v[156:159], v[64:79]
    ds_read_b128 v[204:207], v104 offset:13312
    v_mov_b32 v0, 0
    v_mov_b32 v1, 0
    v_mov_b32 v2, 0
    v_mov_b32 v3, 0
    v_mov_b32 v4, 0
    v_mov_b32 v5, 0
    v_mov_b32 v6, 0
    v_mov_b32 v7, 0
    s_waitcnt lgkmcnt(4)
    v_mfma_f32_32x32x16_bf16 v[80:95], v[220:223], v[156:159], v[80:95]
    ds_read_b128 v[208:211], v104 offset:6144
    v_mov_b32 v8, 0
    v_mov_b32 v9, 0
    v_mov_b32 v10, 0
    v_mov_b32 v11, 0
    v_mov_b32 v12, 0
    v_mov_b32 v13, 0
    v_mov_b32 v14, 0
    v_mov_b32 v15, 0
    s_waitcnt lgkmcnt(4)
    v_mfma_f32_32x32x16_bf16 v[64:79], v[192:195], v[160:163], v[64:79]
    ds_read_b128 v[212:215], v104 offset:14336
    v_mov_b32 v16, 0
    v_mov_b32 v17, 0
    v_mov_b32 v18, 0
    v_mov_b32 v19, 0
    v_mov_b32 v20, 0
    v_mov_b32 v21, 0
    v_mov_b32 v22, 0
    v_mov_b32 v23, 0
    s_waitcnt lgkmcnt(4)
    v_mfma_f32_32x32x16_bf16 v[80:95], v[196:199], v[160:163], v[80:95]
    ds_read_b128 v[216:219], v104 offset:7168
    v_mov_b32 v24, 0
    v_mov_b32 v25, 0
    v_mov_b32 v26, 0
    v_mov_b32 v27, 0
    v_mov_b32 v28, 0
    v_mov_b32 v29, 0
    v_mov_b32 v30, 0
    v_mov_b32 v31, 0
    s_waitcnt lgkmcnt(4)
    v_mfma_f32_32x32x16_bf16 v[64:79], v[200:203], v[164:167], v[64:79]
    ds_read_b128 v[220:223], v104 offset:15360
    v_mov_b32 v32, 0
    v_mov_b32 v33, 0
    v_mov_b32 v34, 0
    v_mov_b32 v35, 0
    v_mov_b32 v36, 0
    v_mov_b32 v37, 0
    v_mov_b32 v38, 0
    v_mov_b32 v39, 0
    s_waitcnt lgkmcnt(4)
    v_mfma_f32_32x32x16_bf16 v[80:95], v[204:207], v[164:167], v[80:95]
    v_mov_b32 v40, 0
    v_mov_b32 v41, 0
    v_mov_b32 v42, 0
    v_mov_b32 v43, 0
    v_mov_b32 v44, 0
    v_mov_b32 v45, 0
    v_mov_b32 v46, 0
    v_mov_b32 v47, 0
    s_waitcnt lgkmcnt(3)
    v_mfma_f32_32x32x16_bf16 v[64:79], v[208:211], v[168:171], v[64:79]
    v_mov_b32 v48, 0
    v_mov_b32 v49, 0
    v_mov_b32 v50, 0
    v_mov_b32 v51, 0
    v_mov_b32 v52, 0
    v_mov_b32 v53, 0
    v_mov_b32 v54, 0
    v_mov_b32 v55, 0
    s_waitcnt lgkmcnt(2)
    v_mfma_f32_32x32x16_bf16 v[80:95], v[212:215], v[168:171], v[80:95]
    v_mov_b32 v56, 0
    v_mov_b32 v57, 0
    v_mov_b32 v58, 0
    v_mov_b32 v59, 0
    v_mov_b32 v60, 0
    v_mov_b32 v61, 0
    v_mov_b32 v62, 0
    v_mov_b32 v63, 0
    s_waitcnt lgkmcnt(1)
    v_mfma_f32_32x32x16_bf16 v[64:79], v[216:219], v[172:175], v[64:79]
    v_mov_b32 v110, 0
    v_mov_b32 v111, 0
    s_waitcnt lgkmcnt(0)
    v_mfma_f32_32x32x16_bf16 v[80:95], v[220:223], v[172:175], v[80:95]
    ds_read_b128 v[192:195], v105 offset:0
    ds_read_b128 v[196:199], v105 offset:8192
    ds_read_b128 v[200:203], v105 offset:1024
    ds_read_b128 v[204:207], v105 offset:9216
    ds_read_b128 v[208:211], v105 offset:2048
    ds_read_b128 v[212:215], v105 offset:10240
    ds_read_b128 v[216:219], v105 offset:3072
    s_nop 0
    v_max3_f32 v113, v64, v65, v66
    s_nop 2
    v_max3_f32 v114, v80, v81, v82
    v_max3_f32 v113, v113, v67, v68
    v_max3_f32 v114, v114, v83, v84
    v_max3_f32 v113, v113, v69, v70
    v_max3_f32 v114, v114, v85, v86
    v_max3_f32 v113, v113, v71, v72
    v_max3_f32 v114, v114, v87, v88
    v_max3_f32 v113, v113, v73, v74
    v_max3_f32 v114, v114, v89, v90
    v_max3_f32 v113, v113, v75, v76
    v_max3_f32 v114, v114, v91, v92
    v_max3_f32 v113, v113, v77, v78
    v_max3_f32 v114, v114, v93, v94
    v_max3_f32 v113, v113, v79, v95
    v_max_f32 v113, v113, v114
    v_mov_b32 v115, v113
    s_nop 1
    v_permlane32_swap_b32 v113, v115
    v_max_f32 v115, v113, v115
    v_sub_f32 v128, 0, v115
    v_sub_f32 v129, 0, v115
    v_sub_f32 v130, 0, v115
    v_sub_f32 v131, 0, v115
    v_sub_f32 v132, 0, v115
    v_sub_f32 v133, 0, v115
    v_sub_f32 v134, 0, v115
    v_sub_f32 v135, 0, v115
    v_sub_f32 v136, 0, v115
    v_sub_f32 v137, 0, v115
    v_sub_f32 v138, 0, v115
    v_sub_f32 v139, 0, v115
    v_sub_f32 v140, 0, v115
    v_sub_f32 v141, 0, v115
    v_sub_f32 v142, 0, v115
    v_sub_f32 v143, 0, v115
    v_sub_f32 v64, v64, v115
    v_sub_f32 v65, v65, v115
    v_sub_f32 v66, v66, v115
    v_sub_f32 v67, v67, v115
    v_sub_f32 v68, v68, v115
    v_sub_f32 v69, v69, v115
    v_sub_f32 v70, v70, v115
    v_sub_f32 v71, v71, v115
    v_sub_f32 v72, v72, v115
    v_sub_f32 v73, v73, v115
    v_sub_f32 v74, v74, v115
    v_sub_f32 v75, v75, v115
    v_sub_f32 v76, v76, v115
    v_sub_f32 v77, v77, v115
    v_sub_f32 v78, v78, v115
    v_sub_f32 v79, v79, v115
    v_sub_f32 v80, v80, v115
    v_sub_f32 v81, v81, v115
    v_sub_f32 v82, v82, v115
    v_sub_f32 v83, v83, v115
    v_sub_f32 v84, v84, v115
    v_sub_f32 v85, v85, v115
    v_sub_f32 v86, v86, v115
    v_sub_f32 v87, v87, v115
    v_sub_f32 v88, v88, v115
    v_sub_f32 v89, v89, v115
    v_sub_f32 v90, v90, v115
    v_sub_f32 v91, v91, v115
    v_sub_f32 v92, v92, v115
    v_sub_f32 v93, v93, v115
    v_sub_f32 v94, v94, v115
    v_sub_f32 v95, v95, v115
    s_waitcnt vmcnt(0)
    s_sub_u32 s6, s2, 128
    s_cmp_ge_u32 s6, 120
    s_cbranch_scc1 k1f_kernel_nrt
    global_load_dword v121, v123, s[16:17]
k1f_kernel_nrt:
    s_setprio 2
    s_cmp_eq_u32 s29, 1
    s_cbranch_scc1 k1f_kernel_Ef
    s_bitcmp1_b32 s29, 0
    s_cbranch_scc1 k1f_kernel_E
    v_mov_b32 v224, v64
    v_mov_b32 v225, v65
    v_mov_b32 v226, v66
    v_mov_b32 v227, v67
    v_mov_b32 v228, v68
    v_mov_b32 v229, v69
    v_mov_b32 v230, v70
    v_mov_b32 v231, v71
    v_mov_b32 v232, v72
    v_mov_b32 v233, v73
    v_mov_b32 v234, v74
    v_mov_b32 v235, v75
    v_mov_b32 v236, v76
    v_mov_b32 v237, v77
    v_mov_b32 v238, v78
    v_mov_b32 v239, v79
    v_mov_b32 v240, v80
    v_mov_b32 v241, v81
    v_mov_b32 v242, v82
    v_mov_b32 v243, v83
    v_mov_b32 v244, v84
    v_mov_b32 v245, v85
    v_mov_b32 v246, v86
    v_mov_b32 v247, v87
    v_mov_b32 v248, v88
    v_mov_b32 v249, v89
    v_mov_b32 v250, v90
    v_mov_b32 v251, v91
    v_mov_b32 v252, v92
    v_mov_b32 v253, v93
    v_mov_b32 v254, v94
    v_mov_b32 v255, v95
    v_swap_b32 v104, v105
    s_branch k1f_kernel_Oc
k1f_kernel_E:
    s_waitcnt lgkmcnt(6)
    v_mfma_f32_32x32x16_bf16 v[224:239], v[192:195], v[144:147], v[128:143]
    ds_read_b128 v[220:223], v105 offset:11264
    v_exp_f32 v64, v64
    v_exp_f32 v65, v65
    s_waitcnt lgkmcnt(6)
    v_mfma_f32_32x32x16_bf16 v[240:255], v[196:199], v[144:147], v[128:143]
    s_waitcnt vmcnt(20)
    s_barrier
    ds_read_b128 v[192:195], v105 offset:4096
    s_waitcnt lgkmcnt(6)
    v_mfma_f32_32x32x16_bf16 v[224:239], v[200:203], v[148:151], v[224:239]
    ds_read_b128 v[196:199], v105 offset:12288
    s_add_u32 s30, s30, 1
    s_cmp_eq_u32 s31, 0
    s_cbranch_scc1 k1f_kernel_s1
    s_mov_b32 m0, s33
    s_sub_u32 s83, s81, 16384
    buffer_load_dwordx4 v117, s[72:75], s81 offen offset:0 sc1 lds
    buffer_load_dwordx4 v117, s[72:75], s81 offen offset:1024 sc1 lds
    buffer_load_dwordx4 v117, s[72:75], s81 offen offset:2048 sc1 lds
    buffer_load_dwordx4 v117, s[72:75], s81 offen offset:3072 sc1 lds
    s_mov_b32 m0, s80
    s_add_u32 s81, s81, 32768
    buffer_load_dwordx4 v117, s[72:75], s83 offen offset:0 sc1 lds
    buffer_load_dwordx4 v117, s[72:75], s83 offen offset:1024 sc1 lds
    buffer_load_dwordx4 v117, s[72:75], s83 offen offset:2048 sc1 lds
    buffer_load_dwordx4 v117, s[72:75], s83 offen offset:3072 sc1 lds
    s_add_u32 s80, s33, 16384
    s_sub_u32 s33, s33, 32768
    s_cselect_b32 s33, s40, s33
k1f_kernel_s1:
    s_waitcnt lgkmcnt(6)
    v_mfma_f32_32x32x16_bf16 v[240:255], v[204:207], v[148:151], v[240:255]
    ds_read_b128 v[200:203], v105 offset:5120
    v_exp_f32 v66, v66
    v_exp_f32 v67, v67
    v_cvt_pk_bf16_f32 v176, v64, v65
    s_waitcnt lgkmcnt(6)
    v_mfma_f32_32x32x16_bf16 v[224:239], v[208:211], v[152:155], v[224:239]
    ds_read_b128 v[204:207], v105 offset:13312
    v_exp_f32 v68, v68
    v_cvt_pk_bf16_f32 v177, v66, v67
    v_add_f32 v110, v110, v64
    s_waitcnt lgkmcnt(6)
    v_mfma_f32_32x32x16_bf16 v[240:255], v[212:215], v[152:155], v[240:255]
    ds_read_b128 v[208:211], v105 offset:6144
    v_exp_f32 v69, v69
    v_exp_f32 v70, v70
    v_add_f32 v111, v111, v65
    s_waitcnt lgkmcnt(6)
    v_mfma_f32_32x32x16_bf16 v[224:239], v[216:219], v[156:159], v[224:239]
    ds_read_b128 v[212:215], v105 offset:14336
    v_exp_f32 v71, v71
    v_cvt_pk_bf16_f32 v178, v68, v69
    v_add_f32 v110, v110, v66
    s_waitcnt lgkmcnt(6)
    v_mfma_f32_32x32x16_bf16 v[240:255], v[220:223], v[156:159], v[240:255]
    ds_read_b128 v[216:219], v105 offset:7168
    v_exp_f32 v72, v72
    v_exp_f32 v73, v73
    v_cvt_pk_bf16_f32 v179, v70, v71
    s_waitcnt lgkmcnt(6)
    v_mfma_f32_32x32x16_bf16 v[224:239], v[192:195], v[160:163], v[224:239]
    ds_read_b128 v[220:223], v105 offset:15360
    v_exp_f32 v74, v74
    v_cvt_pk_bf16_f32 v180, v72, v73
    v_add_f32 v111, v111, v67
    s_waitcnt lgkmcnt(6)
    v_mfma_f32_32x32x16_bf16 v[240:255], v[196:199], v[160:163], v[240:255]
    ds_read_b128 v[192:195], v104 offset:16384
    v_exp_f32 v75, v75
    v_exp_f32 v76, v76
    v_add_f32 v110, v110, v68
    s_waitcnt lgkmcnt(6)
    v_mfma_f32_32x32x16_bf16 v[224:239], v[200:203], v[164:167], v[224:239]
    ds_read_b128 v[196:199], v104 offset:20480
    v_exp_f32 v77, v77
    v_cvt_pk_bf16_f32 v181, v74, v75
    v_add_f32 v111, v111, v69
    s_waitcnt lgkmcnt(6)
    v_mfma_f32_32x32x16_bf16 v[240:255], v[204:207], v[164:167], v[240:255]
    ds_read_b128 v[200:203], v104 offset:24576
    v_exp_f32 v78, v78
    v_exp_f32 v79, v79
    v_cvt_pk_bf16_f32 v182, v76, v77
    s_waitcnt lgkmcnt(6)
    v_mfma_f32_32x32x16_bf16 v[224:239], v[208:211], v[168:171], v[224:239]
    ds_read_b128 v[204:207], v104 offset:28672
    v_exp_f32 v80, v80
    v_cvt_pk_bf16_f32 v183, v78, v79
    v_add_f32 v110, v110, v70
    s_waitcnt lgkmcnt(6)
    v_mfma_f32_32x32x16_bf16 v[240:255], v[212:215], v[168:171], v[240:255]
    ds_read_b128 v[208:211], v104 offset:17408
    v_exp_f32 v81, v81
    v_exp_f32 v82, v82
    s_waitcnt lgkmcnt(6)
    v_mfma_f32_32x32x16_bf16 v[224:239], v[216:219], v[172:175], v[224:239]
    ds_read_b128 v[212:215], v104 offset:21504
    v_exp_f32 v83, v83
    v_cvt_pk_bf16_f32 v184, v80, v81
    v_add_f32 v111, v111, v71
    v_add_f32 v110, v110, v72
    s_waitcnt lgkmcnt(6)
    v_mfma_f32_32x32x16_bf16 v[240:255], v[220:223], v[172:175], v[240:255]
    ds_read_b128 v[216:219], v104 offset:25600
    v_exp_f32 v84, v84
    v_cvt_pk_bf16_f32 v185, v82, v83
    v_add_f32 v111, v111, v73
    s_waitcnt lgkmcnt(6)
    v_mfma_f32_32x32x16_bf16 v[0:15], v[192:195], v[176:179], v[0:15]
    ds_read_b128 v[220:223], v104 offset:29696
    v_exp_f32 v85, v85
    v_add_f32 v110, v110, v74
    v_add_f32 v111, v111, v75
    v_add_f32 v110, v110, v76
    s_waitcnt lgkmcnt(6)
    v_mfma_f32_32x32x16_bf16 v[16:31], v[196:199], v[176:179], v[16:31]
    ds_read_b128 v[192:195], v104 offset:18432
    v_exp_f32 v86, v86
    v_cvt_pk_bf16_f32 v186, v84, v85
    v_max3_f32 v113, v224, v225, v226
    v_max3_f32 v114, v240, v241, v242
    s_waitcnt lgkmcnt(6)
    v_mfma_f32_32x32x16_bf16 v[32:47], v[200:203], v[176:179], v[32:47]
    ds_read_b128 v[196:199], v104 offset:22528
    v_exp_f32 v87, v87
    v_max3_f32 v113, v113, v227, v228
    v_add_f32 v111, v111, v77
    s_waitcnt lgkmcnt(6)
    v_mfma_f32_32x32x16_bf16 v[48:63], v[204:207], v[176:179], v[48:63]
    ds_read_b128 v[200:203], v104 offset:26624
    v_exp_f32 v88, v88
    v_cvt_pk_bf16_f32 v187, v86, v87
    v_max3_f32 v114, v114, v243, v244
    s_waitcnt lgkmcnt(6)
    v_mfma_f32_32x32x16_bf16 v[0:15], v[208:211], v[180:183], v[0:15]
    ds_read_b128 v[204:207], v104 offset:30720
    v_exp_f32 v89, v89
    v_max3_f32 v113, v113, v229, v230
    v_add_f32 v110, v110, v78
    v_add_f32 v111, v111, v79
    s_waitcnt lgkmcnt(6)
    v_mfma_f32_32x32x16_bf16 v[16:31], v[212:215], v[180:183], v[16:31]
    ds_read_b128 v[208:211], v104 offset:19456
    v_exp_f32 v90, v90
    v_cvt_pk_bf16_f32 v188, v88, v89
    v_max3_f32 v114, v114, v245, v246
    v_max3_f32 v113, v113, v231, v232
    s_waitcnt lgkmcnt(6)
    v_mfma_f32_32x32x16_bf16 v[32:47], v[216:219], v[180:183], v[32:47]
    ds_read_b128 v[212:215], v104 offset:23552
    v_exp_f32 v91, v91
    v_max3_f32 v114, v114, v247, v248
    s_waitcnt lgkmcnt(6)
    v_mfma_f32_32x32x16_bf16 v[48:63], v[220:223], v[180:183], v[48:63]
    ds_read_b128 v[216:219], v104 offset:27648
    v_exp_f32 v92, v92
    v_cvt_pk_bf16_f32 v189, v90, v91
    v_max3_f32 v113, v113, v233, v234
    v_add_f32 v110, v110, v80
    s_waitcnt lgkmcnt(6)
    v_mfma_f32_32x32x16_bf16 v[0:15], v[192:195], v[184:187], v[0:15]
    ds_read_b128 v[220:223], v104 offset:31744
    v_exp_f32 v93, v93
    v_max3_f32 v114, v114, v249, v250
    v_add_f32 v111, v111, v81
    s_waitcnt lgkmcnt(6)
    v_mfma_f32_32x32x16_bf16 v[16:31], v[196:199], v[184:187], v[16:31]
    v_add_u32 v104, s32, v117
    s_sub_u32 s32, s32, 32768
    s_cselect_b32 s32, 131072, s32
    ds_read_b128 v[192:195], v104 offset:0
    v_exp_f32 v94, v94
    v_cvt_pk_bf16_f32 v190, v92, v93
    v_max3_f32 v113, v113, v235, v236
    v_add_f32 v110, v110, v82
    s_waitcnt lgkmcnt(6)
    v_mfma_f32_32x32x16_bf16 v[32:47], v[200:203], v[184:187], v[32:47]
    ds_read_b128 v[196:199], v104 offset:8192
    v_exp_f32 v95, v95
    v_max3_f32 v114, v114, v251, v252
    v_max3_f32 v113, v113, v237, v238
    s_waitcnt lgkmcnt(6)
    v_mfma_f32_32x32x16_bf16 v[48:63], v[204:207], v[184:187], v[48:63]
    ds_read_b128 v[200:203], v104 offset:1024
    v_cvt_pk_bf16_f32 v191, v94, v95
    v_max3_f32 v114, v114, v253, v254
    v_add_f32 v111, v111, v83
    v_add_f32 v110, v110, v84
    v_add_f32 v111, v111, v85
    s_waitcnt lgkmcnt(6)
    v_mfma_f32_32x32x16_bf16 v[0:15], v[208:211], v[188:191], v[0:15]
    ds_read_b128 v[204:207], v104 offset:9216
    v_max3_f32 v113, v113, v239, v255
    v_add_f32 v110, v110, v86
    v_add_f32 v111, v111, v87
    v_add_f32 v110, v110, v88
    s_waitcnt lgkmcnt(6)
    v_mfma_f32_32x32x16_bf16 v[16:31], v[212:215], v[188:191], v[16:31]
    ds_read_b128 v[208:211], v104 offset:2048
    v_max_f32 v113, v113, v114
    v_add_f32 v111, v111, v89
    v_add_f32 v110, v110, v90
    v_add_f32 v111, v111, v91
    v_add_f32 v110, v110, v92
    s_waitcnt lgkmcnt(6)
    v_mfma_f32_32x32x16_bf16 v[32:47], v[216:219], v[188:191], v[32:47]
    ds_read_b128 v[212:215], v104 offset:10240
    v_cmp_lt_f32 vcc, 0x42200000, v113
    v_add_f32 v111, v111, v93
    v_add_f32 v110, v110, v94
    v_add_f32 v111, v111, v95
    s_waitcnt lgkmcnt(6)
    v_mfma_f32_32x32x16_bf16 v[48:63], v[220:223], v[188:191], v[48:63]
    ds_read_b128 v[216:219], v104 offset:3072
    s_cbranch_vccnz k1f_kernel_E_slow
k1f_kernel_E_ret:
k1f_kernel_Oc:
    s_add_u32 s6, s30, 2
    s_cmp_eq_u32 s6, s29
    s_cbranch_scc1 k1f_kernel_Om
k1f_kernel_O:
    s_waitcnt lgkmcnt(6)
    v_mfma_f32_32x32x16_bf16 v[64:79], v[192:195], v[144:147], v[128:143]
    ds_read_b128 v[220:223], v104 offset:11264
    v_exp_f32 v224, v224
    v_exp_f32 v225, v225
    s_waitcnt lgkmcnt(6)
    v_mfma_f32_32x32x16_bf16 v[80:95], v[196:199], v[144:147], v[128:143]
    s_waitcnt vmcnt(20)
    s_barrier
    ds_read_b128 v[192:195], v104 offset:4096
    s_waitcnt lgkmcnt(6)
    v_mfma_f32_32x32x16_bf16 v[64:79], v[200:203], v[148:151], v[64:79]
    ds_read_b128 v[196:199], v104 offset:12288
    s_add_u32 s30, s30, 1
    s_cmp_eq_u32 s31, 0
    s_cbranch_scc1 k1f_kernel_s2
    s_mov_b32 m0, s33
    s_sub_u32 s83, s81, 16384
    buffer_load_dwordx4 v117, s[72:75], s81 offen offset:0 sc1 lds
    buffer_load_dwordx4 v117, s[72:75], s81 offen offset:1024 sc1 lds
    buffer_load_dwordx4 v117, s[72:75], s81 offen offset:2048 sc1 lds
    buffer_load_dwordx4 v117, s[72:75], s81 offen offset:3072 sc1 lds
    s_mov_b32 m0, s80
    s_add_u32 s81, s81, 32768
    buffer_load_dwordx4 v117, s[72:75], s83 offen offset:0 sc1 lds
    buffer_load_dwordx4 v117, s[72:75], s83 offen offset:1024 sc1 lds
    buffer_load_dwordx4 v117, s[72:75], s83 offen offset:2048 sc1 lds
    buffer_load_dwordx4 v117, s[72:75], s83 offen offset:3072 sc1 lds
    s_add_u32 s80, s33, 16384
    s_sub_u32 s33, s33, 32768
    s_cselect_b32 s33, s40, s33
k1f_kernel_s2:
    s_waitcnt lgkmcnt(6)
    v_mfma_f32_32x32x16_bf16 v[80:95], v[204:207], v[148:151], v[80:95]
    ds_read_b128 v[200:203], v104 offset:5120
    v_exp_f32 v226, v226
    v_exp_f32 v227, v227
    v_cvt_pk_bf16_f32 v176, v224, v225
    s_waitcnt lgkmcnt(6)
    v_mfma_f32_32x32x16_bf16 v[64:79], v[208:211], v[152:155], v[64:79]
    ds_read_b128 v[204:207], v104 offset:13312
    v_exp_f32 v228, v228
    v_cvt_pk_bf16_f32 v177, v226, v227
    v_add_f32 v110, v110, v224
    s_waitcnt lgkmcnt(6)
    v_mfma_f32_32x32x16_bf16 v[80:95], v[212:215], v[152:155], v[80:95]
    ds_read_b128 v[208:211], v104 offset:6144
    v_exp_f32 v229, v229
    v_exp_f32 v230, v230
    v_add_f32 v111, v111, v225
    s_waitcnt lgkmcnt(6)
    v_mfma_f32_32x32x16_bf16 v[64:79], v[216:219], v[156:159], v[64:79]
    ds_read_b128 v[212:215], v104 offset:14336
    v_exp_f32 v231, v231
    v_cvt_pk_bf16_f32 v178, v228, v229
    v_add_f32 v110, v110, v226
    s_waitcnt lgkmcnt(6)
    v_mfma_f32_32x32x16_bf16 v[80:95], v[220:223], v[156:159], v[80:95]
    ds_read_b128 v[216:219], v104 offset:7168
    v_exp_f32 v232, v232
    v_exp_f32 v233, v233
    v_cvt_pk_bf16_f32 v179, v230, v231
    s_waitcnt lgkmcnt(6)
    v_mfma_f32_32x32x16_bf16 v[64:79], v[192:195], v[160:163], v[64:79]
    ds_read_b128 v[220:223], v104 offset:15360
    v_exp_f32 v234, v234
    v_cvt_pk_bf16_f32 v180, v232, v233
    v_add_f32 v111, v111, v227
    s_waitcnt lgkmcnt(6)
    v_mfma_f32_32x32x16_bf16 v[80:95], v[196:199], v[160:163], v[80:95]
    ds_read_b128 v[192:195], v105 offset:16384
    v_exp_f32 v235, v235
    v_exp_f32 v236, v236
    v_add_f32 v110, v110, v228
    s_waitcnt lgkmcnt(6)
    v_mfma_f32_32x32x16_bf16 v[64:79], v[200:203], v[164:167], v[64:79]
    ds_read_b128 v[196:199], v105 offset:20480
    v_exp_f32 v237, v237
    v_cvt_pk_bf16_f32 v181, v234, v235
    v_add_f32 v111, v111, v229
    s_waitcnt lgkmcnt(6)
    v_mfma_f32_32x32x16_bf16 v[80:95], v[204:207], v[164:167], v[80:95]
    ds_read_b128 v[200:203], v105 offset:24576
    v_exp_f32 v238, v238
    v_exp_f32 v239, v239
    v_cvt_pk_bf16_f32 v182, v236, v237
    s_waitcnt lgkmcnt(6)
    v_mfma_f32_32x32x16_bf16 v[64:79], v[208:211], v[168:171], v[64:79]
    ds_read_b128 v[204:207], v105 offset:28672
    v_exp_f32 v240, v240
    v_cvt_pk_bf16_f32 v183, v238, v239
    v_add_f32 v110, v110, v230
    s_waitcnt lgkmcnt(6)
    v_mfma_f32_32x32x16_bf16 v[80:95], v[212:215], v[168:171], v[80:95]
    ds_read_b128 v[208:211], v105 offset:17408
    v_exp_f32 v241, v241
    v_exp_f32 v242, v242
    s_waitcnt lgkmcnt(6)
    v_mfma_f32_32x32x16_bf16 v[64:79], v[216:219], v[172:175], v[64:79]
    ds_read_b128 v[212:215], v105 offset:21504
    v_exp_f32 v243, v243
    v_cvt_pk_bf16_f32 v184, v240, v241
    v_add_f32 v111, v111, v231
    v_add_f32 v110, v110, v232
    s_waitcnt lgkmcnt(6)
    v_mfma_f32_32x32x16_bf16 v[80:95], v[220:223], v[172:175], v[80:95]
    ds_read_b128 v[216:219], v105 offset:25600
    v_exp_f32 v244, v244
    v_cvt_pk_bf16_f32 v185, v242, v243
    v_add_f32 v111, v111, v233
    s_waitcnt lgkmcnt(6)
    v_mfma_f32_32x32x16_bf16 v[0:15], v[192:195], v[176:179], v[0:15]
    ds_read_b128 v[220:223], v105 offset:29696
    v_exp_f32 v245, v245
    v_add_f32 v110, v110, v234
    v_add_f32 v111, v111, v235
    v_add_f32 v110, v110, v236
    s_waitcnt lgkmcnt(6)
    v_mfma_f32_32x32x16_bf16 v[16:31], v[196:199], v[176:179], v[16:31]
    ds_read_b128 v[192:195], v105 offset:18432
    v_exp_f32 v246, v246
    v_cvt_pk_bf16_f32 v186, v244, v245
    v_max3_f32 v113, v64, v65, v66
    v_max3_f32 v114, v80, v81, v82
    s_waitcnt lgkmcnt(6)
    v_mfma_f32_32x32x16_bf16 v[32:47], v[200:203], v[176:179], v[32:47]
    ds_read_b128 v[196:199], v105 offset:22528
    v_exp_f32 v247, v247
    v_max3_f32 v113, v113, v67, v68
    v_add_f32 v111, v111, v237
    s_waitcnt lgkmcnt(6)
    v_mfma_f32_32x32x16_bf16 v[48:63], v[204:207], v[176:179], v[48:63]
    ds_read_b128 v[200:203], v105 offset:26624
    v_exp_f32 v248, v248
    v_cvt_pk_bf16_f32 v187, v246, v247
    v_max3_f32 v114, v114, v83, v84
    s_waitcnt lgkmcnt(6)
    v_mfma_f32_32x32x16_bf16 v[0:15], v[208:211], v[180:183], v[0:15]
    ds_read_b128 v[204:207], v105 offset:30720
    v_exp_f32 v249, v249
    v_max3_f32 v113, v113, v69, v70
    v_add_f32 v110, v110, v238
    v_add_f32 v111, v111, v239
    s_waitcnt lgkmcnt(6)
    v_mfma_f32_32x32x16_bf16 v[16:31], v[212:215], v[180:183], v[16:31]
    ds_read_b128 v[208:211], v105 offset:19456
    v_exp_f32 v250, v250
    v_cvt_pk_bf16_f32 v188, v248, v249
    v_max3_f32 v114, v114, v85, v86
    v_max3_f32 v113, v113, v71, v72
    s_waitcnt lgkmcnt(6)
    v_mfma_f32_32x32x16_bf16 v[32:47], v[216:219], v[180:183], v[32:47]
    ds_read_b128 v[212:215], v105 offset:23552
    v_exp_f32 v251, v251
    v_max3_f32 v114, v114, v87, v88
    s_waitcnt lgkmcnt(6)
    v_mfma_f32_32x32x16_bf16 v[48:63], v[220:223], v[180:183], v[48:63]
    ds_read_b128 v[216:219], v105 offset:27648
    v_exp_f32 v252, v252
    v_cvt_pk_bf16_f32 v189, v250, v251
    v_max3_f32 v113, v113, v73, v74
    v_add_f32 v110, v110, v240
    s_waitcnt lgkmcnt(6)
    v_mfma_f32_32x32x16_bf16 v[0:15], v[192:195], v[184:187], v[0:15]
    ds_read_b128 v[220:223], v105 offset:31744
    v_exp_f32 v253, v253
    v_max3_f32 v114, v114, v89, v90
    v_add_f32 v111, v111, v241
    s_waitcnt lgkmcnt(6)
    v_mfma_f32_32x32x16_bf16 v[16:31], v[196:199], v[184:187], v[16:31]
    v_add_u32 v105, s32, v117
    s_sub_u32 s32, s32, 32768
    s_cselect_b32 s32, 131072, s32
    ds_read_b128 v[192:195], v105 offset:0
    v_exp_f32 v254, v254
    v_cvt_pk_bf16_f32 v190, v252, v253
    v_max3_f32 v113, v113, v75, v76
    v_add_f32 v110, v110, v242
    s_waitcnt lgkmcnt(6)
    v_mfma_f32_32x32x16_bf16 v[32:47], v[200:203], v[184:187], v[32:47]
    ds_read_b128 v[196:199], v105 offset:8192
    v_exp_f32 v255, v255
    v_max3_f32 v114, v114, v91, v92
    v_max3_f32 v113, v113, v77, v78
    s_waitcnt lgkmcnt(6)
    v_mfma_f32_32x32x16_bf16 v[48:63], v[204:207], v[184:187], v[48:63]
    ds_read_b128 v[200:203], v105 offset:1024
    v_cvt_pk_bf16_f32 v191, v254, v255
    v_max3_f32 v114, v114, v93, v94
    v_add_f32 v111, v111, v243
    v_add_f32 v110, v110, v244
    v_add_f32 v111, v111, v245
    s_waitcnt lgkmcnt(6)
    v_mfma_f32_32x32x16_bf16 v[0:15], v[208:211], v[188:191], v[0:15]
    ds_read_b128 v[204:207], v105 offset:9216
    v_max3_f32 v113, v113, v79, v95
    v_add_f32 v110, v110, v246
    v_add_f32 v111, v111, v247
    v_add_f32 v110, v110, v248
    s_waitcnt lgkmcnt(6)
    v_mfma_f32_32x32x16_bf16 v[16:31], v[212:215], v[188:191], v[16:31]
    ds_read_b128 v[208:211], v105 offset:2048
    v_max_f32 v113, v113, v114
    v_add_f32 v111, v111, v249
    v_add_f32 v110, v110, v250
    v_add_f32 v111, v111, v251
    v_add_f32 v110, v110, v252
    s_waitcnt lgkmcnt(6)
    v_mfma_f32_32x32x16_bf16 v[32:47], v[216:219], v[188:191], v[32:47]
    ds_read_b128 v[212:215], v105 offset:10240
    v_cmp_lt_f32 vcc, 0x42200000, v113
    v_add_f32 v111, v111, v253
    v_add_f32 v110, v110, v254
    v_add_f32 v111, v111, v255
    s_waitcnt lgkmcnt(6)
    v_mfma_f32_32x32x16_bf16 v[48:63], v[220:223], v[188:191], v[48:63]
    ds_read_b128 v[216:219], v105 offset:3072
    s_cbranch_vccnz k1f_kernel_O_slow
k1f_kernel_O_ret:
    s_branch k1f_kernel_E
k1f_kernel_Om:
    s_waitcnt lgkmcnt(6)
    v_mfma_f32_32x32x16_bf16 v[64:79], v[192:195], v[144:147], v[128:143]
    ds_read_b128 v[220:223], v104 offset:11264
    v_exp_f32 v224, v224
    v_exp_f32 v225, v225
    s_waitcnt lgkmcnt(6)
    v_mfma_f32_32x32x16_bf16 v[80:95], v[196:199], v[144:147], v[128:143]
    s_waitcnt vmcnt(20)
    s_barrier
    ds_read_b128 v[192:195], v104 offset:4096
    s_waitcnt lgkmcnt(6)
    v_mfma_f32_32x32x16_bf16 v[64:79], v[200:203], v[148:151], v[64:79]
    ds_read_b128 v[196:199], v104 offset:12288
    s_add_u32 s30, s30, 1
    s_cmp_eq_u32 s31, 0
    s_cbranch_scc1 k1f_kernel_s3
    s_mov_b32 m0, s33
    s_sub_u32 s83, s81, 16384
    buffer_load_dwordx4 v117, s[72:75], s81 offen offset:0 sc1 lds
    buffer_load_dwordx4 v117, s[72:75], s81 offen offset:1024 sc1 lds
    buffer_load_dwordx4 v117, s[72:75], s81 offen offset:2048 sc1 lds
    buffer_load_dwordx4 v117, s[72:75], s81 offen offset:3072 sc1 lds
    s_mov_b32 m0, s80
    s_add_u32 s81, s81, 32768
    buffer_load_dwordx4 v117, s[72:75], s83 offen offset:0 sc1 lds
    buffer_load_dwordx4 v117, s[72:75], s83 offen offset:1024 sc1 lds
    buffer_load_dwordx4 v117, s[72:75], s83 offen offset:2048 sc1 lds
    buffer_load_dwordx4 v117, s[72:75], s83 offen offset:3072 sc1 lds
    s_add_u32 s80, s33, 16384
    s_sub_u32 s33, s33, 32768
    s_cselect_b32 s33, s40, s33
k1f_kernel_s3:
    s_waitcnt lgkmcnt(6)
    v_mfma_f32_32x32x16_bf16 v[80:95], v[204:207], v[148:151], v[80:95]
    ds_read_b128 v[200:203], v104 offset:5120
    v_exp_f32 v226, v226
    v_exp_f32 v227, v227
    v_cvt_pk_bf16_f32 v176, v224, v225
    s_waitcnt lgkmcnt(6)
    v_mfma_f32_32x32x16_bf16 v[64:79], v[208:211], v[152:155], v[64:79]
    ds_read_b128 v[204:207], v104 offset:13312
    v_exp_f32 v228, v228
    v_cvt_pk_bf16_f32 v177, v226, v227
    v_add_f32 v110, v110, v224
    v_add_f32 v111, v111, v225
    s_waitcnt lgkmcnt(6)
    v_mfma_f32_32x32x16_bf16 v[80:95], v[212:215], v[152:155], v[80:95]
    ds_read_b128 v[208:211], v104 offset:6144
    v_exp_f32 v229, v229
    v_exp_f32 v230, v230
    v_add_f32 v110, v110, v226
    s_waitcnt lgkmcnt(6)
    v_mfma_f32_32x32x16_bf16 v[64:79], v[216:219], v[156:159], v[64:79]
    ds_read_b128 v[212:215], v104 offset:14336
    v_exp_f32 v231, v231
    v_cvt_pk_bf16_f32 v178, v228, v229
    v_add_f32 v111, v111, v227
    v_add_f32 v110, v110, v228
    s_waitcnt lgkmcnt(6)
    v_mfma_f32_32x32x16_bf16 v[80:95], v[220:223], v[156:159], v[80:95]
    ds_read_b128 v[216:219], v104 offset:7168
    v_exp_f32 v232, v232
    v_exp_f32 v233, v233
    v_cvt_pk_bf16_f32 v179, v230, v231
    s_waitcnt lgkmcnt(6)
    v_mfma_f32_32x32x16_bf16 v[64:79], v[192:195], v[160:163], v[64:79]
    ds_read_b128 v[220:223], v104 offset:15360
    v_exp_f32 v234, v234
    v_cvt_pk_bf16_f32 v180, v232, v233
    v_add_f32 v111, v111, v229
    v_add_f32 v110, v110, v230
    s_waitcnt lgkmcnt(6)
    v_mfma_f32_32x32x16_bf16 v[80:95], v[196:199], v[160:163], v[80:95]
    ds_read_b128 v[192:195], v105 offset:16384
    v_exp_f32 v235, v235
    v_exp_f32 v236, v236
    v_add_f32 v111, v111, v231
    s_waitcnt lgkmcnt(6)
    v_mfma_f32_32x32x16_bf16 v[64:79], v[200:203], v[164:167], v[64:79]
    ds_read_b128 v[196:199], v105 offset:20480
    v_exp_f32 v237, v237
    v_cvt_pk_bf16_f32 v181, v234, v235
    v_add_f32 v110, v110, v232
    v_add_f32 v111, v111, v233
    s_waitcnt lgkmcnt(6)
    v_mfma_f32_32x32x16_bf16 v[80:95], v[204:207], v[164:167], v[80:95]
    ds_read_b128 v[200:203], v105 offset:24576
    v_exp_f32 v238, v238
    v_exp_f32 v239, v239
    v_cvt_pk_bf16_f32 v182, v236, v237
    s_waitcnt lgkmcnt(6)
    v_mfma_f32_32x32x16_bf16 v[64:79], v[208:211], v[168:171], v[64:79]
    ds_read_b128 v[204:207], v105 offset:28672
    v_exp_f32 v240, v240
    v_cvt_pk_bf16_f32 v183, v238, v239
    v_add_f32 v110, v110, v234
    v_add_f32 v111, v111, v235
    s_waitcnt lgkmcnt(6)
    v_mfma_f32_32x32x16_bf16 v[80:95], v[212:215], v[168:171], v[80:95]
    ds_read_b128 v[208:211], v105 offset:17408
    v_exp_f32 v241, v241
    v_exp_f32 v242, v242
    v_add_f32 v110, v110, v236
    s_waitcnt lgkmcnt(6)
    v_mfma_f32_32x32x16_bf16 v[64:79], v[216:219], v[172:175], v[64:79]
    ds_read_b128 v[212:215], v105 offset:21504
    v_exp_f32 v243, v243
    v_cvt_pk_bf16_f32 v184, v240, v241
    v_add_f32 v111, v111, v237
    v_add_f32 v110, v110, v238
    s_waitcnt lgkmcnt(6)
    v_mfma_f32_32x32x16_bf16 v[80:95], v[220:223], v[172:175], v[80:95]
    ds_read_b128 v[216:219], v105 offset:25600
    v_exp_f32 v244, v244
    v_cvt_pk_bf16_f32 v185, v242, v243
    v_add_f32 v111, v111, v239
    v_add_f32 v110, v110, v240
    s_waitcnt lgkmcnt(6)
    v_mfma_f32_32x32x16_bf16 v[0:15], v[192:195], v[176:179], v[0:15]
    ds_read_b128 v[220:223], v105 offset:29696
    v_exp_f32 v245, v245
    v_add_f32 v111, v111, v241
    v_add_f32 v110, v110, v242
    v_add_f32 v111, v111, v243
    s_waitcnt lgkmcnt(6)
    v_mfma_f32_32x32x16_bf16 v[16:31], v[196:199], v[176:179], v[16:31]
    ds_read_b128 v[192:195], v105 offset:18432
    v_exp_f32 v246, v246
    v_cvt_pk_bf16_f32 v186, v244, v245
    v_cmp_gt_i32_e64 s[8:9], 0, v107
    v_cmp_gt_i32_e64 s[10:11], 1, v107
    v_cmp_gt_i32_e64 s[12:13], 2, v107
    v_cmp_gt_i32_e64 s[14:15], 3, v107
    v_cndmask_b32_e64 v64, v64, v122, s[8:9]
    v_cndmask_b32_e64 v65, v65, v122, s[10:11]
    v_add_f32 v110, v110, v244
    v_add_f32 v111, v111, v245
    s_waitcnt lgkmcnt(6)
    v_mfma_f32_32x32x16_bf16 v[32:47], v[200:203], v[176:179], v[32:47]
    ds_read_b128 v[196:199], v105 offset:22528
    v_exp_f32 v247, v247
    v_cndmask_b32_e64 v66, v66, v122, s[12:13]
    v_cndmask_b32_e64 v67, v67, v122, s[14:15]
    v_cmp_gt_i32_e64 s[8:9], 8, v107
    v_cmp_gt_i32_e64 s[10:11], 9, v107
    v_cmp_gt_i32_e64 s[12:13], 10, v107
    v_cmp_gt_i32_e64 s[14:15], 11, v107
    v_add_f32 v110, v110, v246
    s_waitcnt lgkmcnt(6)
    v_mfma_f32_32x32x16_bf16 v[48:63], v[204:207], v[176:179], v[48:63]
    ds_read_b128 v[200:203], v105 offset:26624
    v_exp_f32 v248, v248
    v_cvt_pk_bf16_f32 v187, v246, v247
    v_cndmask_b32_e64 v68, v68, v122, s[8:9]
    v_cndmask_b32_e64 v69, v69, v122, s[10:11]
    v_cndmask_b32_e64 v70, v70, v122, s[12:13]
    v_cndmask_b32_e64 v71, v71, v122, s[14:15]
    v_cmp_gt_i32_e64 s[8:9], 16, v107
    v_cmp_gt_i32_e64 s[10:11], 17, v107
    v_add_f32 v111, v111, v247
    s_waitcnt lgkmcnt(6)
    v_mfma_f32_32x32x16_bf16 v[0:15], v[208:211], v[180:183], v[0:15]
    ds_read_b128 v[204:207], v105 offset:30720
    v_exp_f32 v249, v249
    v_cmp_gt_i32_e64 s[12:13], 18, v107
    v_cmp_gt_i32_e64 s[14:15], 19, v107
    v_cndmask_b32_e64 v72, v72, v122, s[8:9]
    v_cndmask_b32_e64 v73, v73, v122, s[10:11]
    v_cndmask_b32_e64 v74, v74, v122, s[12:13]
    v_cndmask_b32_e64 v75, v75, v122, s[14:15]
    v_add_f32 v110, v110, v248
    s_waitcnt lgkmcnt(6)
    v_mfma_f32_32x32x16_bf16 v[16:31], v[212:215], v[180:183], v[16:31]
    ds_read_b128 v[208:211], v105 offset:19456
    v_exp_f32 v250, v250
    v_cvt_pk_bf16_f32 v188, v248, v249
    v_cmp_gt_i32_e64 s[8:9], 24, v107
    v_cmp_gt_i32_e64 s[10:11], 25, v107
    v_cmp_gt_i32_e64 s[12:13], 26, v107
    v_cmp_gt_i32_e64 s[14:15], 27, v107
    v_cndmask_b32_e64 v76, v76, v122, s[8:9]
    v_add_f32 v111, v111, v249
    s_waitcnt lgkmcnt(6)
    v_mfma_f32_32x32x16_bf16 v[32:47], v[216:219], v[180:183], v[32:47]
    ds_read_b128 v[212:215], v105 offset:23552
    v_exp_f32 v251, v251
    v_cndmask_b32_e64 v77, v77, v122, s[10:11]
    v_cndmask_b32_e64 v78, v78, v122, s[12:13]
    v_cndmask_b32_e64 v79, v79, v122, s[14:15]
    v_cmp_gt_i32_e64 s[8:9], 32, v107
    v_cmp_gt_i32_e64 s[10:11], 33, v107
    v_cmp_gt_i32_e64 s[12:13], 34, v107
    v_add_f32 v110, v110, v250
    s_waitcnt lgkmcnt(6)
    v_mfma_f32_32x32x16_bf16 v[48:63], v[220:223], v[180:183], v[48:63]
    ds_read_b128 v[216:219], v105 offset:27648
    v_exp_f32 v252, v252
    v_cvt_pk_bf16_f32 v189, v250, v251
    v_cmp_gt_i32_e64 s[14:15], 35, v107
    v_cndmask_b32_e64 v80, v80, v122, s[8:9]
    v_cndmask_b32_e64 v81, v81, v122, s[10:11]
    v_cndmask_b32_e64 v82, v82, v122, s[12:13]
    v_cndmask_b32_e64 v83, v83, v122, s[14:15]
    v_cmp_gt_i32_e64 s[8:9], 40, v107
    v_add_f32 v111, v111, v251
    s_waitcnt lgkmcnt(6)
    v_mfma_f32_32x32x16_bf16 v[0:15], v[192:195], v[184:187], v[0:15]
    ds_read_b128 v[220:223], v105 offset:31744
    v_exp_f32 v253, v253
    v_cmp_gt_i32_e64 s[10:11], 41, v107
    v_cmp_gt_i32_e64 s[12:13], 42, v107
    v_cmp_gt_i32_e64 s[14:15], 43, v107
    v_cndmask_b32_e64 v84, v84, v122, s[8:9]
    v_cndmask_b32_e64 v85, v85, v122, s[10:11]
    v_cndmask_b32_e64 v86, v86, v122, s[12:13]
    v_add_f32 v110, v110, v252
    s_waitcnt lgkmcnt(6)
    v_mfma_f32_32x32x16_bf16 v[16:31], v[196:199], v[184:187], v[16:31]
    v_exp_f32 v254, v254
    v_cvt_pk_bf16_f32 v190, v252, v253
    v_cndmask_b32_e64 v87, v87, v122, s[14:15]
    v_cmp_gt_i32_e64 s[8:9], 48, v107
    v_cmp_gt_i32_e64 s[10:11], 49, v107
    v_cmp_gt_i32_e64 s[12:13], 50, v107
    v_cmp_gt_i32_e64 s[14:15], 51, v107
    v_cndmask_b32_e64 v88, v88, v122, s[8:9]
    v_add_f32 v111, v111, v253
    s_waitcnt lgkmcnt(5)
    v_mfma_f32_32x32x16_bf16 v[32:47], v[200:203], v[184:187], v[32:47]
    v_exp_f32 v255, v255
    v_cndmask_b32_e64 v89, v89, v122, s[10:11]
    v_cndmask_b32_e64 v90, v90, v122, s[12:13]
    v_cndmask_b32_e64 v91, v91, v122, s[14:15]
    v_cmp_gt_i32_e64 s[8:9], 56, v107
    v_cmp_gt_i32_e64 s[10:11], 57, v107
    s_waitcnt lgkmcnt(4)
    v_mfma_f32_32x32x16_bf16 v[48:63], v[204:207], v[184:187], v[48:63]
    v_cvt_pk_bf16_f32 v191, v254, v255
    v_cmp_gt_i32_e64 s[12:13], 58, v107
    v_cmp_gt_i32_e64 s[14:15], 59, v107
    v_cndmask_b32_e64 v92, v92, v122, s[8:9]
    v_cndmask_b32_e64 v93, v93, v122, s[10:11]
    v_cndmask_b32_e64 v94, v94, v122, s[12:13]
    v_cndmask_b32_e64 v95, v95, v122, s[14:15]
    s_waitcnt lgkmcnt(3)
    v_mfma_f32_32x32x16_bf16 v[0:15], v[208:211], v[188:191], v[0:15]
    v_max3_f32 v113, v64, v65, v66
    v_max3_f32 v114, v80, v81, v82
    v_max3_f32 v113, v113, v67, v68
    v_max3_f32 v114, v114, v83, v84
    v_max3_f32 v113, v113, v69, v70
    v_max3_f32 v114, v114, v85, v86
    s_waitcnt lgkmcnt(2)
    v_mfma_f32_32x32x16_bf16 v[16:31], v[212:215], v[188:191], v[16:31]
    v_max3_f32 v113, v113, v71, v72
    v_max3_f32 v114, v114, v87, v88
    v_max3_f32 v113, v113, v73, v74
    v_max3_f32 v114, v114, v89, v90
    v_max3_f32 v113, v113, v75, v76
    v_max3_f32 v114, v114, v91, v92
    s_waitcnt lgkmcnt(1)
    v_mfma_f32_32x32x16_bf16 v[32:47], v[216:219], v[188:191], v[32:47]
    v_max3_f32 v113, v113, v77, v78
    v_max3_f32 v114, v114, v93, v94
    v_max3_f32 v113, v113, v79, v95
    v_max_f32 v113, v113, v114
    v_cmp_lt_f32 vcc, 0x42200000, v113
    v_add_f32 v110, v110, v254
    v_add_f32 v111, v111, v255
    s_waitcnt lgkmcnt(0)
    v_mfma_f32_32x32x16_bf16 v[48:63], v[220:223], v[188:191], v[48:63]
    s_cbranch_vccnz k1f_kernel_Om_slow
k1f_kernel_Om_ret:
k1f_kernel_Ef:
    s_waitcnt vmcnt(20)
    s_barrier
    s_add_u32 s30, s30, 1
    s_cmp_eq_u32 s31, 0
    s_cbranch_scc1 k1f_kernel_s4
    s_mov_b32 m0, s33
    s_sub_u32 s83, s81, 16384
    buffer_load_dwordx4 v117, s[72:75], s81 offen offset:0 sc1 lds
    buffer_load_dwordx4 v117, s[72:75], s81 offen offset:1024 sc1 lds
    buffer_load_dwordx4 v117, s[72:75], s81 offen offset:2048 sc1 lds
    buffer_load_dwordx4 v117, s[72:75], s81 offen offset:3072 sc1 lds
    s_mov_b32 m0, s80
    s_add_u32 s81, s81, 32768
    buffer_load_dwordx4 v117, s[72:75], s83 offen offset:0 sc1 lds
    buffer_load_dwordx4 v117, s[72:75], s83 offen offset:1024 sc1 lds
    buffer_load_dwordx4 v117, s[72:75], s83 offen offset:2048 sc1 lds
    buffer_load_dwordx4 v117, s[72:75], s83 offen offset:3072 sc1 lds
    s_add_u32 s80, s33, 16384
    s_sub_u32 s33, s33, 32768
    s_cselect_b32 s33, s40, s33
k1f_kernel_s4:
    ds_read_b128 v[192:195], v104 offset:16384
    ds_read_b128 v[196:199], v104 offset:20480
    ds_read_b128 v[200:203], v104 offset:24576
    ds_read_b128 v[204:207], v104 offset:28672
    ds_read_b128 v[208:211], v104 offset:17408
    ds_read_b128 v[212:215], v104 offset:21504
    ds_read_b128 v[216:219], v104 offset:25600
    v_exp_f32 v64, v64
    v_exp_f32 v65, v65
    v_exp_f32 v66, v66
    v_add_f32 v110, v110, v64
    v_exp_f32 v67, v67
    v_add_f32 v111, v111, v65
    v_cvt_pk_bf16_f32 v64, v64, v65
    v_exp_f32 v68, v68
    v_add_f32 v110, v110, v66
    v_exp_f32 v69, v69
    v_add_f32 v111, v111, v67
    v_cvt_pk_bf16_f32 v65, v66, v67
    v_exp_f32 v70, v70
    v_add_f32 v110, v110, v68
    v_exp_f32 v71, v71
    v_add_f32 v111, v111, v69
    v_cvt_pk_bf16_f32 v66, v68, v69
    v_add_f32 v110, v110, v70
    v_add_f32 v111, v111, v71
    v_cvt_pk_bf16_f32 v67, v70, v71
    s_waitcnt lgkmcnt(6)
    s_nop 0
    v_mfma_f32_32x32x16_bf16 v[0:15], v[192:195], v[64:67], v[0:15]
    ds_read_b128 v[220:223], v104 offset:29696
    v_exp_f32 v72, v72
    v_exp_f32 v73, v73
    v_exp_f32 v74, v74
    v_add_f32 v110, v110, v72
    v_exp_f32 v75, v75
    s_waitcnt lgkmcnt(6)
    v_mfma_f32_32x32x16_bf16 v[16:31], v[196:199], v[64:67], v[16:31]
    ds_read_b128 v[192:195], v104 offset:18432
    v_add_f32 v111, v111, v73
    v_cvt_pk_bf16_f32 v72, v72, v73
    v_exp_f32 v76, v76
    v_add_f32 v110, v110, v74
    v_exp_f32 v77, v77
    s_waitcnt lgkmcnt(6)
    v_mfma_f32_32x32x16_bf16 v[32:47], v[200:203], v[64:67], v[32:47]
    ds_read_b128 v[196:199], v104 offset:22528
    v_add_f32 v111, v111, v75
    v_cvt_pk_bf16_f32 v73, v74, v75
    v_exp_f32 v78, v78
    v_add_f32 v110, v110, v76
    v_exp_f32 v79, v79
    s_waitcnt lgkmcnt(6)
    v_mfma_f32_32x32x16_bf16 v[48:63], v[204:207], v[64:67], v[48:63]
    ds_read_b128 v[200:203], v104 offset:26624
    v_add_f32 v111, v111, v77
    v_cvt_pk_bf16_f32 v74, v76, v77
    v_add_f32 v110, v110, v78
    v_add_f32 v111, v111, v79
    v_cvt_pk_bf16_f32 v75, v78, v79
    s_waitcnt lgkmcnt(6)
    s_nop 0
    v_mfma_f32_32x32x16_bf16 v[0:15], v[208:211], v[72:75], v[0:15]
    ds_read_b128 v[204:207], v104 offset:30720
    v_exp_f32 v80, v80
    v_exp_f32 v81, v81
    v_exp_f32 v82, v82
    v_add_f32 v110, v110, v80
    v_exp_f32 v83, v83
    s_waitcnt lgkmcnt(6)
    v_mfma_f32_32x32x16_bf16 v[16:31], v[212:215], v[72:75], v[16:31]
    ds_read_b128 v[208:211], v104 offset:19456
    v_add_f32 v111, v111, v81
    v_cvt_pk_bf16_f32 v80, v80, v81
    v_exp_f32 v84, v84
    v_add_f32 v110, v110, v82
    v_exp_f32 v85, v85
    s_waitcnt lgkmcnt(6)
    v_mfma_f32_32x32x16_bf16 v[32:47], v[216:219], v[72:75], v[32:47]
    ds_read_b128 v[212:215], v104 offset:23552
    v_add_f32 v111, v111, v83
    v_cvt_pk_bf16_f32 v81, v82, v83
    v_exp_f32 v86, v86
    v_add_f32 v110, v110, v84
    v_exp_f32 v87, v87
    s_waitcnt lgkmcnt(6)
    v_mfma_f32_32x32x16_bf16 v[48:63], v[220:223], v[72:75], v[48:63]
    ds_read_b128 v[216:219], v104 offset:27648
    v_add_f32 v111, v111, v85
    v_cvt_pk_bf16_f32 v82, v84, v85
    v_add_f32 v110, v110, v86
    v_add_f32 v111, v111, v87
    v_cvt_pk_bf16_f32 v83, v86, v87
    s_waitcnt lgkmcnt(6)
    s_nop 0
    v_mfma_f32_32x32x16_bf16 v[0:15], v[192:195], v[80:83], v[0:15]
    ds_read_b128 v[220:223], v104 offset:31744
    v_exp_f32 v88, v88
    v_exp_f32 v89, v89
    v_exp_f32 v90, v90
    v_add_f32 v110, v110, v88
    v_exp_f32 v91, v91
    s_waitcnt lgkmcnt(6)
    v_mfma_f32_32x32x16_bf16 v[16:31], v[196:199], v[80:83], v[16:31]
    v_add_f32 v111, v111, v89
    v_cvt_pk_bf16_f32 v88, v88, v89
    v_exp_f32 v92, v92
    v_add_f32 v110, v110, v90
    v_exp_f32 v93, v93
    s_waitcnt lgkmcnt(5)
    v_mfma_f32_32x32x16_bf16 v[32:47], v[200:203], v[80:83], v[32:47]
    v_add_f32 v111, v111, v91
    v_cvt_pk_bf16_f32 v89, v90, v91
    v_exp_f32 v94, v94
    v_add_f32 v110, v110, v92
    v_exp_f32 v95, v95
    s_waitcnt lgkmcnt(4)
    v_mfma_f32_32x32x16_bf16 v[48:63], v[204:207], v[80:83], v[48:63]
    v_add_f32 v111, v111, v93
    v_cvt_pk_bf16_f32 v90, v92, v93
    v_add_f32 v110, v110, v94
    v_add_f32 v111, v111, v95
    v_cvt_pk_bf16_f32 v91, v94, v95
    s_waitcnt lgkmcnt(3)
    s_nop 0
    v_mfma_f32_32x32x16_bf16 v[0:15], v[208:211], v[88:91], v[0:15]
    s_waitcnt lgkmcnt(2)
    v_mfma_f32_32x32x16_bf16 v[16:31], v[212:215], v[88:91], v[16:31]
    s_waitcnt lgkmcnt(1)
    v_mfma_f32_32x32x16_bf16 v[32:47], v[216:219], v[88:91], v[32:47]
    s_waitcnt lgkmcnt(0)
    v_mfma_f32_32x32x16_bf16 v[48:63], v[220:223], v[88:91], v[48:63]
    s_cmp_ge_u32 s30, s28
    s_cbranch_scc1 k1f_kernel_epi
    s_waitcnt vmcnt(20)
    s_barrier
    s_add_u32 s30, s30, 1
    s_cmp_eq_u32 s31, 0
    s_cbranch_scc1 k1f_kernel_s5
    s_mov_b32 m0, s33
    s_sub_u32 s83, s81, 16384
    buffer_load_dwordx4 v117, s[72:75], s81 offen offset:0 sc1 lds
    buffer_load_dwordx4 v117, s[72:75], s81 offen offset:1024 sc1 lds
    buffer_load_dwordx4 v117, s[72:75], s81 offen offset:2048 sc1 lds
    buffer_load_dwordx4 v117, s[72:75], s81 offen offset:3072 sc1 lds
    s_mov_b32 m0, s80
    s_add_u32 s81, s81, 32768
    buffer_load_dwordx4 v117, s[72:75], s83 offen offset:0 sc1 lds
    buffer_load_dwordx4 v117, s[72:75], s83 offen offset:1024 sc1 lds
    buffer_load_dwordx4 v117, s[72:75], s83 offen offset:2048 sc1 lds
    buffer_load_dwordx4 v117, s[72:75], s83 offen offset:3072 sc1 lds
    s_add_u32 s80, s33, 16384
    s_sub_u32 s33, s33, 32768
    s_cselect_b32 s33, s40, s33
k1f_kernel_s5:
k1f_kernel_epi:
    s_setprio 0
    s_load_dwordx2 s[34:35], s[0:1], 0
    s_load_dwordx2 s[38:39], s[0:1], 72
    s_lshr_b32 s6, s63, 1
    s_lshl_b32 s6, s6, 9
    s_lshl_b32 s7, s4, 4
    s_add_u32 s6, s6, s7
    s_and_b32 s7, s63, 1
    s_lshl_b32 s7, s7, 3
    s_add_u32 s6, s6, s7
    s_add_u32 s50, s6, 0x3b98000
    v_add_f32 v110, v110, v111
    v_mov_b32 v115, v110
    s_nop 1
    v_permlane32_swap_b32 v110, v115
    v_add_f32 v110, v110, v115
    v_rcp_f32 v110, v110
    s_nop 7
    s_add_u32 s55, s82, 4096
    v_mul_f32 v0, v0, v110
    v_mul_f32 v1, v1, v110
    v_mul_f32 v2, v2, v110
    v_mul_f32 v3, v3, v110
    v_mul_f32 v4, v4, v110
    v_mul_f32 v5, v5, v110
    v_mul_f32 v6, v6, v110
    v_mul_f32 v7, v7, v110
    v_cvt_pk_bf16_f32 v0, v0, v1
    v_cvt_pk_bf16_f32 v1, v2, v3
    v_cvt_pk_bf16_f32 v2, v4, v5
    v_cvt_pk_bf16_f32 v3, v6, v7
    buffer_store_dwordx4 v[0:3], v117, s[24:27], s82 offen offset:0 sc1
    v_mul_f32 v8, v8, v110
    v_mul_f32 v9, v9, v110
    v_mul_f32 v10, v10, v110
    v_mul_f32 v11, v11, v110
    v_mul_f32 v12, v12, v110
    v_mul_f32 v13, v13, v110
    v_mul_f32 v14, v14, v110
    v_mul_f32 v15, v15, v110
    v_cvt_pk_bf16_f32 v8, v8, v9
    v_cvt_pk_bf16_f32 v9, v10, v11
    v_cvt_pk_bf16_f32 v10, v12, v13
    v_cvt_pk_bf16_f32 v11, v14, v15
    buffer_store_dwordx4 v[8:11], v117, s[24:27], s82 offen offset:1024 sc1
    v_mul_f32 v16, v16, v110
    v_mul_f32 v17, v17, v110
    v_mul_f32 v18, v18, v110
    v_mul_f32 v19, v19, v110
    v_mul_f32 v20, v20, v110
    v_mul_f32 v21, v21, v110
    v_mul_f32 v22, v22, v110
    v_mul_f32 v23, v23, v110
    v_cvt_pk_bf16_f32 v16, v16, v17
    v_cvt_pk_bf16_f32 v17, v18, v19
    v_cvt_pk_bf16_f32 v18, v20, v21
    v_cvt_pk_bf16_f32 v19, v22, v23
    buffer_store_dwordx4 v[16:19], v117, s[24:27], s82 offen offset:2048 sc1
    v_mul_f32 v24, v24, v110
    v_mul_f32 v25, v25, v110
    v_mul_f32 v26, v26, v110
    v_mul_f32 v27, v27, v110
    v_mul_f32 v28, v28, v110
    v_mul_f32 v29, v29, v110
    v_mul_f32 v30, v30, v110
    v_mul_f32 v31, v31, v110
    v_cvt_pk_bf16_f32 v24, v24, v25
    v_cvt_pk_bf16_f32 v25, v26, v27
    v_cvt_pk_bf16_f32 v26, v28, v29
    v_cvt_pk_bf16_f32 v27, v30, v31
    buffer_store_dwordx4 v[24:27], v117, s[24:27], s82 offen offset:3072 sc1
    v_mul_f32 v32, v32, v110
    v_mul_f32 v33, v33, v110
    v_mul_f32 v34, v34, v110
    v_mul_f32 v35, v35, v110
    v_mul_f32 v36, v36, v110
    v_mul_f32 v37, v37, v110
    v_mul_f32 v38, v38, v110
    v_mul_f32 v39, v39, v110
    v_cvt_pk_bf16_f32 v32, v32, v33
    v_cvt_pk_bf16_f32 v33, v34, v35
    v_cvt_pk_bf16_f32 v34, v36, v37
    v_cvt_pk_bf16_f32 v35, v38, v39
    buffer_store_dwordx4 v[32:35], v117, s[24:27], s55 offen offset:0 sc1
    v_mul_f32 v40, v40, v110
    v_mul_f32 v41, v41, v110
    v_mul_f32 v42, v42, v110
    v_mul_f32 v43, v43, v110
    v_mul_f32 v44, v44, v110
    v_mul_f32 v45, v45, v110
    v_mul_f32 v46, v46, v110
    v_mul_f32 v47, v47, v110
    v_cvt_pk_bf16_f32 v40, v40, v41
    v_cvt_pk_bf16_f32 v41, v42, v43
    v_cvt_pk_bf16_f32 v42, v44, v45
    v_cvt_pk_bf16_f32 v43, v46, v47
    buffer_store_dwordx4 v[40:43], v117, s[24:27], s55 offen offset:1024 sc1
    v_mul_f32 v48, v48, v110
    v_mul_f32 v49, v49, v110
    v_mul_f32 v50, v50, v110
    v_mul_f32 v51, v51, v110
    v_mul_f32 v52, v52, v110
    v_mul_f32 v53, v53, v110
    v_mul_f32 v54, v54, v110
    v_mul_f32 v55, v55, v110
    v_cvt_pk_bf16_f32 v48, v48, v49
    v_cvt_pk_bf16_f32 v49, v50, v51
    v_cvt_pk_bf16_f32 v50, v52, v53
    v_cvt_pk_bf16_f32 v51, v54, v55
    buffer_store_dwordx4 v[48:51], v117, s[24:27], s55 offen offset:2048 sc1
    v_mul_f32 v56, v56, v110
    v_mul_f32 v57, v57, v110
    v_mul_f32 v58, v58, v110
    v_mul_f32 v59, v59, v110
    v_mul_f32 v60, v60, v110
    v_mul_f32 v61, v61, v110
    v_mul_f32 v62, v62, v110
    v_mul_f32 v63, v63, v110
    v_cvt_pk_bf16_f32 v56, v56, v57
    v_cvt_pk_bf16_f32 v57, v58, v59
    v_cvt_pk_bf16_f32 v58, v60, v61
    v_cvt_pk_bf16_f32 v59, v62, v63
    buffer_store_dwordx4 v[56:59], v117, s[24:27], s55 offen offset:3072 sc1
    s_cmp_eq_u32 s31, 0
    s_cbranch_scc1 k1f_kernel_ta
    s_sub_u32 s6, s2, 0
    s_cmp_ge_u32 s6, 120
    s_cbranch_scc1 k1f_kernel_prod
    s_lshl_b32 s6, s6, 2
    s_and_b32 s7, s3, 3
    s_add_u32 s14, s6, s7
    v_lshrrev_b32 v140, 4, v117
    s_lshr_b32 s12, s14, 1
    s_and_b32 s13, s14, 1
    s_mov_b32 s20, s66
    s_mov_b32 s21, s67
    s_mov_b32 s22, 4194304
    s_mov_b32 s23, 0x20000
    s_mov_b32 s11, 1024
    s_mov_b32 s10, 262144
    s_mov_b32 s9, 0x3c00000
    s_cmp_ge_u32 s14, 256
    s_cselect_b32 s20, s70, s20
    s_cselect_b32 s21, s71, s21
    s_cselect_b32 s22, 1835008, s22
    s_cselect_b32 s10, 114688, s10
    s_cselect_b32 s9, 0x4000000, s9
    s_cselect_b32 s8, 128, 0
    s_sub_u32 s12, s12, s8
    s_sub_u32 s8, s14, 368
    s_cmp_ge_u32 s14, 368
    s_cselect_b32 s20, s68, s20
    s_cselect_b32 s21, s69, s21
    s_cselect_b32 s10, 32768, s10
    s_cselect_b32 s9, 0x4200000, s9
    s_cselect_b32 s11, 3584, s11
    s_cbranch_scc0 rp_skip_40816_3864
    s_and_b32 s12, s8, 15
    s_lshr_b32 s13, s8, 4
rp_skip_40816_3864:
    s_mul_i32 s8, s12, s11
    s_lshl_b32 s8, s8, 5
    s_lshl_b32 s12, s12, 11
    s_add_u32 s9, s9, s12
    s_lshl_b32 s12, s13, 9
    s_add_u32 s8, s8, s12
    s_mul_i32 s12, s13, s10
    s_lshl_b32 s12, s12, 3
    s_add_u32 s9, s9, s12
    v_lshrrev_b32 v137, 3, v140
    v_and_b32 v138, 7, v140
    v_mul_lo_u32 v136, v137, s11
    v_lshl_add_u32 v136, v138, 4, v136
    v_lshrrev_b32 v137, 5, v140
    v_mul_lo_u32 v141, v137, s10
    v_lshl_add_u32 v141, v138, 4, v141
    v_bfe_u32 v137, v140, 3, 2
    v_lshl_add_u32 v141, v137, 9, v141
    s_lshl_b32 s11, s11, 3
    s_lshl_b32 s10, s10, 1
    s_add_u32 s12, s8, s11
    s_add_u32 s13, s12, s11
    s_add_u32 s11, s13, s11
    v_and_b32 v137, 31, v140
    v_lshrrev_b32 v138, 5, v140
    v_lshlrev_b32 v138, 3, v138
    v_sub_u32 v137, v137, v138
    v_mov_b32 v138, 0x3f80
    v_mov_b32 v139, 0x3f800000
    v_cmp_eq_u32 vcc, 0, v137
    s_nop 1
    v_cndmask_b32 v128, 0, v138, vcc
    v_cmp_eq_u32 vcc, 1, v137
    s_nop 1
    v_cndmask_b32 v128, v128, v139, vcc
    v_cmp_eq_u32 vcc, 2, v137
    s_nop 1
    v_cndmask_b32 v129, 0, v138, vcc
    v_cmp_eq_u32 vcc, 3, v137
    s_nop 1
    v_cndmask_b32 v129, v129, v139, vcc
    v_cmp_eq_u32 vcc, 4, v137
    s_nop 1
    v_cndmask_b32 v130, 0, v138, vcc
    v_cmp_eq_u32 vcc, 5, v137
    s_nop 1
    v_cndmask_b32 v130, v130, v139, vcc
    v_cmp_eq_u32 vcc, 6, v137
    s_nop 1
    v_cndmask_b32 v131, 0, v138, vcc
    v_cmp_eq_u32 vcc, 7, v137
    s_nop 1
    v_cndmask_b32 v131, v131, v139, vcc
    v_cmp_eq_u32 vcc, 16, v137
    s_nop 1
    v_cndmask_b32 v132, 0, v138, vcc
    v_cmp_eq_u32 vcc, 17, v137
    s_nop 1
    v_cndmask_b32 v132, v132, v139, vcc
    v_cmp_eq_u32 vcc, 18, v137
    s_nop 1
    v_cndmask_b32 v133, 0, v138, vcc
    v_cmp_eq_u32 vcc, 19, v137
    s_nop 1
    v_cndmask_b32 v133, v133, v139, vcc
    v_cmp_eq_u32 vcc, 20, v137
    s_nop 1
    v_cndmask_b32 v134, 0, v138, vcc
    v_cmp_eq_u32 vcc, 21, v137
    s_nop 1
    v_cndmask_b32 v134, v134, v139, vcc
    v_cmp_eq_u32 vcc, 22, v137
    s_nop 1
    v_cndmask_b32 v135, 0, v138, vcc
    v_cmp_eq_u32 vcc, 23, v137
    s_nop 1
    v_cndmask_b32 v135, v135, v139, vcc
    s_waitcnt vmcnt(28)
    s_barrier
    s_add_u32 s30, s30, 1
    s_mov_b32 m0, s33
    s_sub_u32 s83, s81, 16384
    buffer_load_dwordx4 v117, s[72:75], s81 offen offset:0 sc1 lds
    buffer_load_dwordx4 v117, s[72:75], s81 offen offset:1024 sc1 lds
    buffer_load_dwordx4 v117, s[72:75], s81 offen offset:2048 sc1 lds
    buffer_load_dwordx4 v117, s[72:75], s81 offen offset:3072 sc1 lds
    s_mov_b32 m0, s80
    s_add_u32 s81, s81, 32768
    buffer_load_dwordx4 v117, s[72:75], s83 offen offset:0 sc1 lds
    buffer_load_dwordx4 v117, s[72:75], s83 offen offset:1024 sc1 lds
    buffer_load_dwordx4 v117, s[72:75], s83 offen offset:2048 sc1 lds
    buffer_load_dwordx4 v117, s[72:75], s83 offen offset:3072 sc1 lds
    s_add_u32 s80, s33, 16384
    s_sub_u32 s33, s33, 32768
    s_cselect_b32 s33, s40, s33
    buffer_load_dwordx4 v[176:179], v136, s[20:23], s8 offen offset:0
    buffer_load_dwordx4 v[180:183], v136, s[20:23], s12 offen offset:0
    buffer_load_dwordx4 v[184:187], v136, s[20:23], s13 offen offset:0
    buffer_load_dwordx4 v[188:191], v136, s[20:23], s11 offen offset:0
    s_waitcnt vmcnt(32)
    s_barrier
    s_add_u32 s30, s30, 1
    s_mov_b32 m0, s33
    s_sub_u32 s83, s81, 16384
    buffer_load_dwordx4 v117, s[72:75], s81 offen offset:0 sc1 lds
    buffer_load_dwordx4 v117, s[72:75], s81 offen offset:1024 sc1 lds
    buffer_load_dwordx4 v117, s[72:75], s81 offen offset:2048 sc1 lds
    buffer_load_dwordx4 v117, s[72:75], s81 offen offset:3072 sc1 lds
    s_mov_b32 m0, s80
    s_add_u32 s81, s81, 32768
    buffer_load_dwordx4 v117, s[72:75], s83 offen offset:0 sc1 lds
    buffer_load_dwordx4 v117, s[72:75], s83 offen offset:1024 sc1 lds
    buffer_load_dwordx4 v117, s[72:75], s83 offen offset:2048 sc1 lds
    buffer_load_dwordx4 v117, s[72:75], s83 offen offset:3072 sc1 lds
    s_add_u32 s80, s33, 16384
    s_sub_u32 s33, s33, 32768
    s_cselect_b32 s33, s40, s33
    buffer_load_dwordx4 v[192:195], v136, s[20:23], s8 offen offset:128
    buffer_load_dwordx4 v[196:199], v136, s[20:23], s12 offen offset:128
    buffer_load_dwordx4 v[200:203], v136, s[20:23], s13 offen offset:128
    buffer_load_dwordx4 v[204:207], v136, s[20:23], s11 offen offset:128
    s_waitcnt vmcnt(12)
    v_mfma_f32_32x32x16_bf16 v[144:159], v[176:179], v[128:131], 0
    v_mfma_f32_32x32x16_bf16 v[160:175], v[180:183], v[128:131], 0
    v_mfma_f32_32x32x16_bf16 v[144:159], v[184:187], v[132:135], v[144:159]
    v_mfma_f32_32x32x16_bf16 v[160:175], v[188:191], v[132:135], v[160:175]
    s_barrier
    s_add_u32 s30, s30, 1
    s_mov_b32 m0, s33
    s_sub_u32 s83, s81, 16384
    buffer_load_dwordx4 v117, s[72:75], s81 offen offset:0 sc1 lds
    buffer_load_dwordx4 v117, s[72:75], s81 offen offset:1024 sc1 lds
    buffer_load_dwordx4 v117, s[72:75], s81 offen offset:2048 sc1 lds
    buffer_load_dwordx4 v117, s[72:75], s81 offen offset:3072 sc1 lds
    s_mov_b32 m0, s80
    s_add_u32 s81, s81, 32768
    buffer_load_dwordx4 v117, s[72:75], s83 offen offset:0 sc1 lds
    buffer_load_dwordx4 v117, s[72:75], s83 offen offset:1024 sc1 lds
    buffer_load_dwordx4 v117, s[72:75], s83 offen offset:2048 sc1 lds
    buffer_load_dwordx4 v117, s[72:75], s83 offen offset:3072 sc1 lds
    s_add_u32 s80, s33, 16384
    s_sub_u32 s33, s33, 32768
    s_cselect_b32 s33, s40, s33
    buffer_load_dwordx4 v[208:211], v136, s[20:23], s8 offen offset:256
    buffer_load_dwordx4 v[212:215], v136, s[20:23], s12 offen offset:256
    buffer_load_dwordx4 v[216:219], v136, s[20:23], s13 offen offset:256
    buffer_load_dwordx4 v[220:223], v136, s[20:23], s11 offen offset:256
    v_cvt_pk_bf16_f32 v176, v144, v148
    v_cvt_pk_bf16_f32 v177, v152, v156
    v_cvt_pk_bf16_f32 v178, v160, v164
    v_cvt_pk_bf16_f32 v179, v168, v172
    v_cvt_pk_bf16_f32 v180, v145, v149
    v_cvt_pk_bf16_f32 v181, v153, v157
    v_cvt_pk_bf16_f32 v182, v161, v165
    v_cvt_pk_bf16_f32 v183, v169, v173
    v_cvt_pk_bf16_f32 v184, v146, v150
    v_cvt_pk_bf16_f32 v185, v154, v158
    v_cvt_pk_bf16_f32 v186, v162, v166
    v_cvt_pk_bf16_f32 v187, v170, v174
    v_cvt_pk_bf16_f32 v188, v147, v151
    v_cvt_pk_bf16_f32 v189, v155, v159
    v_cvt_pk_bf16_f32 v190, v163, v167
    v_cvt_pk_bf16_f32 v191, v171, v175
    buffer_store_dwordx4 v[176:179], v141, s[24:27], s9 offen offset:0 sc1
    buffer_store_dwordx4 v[180:183], v141, s[24:27], s9 offen offset:128 sc1
    s_barrier
    s_add_u32 s30, s30, 1
    s_mov_b32 m0, s33
    s_sub_u32 s83, s81, 16384
    buffer_load_dwordx4 v117, s[72:75], s81 offen offset:0 sc1 lds
    buffer_load_dwordx4 v117, s[72:75], s81 offen offset:1024 sc1 lds
    buffer_load_dwordx4 v117, s[72:75], s81 offen offset:2048 sc1 lds
    buffer_load_dwordx4 v117, s[72:75], s81 offen offset:3072 sc1 lds
    s_mov_b32 m0, s80
    s_add_u32 s81, s81, 32768
    buffer_load_dwordx4 v117, s[72:75], s83 offen offset:0 sc1 lds
    buffer_load_dwordx4 v117, s[72:75], s83 offen offset:1024 sc1 lds
    buffer_load_dwordx4 v117, s[72:75], s83 offen offset:2048 sc1 lds
    buffer_load_dwordx4 v117, s[72:75], s83 offen offset:3072 sc1 lds
    s_add_u32 s80, s33, 16384
    s_sub_u32 s33, s33, 32768
    s_cselect_b32 s33, s40, s33
    buffer_load_dwordx4 v[224:227], v136, s[20:23], s8 offen offset:384
    buffer_load_dwordx4 v[228:231], v136, s[20:23], s12 offen offset:384
    buffer_load_dwordx4 v[232:235], v136, s[20:23], s13 offen offset:384
    buffer_load_dwordx4 v[236:239], v136, s[20:23], s11 offen offset:384
    s_waitcnt vmcnt(26)
    v_mfma_f32_32x32x16_bf16 v[144:159], v[192:195], v[128:131], 0
    v_mfma_f32_32x32x16_bf16 v[160:175], v[196:199], v[128:131], 0
    v_mfma_f32_32x32x16_bf16 v[144:159], v[200:203], v[132:135], v[144:159]
    v_mfma_f32_32x32x16_bf16 v[160:175], v[204:207], v[132:135], v[160:175]
    buffer_store_dwordx4 v[184:187], v141, s[24:27], s9 offen offset:256 sc1
    buffer_store_dwordx4 v[188:191], v141, s[24:27], s9 offen offset:384 sc1
    s_add_u32 s9, s9, s10
    s_barrier
    s_add_u32 s30, s30, 1
    s_mov_b32 m0, s33
    s_sub_u32 s83, s81, 16384
    buffer_load_dwordx4 v117, s[72:75], s81 offen offset:0 sc1 lds
    buffer_load_dwordx4 v117, s[72:75], s81 offen offset:1024 sc1 lds
    buffer_load_dwordx4 v117, s[72:75], s81 offen offset:2048 sc1 lds
    buffer_load_dwordx4 v117, s[72:75], s81 offen offset:3072 sc1 lds
    s_mov_b32 m0, s80
    s_add_u32 s81, s81, 32768
    buffer_load_dwordx4 v117, s[72:75], s83 offen offset:0 sc1 lds
    buffer_load_dwordx4 v117, s[72:75], s83 offen offset:1024 sc1 lds
    buffer_load_dwordx4 v117, s[72:75], s83 offen offset:2048 sc1 lds
    buffer_load_dwordx4 v117, s[72:75], s83 offen offset:3072 sc1 lds
    s_add_u32 s80, s33, 16384
    s_sub_u32 s33, s33, 32768
    s_cselect_b32 s33, s40, s33
    v_cvt_pk_bf16_f32 v192, v144, v148
    v_cvt_pk_bf16_f32 v193, v152, v156
    v_cvt_pk_bf16_f32 v194, v160, v164
    v_cvt_pk_bf16_f32 v195, v168, v172
    v_cvt_pk_bf16_f32 v196, v145, v149
    v_cvt_pk_bf16_f32 v197, v153, v157
    v_cvt_pk_bf16_f32 v198, v161, v165
    v_cvt_pk_bf16_f32 v199, v169, v173
    v_cvt_pk_bf16_f32 v200, v146, v150
    v_cvt_pk_bf16_f32 v201, v154, v158
    v_cvt_pk_bf16_f32 v202, v162, v166
    v_cvt_pk_bf16_f32 v203, v170, v174
    v_cvt_pk_bf16_f32 v204, v147, v151
    v_cvt_pk_bf16_f32 v205, v155, v159
    v_cvt_pk_bf16_f32 v206, v163, v167
    v_cvt_pk_bf16_f32 v207, v171, v175
    buffer_store_dwordx4 v[192:195], v141, s[24:27], s9 offen offset:0 sc1
    buffer_store_dwordx4 v[196:199], v141, s[24:27], s9 offen offset:128 sc1
    s_waitcnt vmcnt(34)
    s_barrier
    s_add_u32 s30, s30, 1
    s_mov_b32 m0, s33
    s_sub_u32 s83, s81, 16384
    buffer_load_dwordx4 v117, s[72:75], s81 offen offset:0 sc1 lds
    buffer_load_dwordx4 v117, s[72:75], s81 offen offset:1024 sc1 lds
    buffer_load_dwordx4 v117, s[72:75], s81 offen offset:2048 sc1 lds
    buffer_load_dwordx4 v117, s[72:75], s81 offen offset:3072 sc1 lds
    s_mov_b32 m0, s80
    s_add_u32 s81, s81, 32768
    buffer_load_dwordx4 v117, s[72:75], s83 offen offset:0 sc1 lds
    buffer_load_dwordx4 v117, s[72:75], s83 offen offset:1024 sc1 lds
    buffer_load_dwordx4 v117, s[72:75], s83 offen offset:2048 sc1 lds
    buffer_load_dwordx4 v117, s[72:75], s83 offen offset:3072 sc1 lds
    s_add_u32 s80, s33, 16384
    s_sub_u32 s33, s33, 32768
    s_cselect_b32 s33, s40, s33
    s_waitcnt vmcnt(34)
    v_mfma_f32_32x32x16_bf16 v[144:159], v[208:211], v[128:131], 0
    v_mfma_f32_32x32x16_bf16 v[160:175], v[212:215], v[128:131], 0
    v_mfma_f32_32x32x16_bf16 v[144:159], v[216:219], v[132:135], v[144:159]
    v_mfma_f32_32x32x16_bf16 v[160:175], v[220:223], v[132:135], v[160:175]
    buffer_store_dwordx4 v[200:203], v141, s[24:27], s9 offen offset:256 sc1
    buffer_store_dwordx4 v[204:207], v141, s[24:27], s9 offen offset:384 sc1
    s_add_u32 s9, s9, s10
    s_waitcnt vmcnt(30)
    s_barrier
    s_add_u32 s30, s30, 1
    s_mov_b32 m0, s33
    s_sub_u32 s83, s81, 16384
    buffer_load_dwordx4 v117, s[72:75], s81 offen offset:0 sc1 lds
    buffer_load_dwordx4 v117, s[72:75], s81 offen offset:1024 sc1 lds
    buffer_load_dwordx4 v117, s[72:75], s81 offen offset:2048 sc1 lds
    buffer_load_dwordx4 v117, s[72:75], s81 offen offset:3072 sc1 lds
    s_mov_b32 m0, s80
    s_add_u32 s81, s81, 32768
    buffer_load_dwordx4 v117, s[72:75], s83 offen offset:0 sc1 lds
    buffer_load_dwordx4 v117, s[72:75], s83 offen offset:1024 sc1 lds
    buffer_load_dwordx4 v117, s[72:75], s83 offen offset:2048 sc1 lds
    buffer_load_dwordx4 v117, s[72:75], s83 offen offset:3072 sc1 lds
    s_add_u32 s80, s33, 16384
    s_sub_u32 s33, s33, 32768
    s_cselect_b32 s33, s40, s33
    v_cvt_pk_bf16_f32 v208, v144, v148
    v_cvt_pk_bf16_f32 v209, v152, v156
    v_cvt_pk_bf16_f32 v210, v160, v164
    v_cvt_pk_bf16_f32 v211, v168, v172
    v_cvt_pk_bf16_f32 v212, v145, v149
    v_cvt_pk_bf16_f32 v213, v153, v157
    v_cvt_pk_bf16_f32 v214, v161, v165
    v_cvt_pk_bf16_f32 v215, v169, v173
    v_cvt_pk_bf16_f32 v216, v146, v150
    v_cvt_pk_bf16_f32 v217, v154, v158
    v_cvt_pk_bf16_f32 v218, v162, v166
    v_cvt_pk_bf16_f32 v219, v170, v174
    v_cvt_pk_bf16_f32 v220, v147, v151
    v_cvt_pk_bf16_f32 v221, v155, v159
    v_cvt_pk_bf16_f32 v222, v163, v167
    v_cvt_pk_bf16_f32 v223, v171, v175
    buffer_store_dwordx4 v[208:211], v141, s[24:27], s9 offen offset:0 sc1
    buffer_store_dwordx4 v[212:215], v141, s[24:27], s9 offen offset:128 sc1
    s_waitcnt vmcnt(26)
    s_barrier
    s_add_u32 s30, s30, 1
    s_mov_b32 m0, s33
    s_sub_u32 s83, s81, 16384
    buffer_load_dwordx4 v117, s[72:75], s81 offen offset:0 sc1 lds
    buffer_load_dwordx4 v117, s[72:75], s81 offen offset:1024 sc1 lds
    buffer_load_dwordx4 v117, s[72:75], s81 offen offset:2048 sc1 lds
    buffer_load_dwordx4 v117, s[72:75], s81 offen offset:3072 sc1 lds
    s_mov_b32 m0, s80
    s_add_u32 s81, s81, 32768
    buffer_load_dwordx4 v117, s[72:75], s83 offen offset:0 sc1 lds
    buffer_load_dwordx4 v117, s[72:75], s83 offen offset:1024 sc1 lds
    buffer_load_dwordx4 v117, s[72:75], s83 offen offset:2048 sc1 lds
    buffer_load_dwordx4 v117, s[72:75], s83 offen offset:3072 sc1 lds
    s_add_u32 s80, s33, 16384
    s_sub_u32 s33, s33, 32768
    s_cselect_b32 s33, s40, s33
    v_mfma_f32_32x32x16_bf16 v[144:159], v[224:227], v[128:131], 0
    v_mfma_f32_32x32x16_bf16 v[160:175], v[228:231], v[128:131], 0
    v_mfma_f32_32x32x16_bf16 v[144:159], v[232:235], v[132:135], v[144:159]
    v_mfma_f32_32x32x16_bf16 v[160:175], v[236:239], v[132:135], v[160:175]
    buffer_store_dwordx4 v[216:219], v141, s[24:27], s9 offen offset:256 sc1
    buffer_store_dwordx4 v[220:223], v141, s[24:27], s9 offen offset:384 sc1
    s_add_u32 s9, s9, s10
    s_waitcnt vmcnt(26)
    s_barrier
    s_add_u32 s30, s30, 1
    s_mov_b32 m0, s33
    s_sub_u32 s83, s81, 16384
    buffer_load_dwordx4 v117, s[72:75], s81 offen offset:0 sc1 lds
    buffer_load_dwordx4 v117, s[72:75], s81 offen offset:1024 sc1 lds
    buffer_load_dwordx4 v117, s[72:75], s81 offen offset:2048 sc1 lds
    buffer_load_dwordx4 v117, s[72:75], s81 offen offset:3072 sc1 lds
    s_mov_b32 m0, s80
    s_add_u32 s81, s81, 32768
    buffer_load_dwordx4 v117, s[72:75], s83 offen offset:0 sc1 lds
    buffer_load_dwordx4 v117, s[72:75], s83 offen offset:1024 sc1 lds
    buffer_load_dwordx4 v117, s[72:75], s83 offen offset:2048 sc1 lds
    buffer_load_dwordx4 v117, s[72:75], s83 offen offset:3072 sc1 lds
    s_add_u32 s80, s33, 16384
    s_sub_u32 s33, s33, 32768
    s_cselect_b32 s33, s40, s33
    v_cvt_pk_bf16_f32 v224, v144, v148
    v_cvt_pk_bf16_f32 v225, v152, v156
    v_cvt_pk_bf16_f32 v226, v160, v164
    v_cvt_pk_bf16_f32 v227, v168, v172
    v_cvt_pk_bf16_f32 v228, v145, v149
    v_cvt_pk_bf16_f32 v229, v153, v157
    v_cvt_pk_bf16_f32 v230, v161, v165
    v_cvt_pk_bf16_f32 v231, v169, v173
    v_cvt_pk_bf16_f32 v232, v146, v150
    v_cvt_pk_bf16_f32 v233, v154, v158
    v_cvt_pk_bf16_f32 v234, v162, v166
    v_cvt_pk_bf16_f32 v235, v170, v174
    v_cvt_pk_bf16_f32 v236, v147, v151
    v_cvt_pk_bf16_f32 v237, v155, v159
    v_cvt_pk_bf16_f32 v238, v163, v167
    v_cvt_pk_bf16_f32 v239, v171, v175
    buffer_store_dwordx4 v[224:227], v141, s[24:27], s9 offen offset:0 sc1
    buffer_store_dwordx4 v[228:231], v141, s[24:27], s9 offen offset:128 sc1
    s_waitcnt vmcnt(26)
    s_barrier
    s_add_u32 s30, s30, 1
    s_mov_b32 m0, s33
    s_sub_u32 s83, s81, 16384
    buffer_load_dwordx4 v117, s[72:75], s81 offen offset:0 sc1 lds
    buffer_load_dwordx4 v117, s[72:75], s81 offen offset:1024 sc1 lds
    buffer_load_dwordx4 v117, s[72:75], s81 offen offset:2048 sc1 lds
    buffer_load_dwordx4 v117, s[72:75], s81 offen offset:3072 sc1 lds
    s_mov_b32 m0, s80
    s_add_u32 s81, s81, 32768
    buffer_load_dwordx4 v117, s[72:75], s83 offen offset:0 sc1 lds
    buffer_load_dwordx4 v117, s[72:75], s83 offen offset:1024 sc1 lds
    buffer_load_dwordx4 v117, s[72:75], s83 offen offset:2048 sc1 lds
    buffer_load_dwordx4 v117, s[72:75], s83 offen offset:3072 sc1 lds
    s_add_u32 s80, s33, 16384
    s_sub_u32 s33, s33, 32768
    s_cselect_b32 s33, s40, s33
    buffer_store_dwordx4 v[232:235], v141, s[24:27], s9 offen offset:256 sc1
    buffer_store_dwordx4 v[236:239], v141, s[24:27], s9 offen offset:384 sc1
    s_add_u32 s9, s9, s10
    s_waitcnt vmcnt(26)
    s_barrier
    s_add_u32 s30, s30, 1
    s_mov_b32 m0, s33
    s_sub_u32 s83, s81, 16384
    buffer_load_dwordx4 v117, s[72:75], s81 offen offset:0 sc1 lds
    buffer_load_dwordx4 v117, s[72:75], s81 offen offset:1024 sc1 lds
    buffer_load_dwordx4 v117, s[72:75], s81 offen offset:2048 sc1 lds
    buffer_load_dwordx4 v117, s[72:75], s81 offen offset:3072 sc1 lds
    s_mov_b32 m0, s80
    s_add_u32 s81, s81, 32768
    buffer_load_dwordx4 v117, s[72:75], s83 offen offset:0 sc1 lds
    buffer_load_dwordx4 v117, s[72:75], s83 offen offset:1024 sc1 lds
    buffer_load_dwordx4 v117, s[72:75], s83 offen offset:2048 sc1 lds
    buffer_load_dwordx4 v117, s[72:75], s83 offen offset:3072 sc1 lds
    s_add_u32 s80, s33, 16384
    s_sub_u32 s33, s33, 32768
    s_cselect_b32 s33, s40, s33
    s_waitcnt vmcnt(24)
    s_barrier
    s_add_u32 s30, s30, 1
    s_mov_b32 m0, s33
    s_sub_u32 s83, s81, 16384
    buffer_load_dwordx4 v117, s[72:75], s81 offen offset:0 sc1 lds
    buffer_load_dwordx4 v117, s[72:75], s81 offen offset:1024 sc1 lds
    buffer_load_dwordx4 v117, s[72:75], s81 offen offset:2048 sc1 lds
    buffer_load_dwordx4 v117, s[72:75], s81 offen offset:3072 sc1 lds
    s_mov_b32 m0, s80
    s_add_u32 s81, s81, 32768
    buffer_load_dwordx4 v117, s[72:75], s83 offen offset:0 sc1 lds
    buffer_load_dwordx4 v117, s[72:75], s83 offen offset:1024 sc1 lds
    buffer_load_dwordx4 v117, s[72:75], s83 offen offset:2048 sc1 lds
    buffer_load_dwordx4 v117, s[72:75], s83 offen offset:3072 sc1 lds
    s_add_u32 s80, s33, 16384
    s_sub_u32 s33, s33, 32768
    s_cselect_b32 s33, s40, s33
    s_waitcnt vmcnt(16)
    s_lshl_b32 s6, s14, 3
    s_add_u32 s6, s6, 0x3ba0000
    v_mov_b32 v144, s64
    v_mov_b32 v145, s65
    s_mov_b64 exec, 1
    buffer_store_dwordx2 v[144:145], off, s[24:27], s6 sc1
    s_mov_b64 exec, -1
k1f_kernel_prod:
k1f_kernel_prod2:
    s_add_u32 s6, s30, 7
    s_cmp_ge_u32 s6, s28
    s_cbranch_scc1 k1f_kernel_tb
    s_waitcnt vmcnt(20)
    s_barrier
    s_add_u32 s30, s30, 1
    s_cmp_eq_u32 s31, 0
    s_cbranch_scc1 k1f_kernel_s18
    s_mov_b32 m0, s33
    s_sub_u32 s83, s81, 16384
    buffer_load_dwordx4 v117, s[72:75], s81 offen offset:0 sc1 lds
    buffer_load_dwordx4 v117, s[72:75], s81 offen offset:1024 sc1 lds
    buffer_load_dwordx4 v117, s[72:75], s81 offen offset:2048 sc1 lds
    buffer_load_dwordx4 v117, s[72:75], s81 offen offset:3072 sc1 lds
    s_mov_b32 m0, s80
    s_add_u32 s81, s81, 32768
    buffer_load_dwordx4 v117, s[72:75], s83 offen offset:0 sc1 lds
    buffer_load_dwordx4 v117, s[72:75], s83 offen offset:1024 sc1 lds
    buffer_load_dwordx4 v117, s[72:75], s83 offen offset:2048 sc1 lds
    buffer_load_dwordx4 v117, s[72:75], s83 offen offset:3072 sc1 lds
    s_add_u32 s80, s33, 16384
    s_sub_u32 s33, s33, 32768
    s_cselect_b32 s33, s40, s33
k1f_kernel_s18:
    s_branch k1f_kernel_prod2
k1f_kernel_tb:
    s_and_b32 s12, s3, 3
    s_lshl_b32 s6, s12, 9
    v_and_b32 v79, 0x1f0, v117
    v_add_u32 v79, s6, v79
    s_lshr_b32 s6, s5, 2
    s_lshl_b32 s6, s6, 3
    s_add_u32 s20, s6, 0x3ba0000
    v_mov_b32 v76, v117
    s_lshr_b32 s6, s12, 1
    s_lshl_b32 s7, s5, 1
    s_add_u32 s13, s6, s7
    s_and_b32 s6, s12, 1
    s_lshl_b32 s7, s4, 1
    s_add_u32 s14, s6, s7
    s_mul_i32 s21, s12, 65536
    s_xor_b32 s7, s13, 0
    s_mul_i32 s6, s7, 262144
    s_add_u32 s6, s6, s21
    s_add_u32 s6, s6, 0x3c00000
    v_add_u32 v72, s6, v76
    s_xor_b32 s7, s13, 1
    s_mul_i32 s6, s7, 262144
    s_add_u32 s6, s6, s21
    s_add_u32 s6, s6, 0x3c00000
    v_add_u32 v73, s6, v76
    s_xor_b32 s7, s14, 0
    s_mul_i32 s6, s7, 262144
    s_add_u32 s6, s6, s21
    s_add_u32 s6, s6, 0x2200000
    v_add_u32 v74, s6, v76
    s_xor_b32 s7, s14, 1
    s_mul_i32 s6, s7, 262144
    s_add_u32 s6, s6, s21
    s_add_u32 s6, s6, 0x2200000
    v_add_u32 v75, s6, v76
    v_lshrrev_b32 v2, 4, v117
    v_and_b32 v3, 31, v2
    v_lshrrev_b32 v2, 5, v2
    v_lshlrev_b32 v3, 10, v3
    v_lshl_add_u32 v77, v2, 4, v3
    s_lshl_b32 s6, s14, 15
    s_lshl_b32 s7, s13, 6
    s_add_u32 s17, s6, s7
    s_lshl_b32 s7, s13, 11
    s_add_u32 s18, s6, s7
    s_add_u32 s18, s18, 0x3200000
    s_waitcnt lgkmcnt(0)
    s_mov_b32 s8, s34
    s_mov_b32 s9, s35
    s_mov_b32 s10, 0x200000
    s_mov_b32 s11, 0x20000
k1f_kernel_p1:
    buffer_load_dwordx2 v[0:1], v79, s[24:27], s20 offen sc1
    s_waitcnt vmcnt(21)
    s_add_u32 s6, s30, 1
    s_cmp_ge_u32 s6, s28
    s_cbranch_scc1 k1f_kernel_l0
    s_barrier
    s_add_u32 s30, s30, 1
    s_mov_b32 m0, s33
    s_sub_u32 s83, s81, 16384
    buffer_load_dwordx4 v76, s[72:75], s81 offen offset:0 sc1 lds
    buffer_load_dwordx4 v76, s[72:75], s81 offen offset:1024 sc1 lds
    buffer_load_dwordx4 v76, s[72:75], s81 offen offset:2048 sc1 lds
    buffer_load_dwordx4 v76, s[72:75], s81 offen offset:3072 sc1 lds
    s_mov_b32 m0, s80
    s_add_u32 s81, s81, 32768
    buffer_load_dwordx4 v76, s[72:75], s83 offen offset:0 sc1 lds
    buffer_load_dwordx4 v76, s[72:75], s83 offen offset:1024 sc1 lds
    buffer_load_dwordx4 v76, s[72:75], s83 offen offset:2048 sc1 lds
    buffer_load_dwordx4 v76, s[72:75], s83 offen offset:3072 sc1 lds
    s_add_u32 s80, s33, 16384
    s_sub_u32 s33, s33, 32768
    s_cselect_b32 s33, s40, s33
    s_waitcnt vmcnt(8)
    v_cmp_eq_u64 vcc, s[64:65], v[0:1]
    s_cmp_eq_u64 vcc, -1
    s_cbranch_scc0 k1f_kernel_p1
    s_sub_u32 s22, s81, s74
    s_cselect_b32 s22, 0, s22
    s_lshr_b32 s22, s22, 15
    v_mov_b32 v2, s64
    v_mov_b32 v3, s65
    s_mov_b64 exec, 1
    buffer_store_dwordx2 v[2:3], off, s[24:27], s50 sc1
    s_mov_b64 exec, -1
    s_mov_b32 s16, 0
    buffer_load_dwordx4 v[80:83], v72, s[24:27], s16 offen offset:0 sc1
    buffer_load_dwordx4 v[84:87], v72, s[24:27], s16 offen offset:1024 sc1
    buffer_load_dwordx4 v[88:91], v72, s[24:27], s16 offen offset:2048 sc1
    buffer_load_dwordx4 v[92:95], v72, s[24:27], s16 offen offset:3072 sc1
    s_mov_b32 s16, 0
    buffer_load_dwordx4 v[96:99], v73, s[24:27], s16 offen offset:0 sc1
    buffer_load_dwordx4 v[100:103], v73, s[24:27], s16 offen offset:1024 sc1
    buffer_load_dwordx4 v[104:107], v73, s[24:27], s16 offen offset:2048 sc1
    buffer_load_dwordx4 v[108:111], v73, s[24:27], s16 offen offset:3072 sc1
    s_add_u32 s6, s30, 1
    s_cmp_ge_u32 s6, s28
    s_cbranch_scc1 k1f_kernel_l1
    s_barrier
    s_add_u32 s30, s30, 1
    s_mov_b32 m0, s33
    s_sub_u32 s83, s81, 16384
    s_sub_u32 s6, s81, s74
    s_cbranch_scc0 k1f_kernel_s20w0
    buffer_load_dwordx4 v76, s[72:75], s81 offen offset:0 sc1 lds
    buffer_load_dwordx4 v76, s[72:75], s81 offen offset:1024 sc1 lds
    buffer_load_dwordx4 v76, s[72:75], s81 offen offset:2048 sc1 lds
    buffer_load_dwordx4 v76, s[72:75], s81 offen offset:3072 sc1 lds
    s_branch k1f_kernel_s20e0
k1f_kernel_s20w0:
    s_lshr_b32 s6, s6, 15
    s_lshl_b32 s6, s6, 12
    s_add_u32 s6, s6, 16384
    buffer_load_dwordx4 v72, s[24:27], s6 offen offset:0 sc1 lds
    buffer_load_dwordx4 v72, s[24:27], s6 offen offset:1024 sc1 lds
    buffer_load_dwordx4 v72, s[24:27], s6 offen offset:2048 sc1 lds
    buffer_load_dwordx4 v72, s[24:27], s6 offen offset:3072 sc1 lds
k1f_kernel_s20e0:
    s_mov_b32 m0, s80
    s_add_u32 s81, s81, 32768
    s_sub_u32 s6, s83, s74
    s_cbranch_scc0 k1f_kernel_s20w1
    buffer_load_dwordx4 v76, s[72:75], s83 offen offset:0 sc1 lds
    buffer_load_dwordx4 v76, s[72:75], s83 offen offset:1024 sc1 lds
    buffer_load_dwordx4 v76, s[72:75], s83 offen offset:2048 sc1 lds
    buffer_load_dwordx4 v76, s[72:75], s83 offen offset:3072 sc1 lds
    s_branch k1f_kernel_s20e1
k1f_kernel_s20w1:
    s_lshr_b32 s6, s6, 15
    s_lshl_b32 s6, s6, 12
    s_add_u32 s6, s6, 16384
    buffer_load_dwordx4 v73, s[24:27], s6 offen offset:0 sc1 lds
    buffer_load_dwordx4 v73, s[24:27], s6 offen offset:1024 sc1 lds
    buffer_load_dwordx4 v73, s[24:27], s6 offen offset:2048 sc1 lds
    buffer_load_dwordx4 v73, s[24:27], s6 offen offset:3072 sc1 lds
k1f_kernel_s20e1:
    s_add_u32 s80, s33, 16384
    s_sub_u32 s33, s33, 32768
    s_cselect_b32 s33, s40, s33
    s_mov_b32 s16, 4096
    buffer_load_dwordx4 v[112:115], v72, s[24:27], s16 offen offset:0 sc1
    buffer_load_dwordx4 v[116:119], v72, s[24:27], s16 offen offset:1024 sc1
    buffer_load_dwordx4 v[120:123], v72, s[24:27], s16 offen offset:2048 sc1
    buffer_load_dwordx4 v[124:127], v72, s[24:27], s16 offen offset:3072 sc1
    s_mov_b32 s16, 4096
    buffer_load_dwordx4 v[128:131], v73, s[24:27], s16 offen offset:0 sc1
    buffer_load_dwordx4 v[132:135], v73, s[24:27], s16 offen offset:1024 sc1
    buffer_load_dwordx4 v[136:139], v73, s[24:27], s16 offen offset:2048 sc1
    buffer_load_dwordx4 v[140:143], v73, s[24:27], s16 offen offset:3072 sc1
    s_add_u32 s6, s30, 1
    s_cmp_ge_u32 s6, s28
    s_cbranch_scc1 k1f_kernel_l2
    s_barrier
    s_add_u32 s30, s30, 1
    s_mov_b32 m0, s33
    s_sub_u32 s83, s81, 16384
    s_sub_u32 s6, s81, s74
    s_cbranch_scc0 k1f_kernel_s21w0
    buffer_load_dwordx4 v76, s[72:75], s81 offen offset:0 sc1 lds
    buffer_load_dwordx4 v76, s[72:75], s81 offen offset:1024 sc1 lds
    buffer_load_dwordx4 v76, s[72:75], s81 offen offset:2048 sc1 lds
    buffer_load_dwordx4 v76, s[72:75], s81 offen offset:3072 sc1 lds
    s_branch k1f_kernel_s21e0
k1f_kernel_s21w0:
    s_lshr_b32 s6, s6, 15
    s_lshl_b32 s6, s6, 12
    s_add_u32 s6, s6, 16384
    buffer_load_dwordx4 v72, s[24:27], s6 offen offset:0 sc1 lds
    buffer_load_dwordx4 v72, s[24:27], s6 offen offset:1024 sc1 lds
    buffer_load_dwordx4 v72, s[24:27], s6 offen offset:2048 sc1 lds
    buffer_load_dwordx4 v72, s[24:27], s6 offen offset:3072 sc1 lds
k1f_kernel_s21e0:
    s_mov_b32 m0, s80
    s_add_u32 s81, s81, 32768
    s_sub_u32 s6, s83, s74
    s_cbranch_scc0 k1f_kernel_s21w1
    buffer_load_dwordx4 v76, s[72:75], s83 offen offset:0 sc1 lds
    buffer_load_dwordx4 v76, s[72:75], s83 offen offset:1024 sc1 lds
    buffer_load_dwordx4 v76, s[72:75], s83 offen offset:2048 sc1 lds
    buffer_load_dwordx4 v76, s[72:75], s83 offen offset:3072 sc1 lds
    s_branch k1f_kernel_s21e1
k1f_kernel_s21w1:
    s_lshr_b32 s6, s6, 15
    s_lshl_b32 s6, s6, 12
    s_add_u32 s6, s6, 16384
    buffer_load_dwordx4 v73, s[24:27], s6 offen offset:0 sc1 lds
    buffer_load_dwordx4 v73, s[24:27], s6 offen offset:1024 sc1 lds
    buffer_load_dwordx4 v73, s[24:27], s6 offen offset:2048 sc1 lds
    buffer_load_dwordx4 v73, s[24:27], s6 offen offset:3072 sc1 lds
k1f_kernel_s21e1:
    s_add_u32 s80, s33, 16384
    s_sub_u32 s33, s33, 32768
    s_cselect_b32 s33, s40, s33
    s_mov_b32 s16, 8192
    buffer_load_dwordx4 v[144:147], v72, s[24:27], s16 offen offset:0 sc1
    buffer_load_dwordx4 v[148:151], v72, s[24:27], s16 offen offset:1024 sc1
    buffer_load_dwordx4 v[152:155], v72, s[24:27], s16 offen offset:2048 sc1
    buffer_load_dwordx4 v[156:159], v72, s[24:27], s16 offen offset:3072 sc1
    s_mov_b32 s16, 8192
    buffer_load_dwordx4 v[160:163], v73, s[24:27], s16 offen offset:0 sc1
    buffer_load_dwordx4 v[164:167], v73, s[24:27], s16 offen offset:1024 sc1
    buffer_load_dwordx4 v[168:171], v73, s[24:27], s16 offen offset:2048 sc1
    buffer_load_dwordx4 v[172:175], v73, s[24:27], s16 offen offset:3072 sc1
    s_waitcnt vmcnt(45)
    s_add_u32 s6, s30, 1
    s_cmp_ge_u32 s6, s28
    s_cbranch_scc1 k1f_kernel_l3
    s_barrier
    s_add_u32 s30, s30, 1
    s_mov_b32 m0, s33
    s_sub_u32 s83, s81, 16384
    s_sub_u32 s6, s81, s74
    s_cbranch_scc0 k1f_kernel_s22w0
    buffer_load_dwordx4 v76, s[72:75], s81 offen offset:0 sc1 lds
    buffer_load_dwordx4 v76, s[72:75], s81 offen offset:1024 sc1 lds
    buffer_load_dwordx4 v76, s[72:75], s81 offen offset:2048 sc1 lds
    buffer_load_dwordx4 v76, s[72:75], s81 offen offset:3072 sc1 lds
    s_branch k1f_kernel_s22e0
k1f_kernel_s22w0:
    s_lshr_b32 s6, s6, 15
    s_lshl_b32 s6, s6, 12
    s_add_u32 s6, s6, 16384
    buffer_load_dwordx4 v72, s[24:27], s6 offen offset:0 sc1 lds
    buffer_load_dwordx4 v72, s[24:27], s6 offen offset:1024 sc1 lds
    buffer_load_dwordx4 v72, s[24:27], s6 offen offset:2048 sc1 lds
    buffer_load_dwordx4 v72, s[24:27], s6 offen offset:3072 sc1 lds
k1f_kernel_s22e0:
    s_mov_b32 m0, s80
    s_add_u32 s81, s81, 32768
    s_sub_u32 s6, s83, s74
    s_cbranch_scc0 k1f_kernel_s22w1
    buffer_load_dwordx4 v76, s[72:75], s83 offen offset:0 sc1 lds
    buffer_load_dwordx4 v76, s[72:75], s83 offen offset:1024 sc1 lds
    buffer_load_dwordx4 v76, s[72:75], s83 offen offset:2048 sc1 lds
    buffer_load_dwordx4 v76, s[72:75], s83 offen offset:3072 sc1 lds
    s_branch k1f_kernel_s22e1
k1f_kernel_s22w1:
    s_lshr_b32 s6, s6, 15
    s_lshl_b32 s6, s6, 12
    s_add_u32 s6, s6, 16384
    buffer_load_dwordx4 v73, s[24:27], s6 offen offset:0 sc1 lds
    buffer_load_dwordx4 v73, s[24:27], s6 offen offset:1024 sc1 lds
    buffer_load_dwordx4 v73, s[24:27], s6 offen offset:2048 sc1 lds
    buffer_load_dwordx4 v73, s[24:27], s6 offen offset:3072 sc1 lds
k1f_kernel_s22e1:
    s_add_u32 s80, s33, 16384
    s_sub_u32 s33, s33, 32768
    s_cselect_b32 s33, s40, s33
    s_mov_b32 s16, 12288
    buffer_load_dwordx4 v[176:179], v72, s[24:27], s16 offen offset:0 sc1
    buffer_load_dwordx4 v[180:183], v72, s[24:27], s16 offen offset:1024 sc1
    buffer_load_dwordx4 v[184:187], v72, s[24:27], s16 offen offset:2048 sc1
    buffer_load_dwordx4 v[188:191], v72, s[24:27], s16 offen offset:3072 sc1
    s_mov_b32 s16, 12288
    buffer_load_dwordx4 v[192:195], v73, s[24:27], s16 offen offset:0 sc1
    buffer_load_dwordx4 v[196:199], v73, s[24:27], s16 offen offset:1024 sc1
    buffer_load_dwordx4 v[200:203], v73, s[24:27], s16 offen offset:2048 sc1
    buffer_load_dwordx4 v[204:207], v73, s[24:27], s16 offen offset:3072 sc1
    s_waitcnt vmcnt(44)
    s_add_u32 s6, s30, 1
    s_cmp_ge_u32 s6, s28
    s_cbranch_scc1 k1f_kernel_l4
    s_barrier
    s_add_u32 s30, s30, 1
    s_mov_b32 m0, s33
    s_sub_u32 s83, s81, 16384
    s_sub_u32 s6, s81, s74
    s_cbranch_scc0 k1f_kernel_s23w0
    buffer_load_dwordx4 v76, s[72:75], s81 offen offset:0 sc1 lds
    buffer_load_dwordx4 v76, s[72:75], s81 offen offset:1024 sc1 lds
    buffer_load_dwordx4 v76, s[72:75], s81 offen offset:2048 sc1 lds
    buffer_load_dwordx4 v76, s[72:75], s81 offen offset:3072 sc1 lds
    s_branch k1f_kernel_s23e0
k1f_kernel_s23w0:
    s_lshr_b32 s6, s6, 15
    s_lshl_b32 s6, s6, 12
    s_add_u32 s6, s6, 16384
    buffer_load_dwordx4 v72, s[24:27], s6 offen offset:0 sc1 lds
    buffer_load_dwordx4 v72, s[24:27], s6 offen offset:1024 sc1 lds
    buffer_load_dwordx4 v72, s[24:27], s6 offen offset:2048 sc1 lds
    buffer_load_dwordx4 v72, s[24:27], s6 offen offset:3072 sc1 lds
k1f_kernel_s23e0:
    s_mov_b32 m0, s80
    s_add_u32 s81, s81, 32768
    s_sub_u32 s6, s83, s74
    s_cbranch_scc0 k1f_kernel_s23w1
    buffer_load_dwordx4 v76, s[72:75], s83 offen offset:0 sc1 lds
    buffer_load_dwordx4 v76, s[72:75], s83 offen offset:1024 sc1 lds
    buffer_load_dwordx4 v76, s[72:75], s83 offen offset:2048 sc1 lds
    buffer_load_dwordx4 v76, s[72:75], s83 offen offset:3072 sc1 lds
    s_branch k1f_kernel_s23e1
k1f_kernel_s23w1:
    s_lshr_b32 s6, s6, 15
    s_lshl_b32 s6, s6, 12
    s_add_u32 s6, s6, 16384
    buffer_load_dwordx4 v73, s[24:27], s6 offen offset:0 sc1 lds
    buffer_load_dwordx4 v73, s[24:27], s6 offen offset:1024 sc1 lds
    buffer_load_dwordx4 v73, s[24:27], s6 offen offset:2048 sc1 lds
    buffer_load_dwordx4 v73, s[24:27], s6 offen offset:3072 sc1 lds
k1f_kernel_s23e1:
    s_add_u32 s80, s33, 16384
    s_sub_u32 s33, s33, 32768
    s_cselect_b32 s33, s40, s33
    v_lshrrev_b32 v4, 4, v76
    v_bfe_u32 v5, v4, 3, 2
    v_and_b32 v6, 7, v4
    v_lshlrev_b32 v6, 7, v6
    v_lshl_add_u32 v5, v5, 12, v6
    v_sub_u32 v5, v5, v76
    v_cmp_gt_u32 vcc, 32, v4
    s_nop 1
    v_cndmask_b32 v4, v73, v72, vcc
    v_add_u32 v4, v4, v5
    s_and_b32 s6, s4, 3
    s_lshl_b32 s6, s6, 10
    s_add_u32 s7, s6, 32768
    buffer_load_dword v7, v4, s[24:27], s7 offen sc1
    s_add_u32 s7, s6, 49152
    buffer_load_dword v7, v4, s[24:27], s7 offen sc1
    s_waitcnt vmcnt(38)
    s_add_u32 s6, s30, 1
    s_cmp_ge_u32 s6, s28
    s_cbranch_scc1 k1f_kernel_l5
    s_barrier
    s_add_u32 s30, s30, 1
    s_mov_b32 m0, s33
    s_sub_u32 s83, s81, 16384
    s_sub_u32 s6, s81, s74
    s_cbranch_scc0 k1f_kernel_s24w0
    buffer_load_dwordx4 v76, s[72:75], s81 offen offset:0 sc1 lds
    buffer_load_dwordx4 v76, s[72:75], s81 offen offset:1024 sc1 lds
    buffer_load_dwordx4 v76, s[72:75], s81 offen offset:2048 sc1 lds
    buffer_load_dwordx4 v76, s[72:75], s81 offen offset:3072 sc1 lds
    s_branch k1f_kernel_s24e0
k1f_kernel_s24w0:
    s_lshr_b32 s6, s6, 15
    s_lshl_b32 s6, s6, 12
    s_add_u32 s6, s6, 16384
    buffer_load_dwordx4 v72, s[24:27], s6 offen offset:0 sc1 lds
    buffer_load_dwordx4 v72, s[24:27], s6 offen offset:1024 sc1 lds
    buffer_load_dwordx4 v72, s[24:27], s6 offen offset:2048 sc1 lds
    buffer_load_dwordx4 v72, s[24:27], s6 offen offset:3072 sc1 lds
k1f_kernel_s24e0:
    s_mov_b32 m0, s80
    s_add_u32 s81, s81, 32768
    s_sub_u32 s6, s83, s74
    s_cbranch_scc0 k1f_kernel_s24w1
    buffer_load_dwordx4 v76, s[72:75], s83 offen offset:0 sc1 lds
    buffer_load_dwordx4 v76, s[72:75], s83 offen offset:1024 sc1 lds
    buffer_load_dwordx4 v76, s[72:75], s83 offen offset:2048 sc1 lds
    buffer_load_dwordx4 v76, s[72:75], s83 offen offset:3072 sc1 lds
    s_branch k1f_kernel_s24e1
k1f_kernel_s24w1:
    s_lshr_b32 s6, s6, 15
    s_lshl_b32 s6, s6, 12
    s_add_u32 s6, s6, 16384
    buffer_load_dwordx4 v73, s[24:27], s6 offen offset:0 sc1 lds
    buffer_load_dwordx4 v73, s[24:27], s6 offen offset:1024 sc1 lds
    buffer_load_dwordx4 v73, s[24:27], s6 offen offset:2048 sc1 lds
    buffer_load_dwordx4 v73, s[24:27], s6 offen offset:3072 sc1 lds
k1f_kernel_s24e1:
    s_add_u32 s80, s33, 16384
    s_sub_u32 s33, s33, 32768
    s_cselect_b32 s33, s40, s33
    s_waitcnt vmcnt(30)
    s_add_u32 s6, s30, 1
    s_cmp_ge_u32 s6, s28
    s_cbranch_scc1 k1f_kernel_l5
    s_barrier
    s_add_u32 s30, s30, 1
    s_mov_b32 m0, s33
    s_sub_u32 s83, s81, 16384
    s_sub_u32 s6, s81, s74
    s_cbranch_scc0 k1f_kernel_s25w0
    buffer_load_dwordx4 v76, s[72:75], s81 offen offset:0 sc1 lds
    buffer_load_dwordx4 v76, s[72:75], s81 offen offset:1024 sc1 lds
    buffer_load_dwordx4 v76, s[72:75], s81 offen offset:2048 sc1 lds
    buffer_load_dwordx4 v76, s[72:75], s81 offen offset:3072 sc1 lds
    s_branch k1f_kernel_s25e0
k1f_kernel_s25w0:
    s_lshr_b32 s6, s6, 15
    s_lshl_b32 s6, s6, 12
    s_add_u32 s6, s6, 16384
    buffer_load_dwordx4 v72, s[24:27], s6 offen offset:0 sc1 lds
    buffer_load_dwordx4 v72, s[24:27], s6 offen offset:1024 sc1 lds
    buffer_load_dwordx4 v72, s[24:27], s6 offen offset:2048 sc1 lds
    buffer_load_dwordx4 v72, s[24:27], s6 offen offset:3072 sc1 lds
k1f_kernel_s25e0:
    s_mov_b32 m0, s80
    s_add_u32 s81, s81, 32768
    s_sub_u32 s6, s83, s74
    s_cbranch_scc0 k1f_kernel_s25w1
    buffer_load_dwordx4 v76, s[72:75], s83 offen offset:0 sc1 lds
    buffer_load_dwordx4 v76, s[72:75], s83 offen offset:1024 sc1 lds
    buffer_load_dwordx4 v76, s[72:75], s83 offen offset:2048 sc1 lds
    buffer_load_dwordx4 v76, s[72:75], s83 offen offset:3072 sc1 lds
    s_branch k1f_kernel_s25e1
k1f_kernel_s25w1:
    s_lshr_b32 s6, s6, 15
    s_lshl_b32 s6, s6, 12
    s_add_u32 s6, s6, 16384
    buffer_load_dwordx4 v73, s[24:27], s6 offen offset:0 sc1 lds
    buffer_load_dwordx4 v73, s[24:27], s6 offen offset:1024 sc1 lds
    buffer_load_dwordx4 v73, s[24:27], s6 offen offset:2048 sc1 lds
    buffer_load_dwordx4 v73, s[24:27], s6 offen offset:3072 sc1 lds
k1f_kernel_s25e1:
    s_add_u32 s80, s33, 16384
    s_sub_u32 s33, s33, 32768
    s_cselect_b32 s33, s40, s33
    s_waitcnt vmcnt(22)
    s_add_u32 s6, s30, 1
    s_cmp_ge_u32 s6, s28
    s_cbranch_scc1 k1f_kernel_l5
    s_barrier
    s_add_u32 s30, s30, 1
    s_mov_b32 m0, s33
    s_sub_u32 s83, s81, 16384
    s_sub_u32 s6, s81, s74
    s_cbranch_scc0 k1f_kernel_s26w0
    buffer_load_dwordx4 v76, s[72:75], s81 offen offset:0 sc1 lds
    buffer_load_dwordx4 v76, s[72:75], s81 offen offset:1024 sc1 lds
    buffer_load_dwordx4 v76, s[72:75], s81 offen offset:2048 sc1 lds
    buffer_load_dwordx4 v76, s[72:75], s81 offen offset:3072 sc1 lds
    s_branch k1f_kernel_s26e0
k1f_kernel_s26w0:
    s_lshr_b32 s6, s6, 15
    s_lshl_b32 s6, s6, 12
    s_add_u32 s6, s6, 16384
    buffer_load_dwordx4 v72, s[24:27], s6 offen offset:0 sc1 lds
    buffer_load_dwordx4 v72, s[24:27], s6 offen offset:1024 sc1 lds
    buffer_load_dwordx4 v72, s[24:27], s6 offen offset:2048 sc1 lds
    buffer_load_dwordx4 v72, s[24:27], s6 offen offset:3072 sc1 lds
k1f_kernel_s26e0:
    s_mov_b32 m0, s80
    s_add_u32 s81, s81, 32768
    s_sub_u32 s6, s83, s74
    s_cbranch_scc0 k1f_kernel_s26w1
    buffer_load_dwordx4 v76, s[72:75], s83 offen offset:0 sc1 lds
    buffer_load_dwordx4 v76, s[72:75], s83 offen offset:1024 sc1 lds
    buffer_load_dwordx4 v76, s[72:75], s83 offen offset:2048 sc1 lds
    buffer_load_dwordx4 v76, s[72:75], s83 offen offset:3072 sc1 lds
    s_branch k1f_kernel_s26e1
k1f_kernel_s26w1:
    s_lshr_b32 s6, s6, 15
    s_lshl_b32 s6, s6, 12
    s_add_u32 s6, s6, 16384
    buffer_load_dwordx4 v73, s[24:27], s6 offen offset:0 sc1 lds
    buffer_load_dwordx4 v73, s[24:27], s6 offen offset:1024 sc1 lds
    buffer_load_dwordx4 v73, s[24:27], s6 offen offset:2048 sc1 lds
    buffer_load_dwordx4 v73, s[24:27], s6 offen offset:3072 sc1 lds
k1f_kernel_s26e1:
    s_add_u32 s80, s33, 16384
    s_sub_u32 s33, s33, 32768
    s_cselect_b32 s33, s40, s33
k1f_kernel_p2:
    s_waitcnt vmcnt(20)
    s_add_u32 s6, s30, 1
    s_cmp_ge_u32 s6, s28
    s_cbranch_scc1 k1f_kernel_l5
    s_barrier
    s_add_u32 s30, s30, 1
    s_mov_b32 m0, s33
    s_sub_u32 s83, s81, 16384
    s_sub_u32 s6, s81, s74
    s_cbranch_scc0 k1f_kernel_s27w0
    buffer_load_dwordx4 v76, s[72:75], s81 offen offset:0 sc1 lds
    buffer_load_dwordx4 v76, s[72:75], s81 offen offset:1024 sc1 lds
    buffer_load_dwordx4 v76, s[72:75], s81 offen offset:2048 sc1 lds
    buffer_load_dwordx4 v76, s[72:75], s81 offen offset:3072 sc1 lds
    s_branch k1f_kernel_s27e0
k1f_kernel_s27w0:
    s_lshr_b32 s6, s6, 15
    s_lshl_b32 s6, s6, 12
    s_add_u32 s6, s6, 16384
    buffer_load_dwordx4 v72, s[24:27], s6 offen offset:0 sc1 lds
    buffer_load_dwordx4 v72, s[24:27], s6 offen offset:1024 sc1 lds
    buffer_load_dwordx4 v72, s[24:27], s6 offen offset:2048 sc1 lds
    buffer_load_dwordx4 v72, s[24:27], s6 offen offset:3072 sc1 lds
k1f_kernel_s27e0:
    s_mov_b32 m0, s80
    s_add_u32 s81, s81, 32768
    s_sub_u32 s6, s83, s74
    s_cbranch_scc0 k1f_kernel_s27w1
    buffer_load_dwordx4 v76, s[72:75], s83 offen offset:0 sc1 lds
    buffer_load_dwordx4 v76, s[72:75], s83 offen offset:1024 sc1 lds
    buffer_load_dwordx4 v76, s[72:75], s83 offen offset:2048 sc1 lds
    buffer_load_dwordx4 v76, s[72:75], s83 offen offset:3072 sc1 lds
    s_branch k1f_kernel_s27e1
k1f_kernel_s27w1:
    s_lshr_b32 s6, s6, 15
    s_lshl_b32 s6, s6, 12
    s_add_u32 s6, s6, 16384
    buffer_load_dwordx4 v73, s[24:27], s6 offen offset:0 sc1 lds
    buffer_load_dwordx4 v73, s[24:27], s6 offen offset:1024 sc1 lds
    buffer_load_dwordx4 v73, s[24:27], s6 offen offset:2048 sc1 lds
    buffer_load_dwordx4 v73, s[24:27], s6 offen offset:3072 sc1 lds
k1f_kernel_s27e1:
    s_add_u32 s80, s33, 16384
    s_sub_u32 s33, s33, 32768
    s_cselect_b32 s33, s40, s33
    s_branch k1f_kernel_p2
k1f_kernel_l5:
    s_barrier
    s_branch k1f_kernel_c5
k1f_kernel_l4:
    s_barrier
    s_branch k1f_kernel_c4
k1f_kernel_l3:
    s_barrier
    s_branch k1f_kernel_c3
k1f_kernel_l2:
    s_barrier
    s_branch k1f_kernel_c2
k1f_kernel_l1:
    s_barrier
    s_branch k1f_kernel_c1
k1f_kernel_l0:
    s_barrier
    s_mov_b32 s19, 0x40000
    s_branch k1f_kernel_rpcw
k1f_kernel_rpc:
    buffer_load_dwordx2 v[0:1], v79, s[24:27], s20 offen sc1
k1f_kernel_rpcw:
    s_waitcnt vmcnt(0)
    v_cmp_eq_u64 vcc, s[64:65], v[0:1]
    s_cmp_eq_u64 vcc, -1
    s_cbranch_scc1 k1f_kernel_rpcd
    s_sleep 1
    s_sub_u32 s19, s19, 1
    s_cbranch_scc0 k1f_kernel_rpc
k1f_kernel_rpcd:
    s_sub_u32 s22, s81, s74
    s_cselect_b32 s22, 0, s22
    s_lshr_b32 s22, s22, 15
    s_branch k1f_kernel_c0
k1f_kernel_c0:
    v_mov_b32 v2, s64
    v_mov_b32 v3, s65
    s_mov_b64 exec, 1
    buffer_store_dwordx2 v[2:3], off, s[24:27], s50 sc1
    s_mov_b64 exec, -1
    s_mov_b32 s16, 0
    buffer_load_dwordx4 v[80:83], v72, s[24:27], s16 offen offset:0 sc1
    buffer_load_dwordx4 v[84:87], v72, s[24:27], s16 offen offset:1024 sc1
    buffer_load_dwordx4 v[88:91], v72, s[24:27], s16 offen offset:2048 sc1
    buffer_load_dwordx4 v[92:95], v72, s[24:27], s16 offen offset:3072 sc1
    s_mov_b32 s16, 0
    buffer_load_dwordx4 v[96:99], v73, s[24:27], s16 offen offset:0 sc1
    buffer_load_dwordx4 v[100:103], v73, s[24:27], s16 offen offset:1024 sc1
    buffer_load_dwordx4 v[104:107], v73, s[24:27], s16 offen offset:2048 sc1
    buffer_load_dwordx4 v[108:111], v73, s[24:27], s16 offen offset:3072 sc1
k1f_kernel_c1:
    s_mov_b32 s16, 4096
    buffer_load_dwordx4 v[112:115], v72, s[24:27], s16 offen offset:0 sc1
    buffer_load_dwordx4 v[116:119], v72, s[24:27], s16 offen offset:1024 sc1
    buffer_load_dwordx4 v[120:123], v72, s[24:27], s16 offen offset:2048 sc1
    buffer_load_dwordx4 v[124:127], v72, s[24:27], s16 offen offset:3072 sc1
    s_mov_b32 s16, 4096
    buffer_load_dwordx4 v[128:131], v73, s[24:27], s16 offen offset:0 sc1
    buffer_load_dwordx4 v[132:135], v73, s[24:27], s16 offen offset:1024 sc1
    buffer_load_dwordx4 v[136:139], v73, s[24:27], s16 offen offset:2048 sc1
    buffer_load_dwordx4 v[140:143], v73, s[24:27], s16 offen offset:3072 sc1
k1f_kernel_c2:
    s_mov_b32 s16, 8192
    buffer_load_dwordx4 v[144:147], v72, s[24:27], s16 offen offset:0 sc1
    buffer_load_dwordx4 v[148:151], v72, s[24:27], s16 offen offset:1024 sc1
    buffer_load_dwordx4 v[152:155], v72, s[24:27], s16 offen offset:2048 sc1
    buffer_load_dwordx4 v[156:159], v72, s[24:27], s16 offen offset:3072 sc1
    s_mov_b32 s16, 8192
    buffer_load_dwordx4 v[160:163], v73, s[24:27], s16 offen offset:0 sc1
    buffer_load_dwordx4 v[164:167], v73, s[24:27], s16 offen offset:1024 sc1
    buffer_load_dwordx4 v[168:171], v73, s[24:27], s16 offen offset:2048 sc1
    buffer_load_dwordx4 v[172:175], v73, s[24:27], s16 offen offset:3072 sc1
k1f_kernel_c3:
    s_mov_b32 s16, 12288
    buffer_load_dwordx4 v[176:179], v72, s[24:27], s16 offen offset:0 sc1
    buffer_load_dwordx4 v[180:183], v72, s[24:27], s16 offen offset:1024 sc1
    buffer_load_dwordx4 v[184:187], v72, s[24:27], s16 offen offset:2048 sc1
    buffer_load_dwordx4 v[188:191], v72, s[24:27], s16 offen offset:3072 sc1
    s_mov_b32 s16, 12288
    buffer_load_dwordx4 v[192:195], v73, s[24:27], s16 offen offset:0 sc1
    buffer_load_dwordx4 v[196:199], v73, s[24:27], s16 offen offset:1024 sc1
    buffer_load_dwordx4 v[200:203], v73, s[24:27], s16 offen offset:2048 sc1
    buffer_load_dwordx4 v[204:207], v73, s[24:27], s16 offen offset:3072 sc1
k1f_kernel_c4:
    v_lshrrev_b32 v4, 4, v76
    v_bfe_u32 v5, v4, 3, 2
    v_and_b32 v6, 7, v4
    v_lshlrev_b32 v6, 7, v6
    v_lshl_add_u32 v5, v5, 12, v6
    v_sub_u32 v5, v5, v76
    v_cmp_gt_u32 vcc, 32, v4
    s_nop 1
    v_cndmask_b32 v4, v73, v72, vcc
    v_add_u32 v4, v4, v5
    s_and_b32 s6, s4, 3
    s_lshl_b32 s6, s6, 10
    s_add_u32 s7, s6, 32768
    buffer_load_dword v7, v4, s[24:27], s7 offen sc1
    s_add_u32 s7, s6, 49152
    buffer_load_dword v7, v4, s[24:27], s7 offen sc1
k1f_kernel_c5:
k1f_kernel_bm:
    s_sub_u32 s44, s33, 32768
    s_cselect_b32 s44, s40, s44
    s_sub_u32 s45, s44, 32768
    s_cselect_b32 s45, s40, s45
    s_sub_u32 s46, s45, 32768
    s_cselect_b32 s46, s40, s46
    s_sub_u32 s47, s46, 32768
    s_cselect_b32 s47, s40, s47
    s_mul_i32 s7, s12, 224
    s_add_u32 s7, s7, 2048
    v_min_u32 v4, 208, v76
    v_add_u32 v4, s7, v4
    s_mov_b32 s21, s20
    s_cmp_ge_u32 0, s22
    s_cbranch_scc1 k1f_kernel_lq7
    s_add_u32 m0, s44, 0
    s_mov_b32 s16, 16384
    buffer_load_dwordx4 v72, s[24:27], s16 offen offset:0 sc1 lds
    buffer_load_dwordx4 v72, s[24:27], s16 offen offset:1024 sc1 lds
    buffer_load_dwordx4 v72, s[24:27], s16 offen offset:2048 sc1 lds
    buffer_load_dwordx4 v72, s[24:27], s16 offen offset:3072 sc1 lds
    s_cmp_ge_u32 1, s22
    s_cbranch_scc1 k1f_kernel_lq7
    s_add_u32 m0, s44, 16384
    s_mov_b32 s16, 16384
    buffer_load_dwordx4 v73, s[24:27], s16 offen offset:0 sc1 lds
    buffer_load_dwordx4 v73, s[24:27], s16 offen offset:1024 sc1 lds
    buffer_load_dwordx4 v73, s[24:27], s16 offen offset:2048 sc1 lds
    buffer_load_dwordx4 v73, s[24:27], s16 offen offset:3072 sc1 lds
    s_cmp_ge_u32 1, s22
    s_cbranch_scc1 k1f_kernel_lq7
    s_add_u32 m0, s45, 0
    s_mov_b32 s16, 20480
    buffer_load_dwordx4 v72, s[24:27], s16 offen offset:0 sc1 lds
    buffer_load_dwordx4 v72, s[24:27], s16 offen offset:1024 sc1 lds
    buffer_load_dwordx4 v72, s[24:27], s16 offen offset:2048 sc1 lds
    buffer_load_dwordx4 v72, s[24:27], s16 offen offset:3072 sc1 lds
    s_cmp_ge_u32 2, s22
    s_cbranch_scc1 k1f_kernel_lq7
    s_add_u32 m0, s45, 16384
    s_mov_b32 s16, 20480
    buffer_load_dwordx4 v73, s[24:27], s16 offen offset:0 sc1 lds
    buffer_load_dwordx4 v73, s[24:27], s16 offen offset:1024 sc1 lds
    buffer_load_dwordx4 v73, s[24:27], s16 offen offset:2048 sc1 lds
    buffer_load_dwordx4 v73, s[24:27], s16 offen offset:3072 sc1 lds
    s_cmp_ge_u32 2, s22
    s_cbranch_scc1 k1f_kernel_lq7
    s_add_u32 m0, s46, 0
    s_mov_b32 s16, 24576
    buffer_load_dwordx4 v72, s[24:27], s16 offen offset:0 sc1 lds
    buffer_load_dwordx4 v72, s[24:27], s16 offen offset:1024 sc1 lds
    buffer_load_dwordx4 v72, s[24:27], s16 offen offset:2048 sc1 lds
    buffer_load_dwordx4 v72, s[24:27], s16 offen offset:3072 sc1 lds
    s_cmp_ge_u32 3, s22
    s_cbranch_scc1 k1f_kernel_lq7
    s_add_u32 m0, s46, 16384
    s_mov_b32 s16, 24576
    buffer_load_dwordx4 v73, s[24:27], s16 offen offset:0 sc1 lds
    buffer_load_dwordx4 v73, s[24:27], s16 offen offset:1024 sc1 lds
    buffer_load_dwordx4 v73, s[24:27], s16 offen offset:2048 sc1 lds
    buffer_load_dwordx4 v73, s[24:27], s16 offen offset:3072 sc1 lds
    s_cmp_ge_u32 3, s22
    s_cbranch_scc1 k1f_kernel_lq7
    s_add_u32 m0, s47, 0
    s_mov_b32 s16, 28672
    buffer_load_dwordx4 v72, s[24:27], s16 offen offset:0 sc1 lds
    buffer_load_dwordx4 v72, s[24:27], s16 offen offset:1024 sc1 lds
    buffer_load_dwordx4 v72, s[24:27], s16 offen offset:2048 sc1 lds
    buffer_load_dwordx4 v72, s[24:27], s16 offen offset:3072 sc1 lds
k1f_kernel_lq7:
    s_barrier
    s_add_u32 m0, s47, 16384
    s_mov_b32 s16, 28672
    buffer_load_dwordx4 v73, s[24:27], s16 offen offset:0 sc1 lds
    buffer_load_dwordx4 v73, s[24:27], s16 offen offset:1024 sc1 lds
    buffer_load_dwordx4 v73, s[24:27], s16 offen offset:2048 sc1 lds
    buffer_load_dwordx4 v73, s[24:27], s16 offen offset:3072 sc1 lds
    s_add_u32 m0, s33, 0
    s_mov_b32 s16, 32768
    buffer_load_dwordx4 v72, s[24:27], s16 offen offset:0 sc1 lds
    buffer_load_dwordx4 v72, s[24:27], s16 offen offset:1024 sc1 lds
    buffer_load_dwordx4 v72, s[24:27], s16 offen offset:2048 sc1 lds
    buffer_load_dwordx4 v72, s[24:27], s16 offen offset:3072 sc1 lds
    buffer_load_dwordx4 v[64:67], v77, s[8:11], s17 offen offset:0
    buffer_load_dwordx4 v[68:71], v77, s[8:11], s17 offen offset:32
    v_lshrrev_b32 v79, 1, v76
    v_and_b32 v79, 0x78, v79
    s_lshl_b32 s6, s4, 2
    s_add_u32 s6, s6, s12
    s_lshl_b32 s6, s6, 7
    s_add_u32 s20, s6, 0x3b98000
    s_mov_b32 s19, 0x40000
    buffer_load_dwordx2 v[0:1], v79, s[24:27], s20 offen sc1
    s_sleep 8
    buffer_load_dwordx2 v[2:3], v79, s[24:27], s20 offen sc1
k1f_kernel_cx:
    s_waitcnt vmcnt(1)
    v_cmp_eq_u64 vcc, s[64:65], v[0:1]
    s_cmp_eq_u64 vcc, -1
    s_cbranch_scc1 k1f_kernel_cxd
    buffer_load_dwordx2 v[0:1], v79, s[24:27], s20 offen sc1
    s_waitcnt vmcnt(1)
    v_cmp_eq_u64 vcc, s[64:65], v[2:3]
    s_cmp_eq_u64 vcc, -1
    s_cbranch_scc1 k1f_kernel_cxd
    buffer_load_dwordx2 v[2:3], v79, s[24:27], s20 offen sc1
    s_sub_u32 s19, s19, 1
    s_cbranch_scc0 k1f_kernel_cx
k1f_kernel_cxd:
    s_mov_b32 s15, 0
    buffer_load_dwordx4 v[208:211], v74, s[24:27], s15 offen offset:0 sc1
    buffer_load_dwordx4 v[212:215], v75, s[24:27], s15 offen offset:0 sc1
    buffer_load_dwordx4 v[216:219], v74, s[24:27], s15 offen offset:1024 sc1
    buffer_load_dwordx4 v[220:223], v75, s[24:27], s15 offen offset:1024 sc1
    buffer_load_dwordx4 v[224:227], v74, s[24:27], s15 offen offset:2048 sc1
    buffer_load_dwordx4 v[228:231], v75, s[24:27], s15 offen offset:2048 sc1
    buffer_load_dwordx4 v[232:235], v74, s[24:27], s15 offen offset:3072 sc1
    buffer_load_dwordx4 v[236:239], v75, s[24:27], s15 offen offset:3072 sc1
    s_mov_b32 s15, 4096
    buffer_load_dwordx4 v[240:243], v74, s[24:27], s15 offen offset:0 sc1
    buffer_load_dwordx4 v[244:247], v75, s[24:27], s15 offen offset:0 sc1
    s_waitcnt vmcnt(9)
    v_mfma_f32_32x32x16_bf16 v[0:15], v[80:83], v[208:211], 0
    buffer_load_dwordx4 v[248:251], v74, s[24:27], s15 offen offset:1024 sc1
    s_waitcnt vmcnt(9)
    v_mfma_f32_32x32x16_bf16 v[16:31], v[80:83], v[212:215], 0
    buffer_load_dwordx4 v[252:255], v75, s[24:27], s15 offen offset:1024 sc1
    v_mfma_f32_32x32x16_bf16 v[48:63], v[96:99], v[212:215], 0
    v_mfma_f32_32x32x16_bf16 v[32:47], v[96:99], v[208:211], 0
    s_waitcnt vmcnt(9)
    v_mfma_f32_32x32x16_bf16 v[0:15], v[84:87], v[216:219], v[0:15]
    buffer_load_dwordx4 v[80:83], v74, s[24:27], s15 offen offset:2048 sc1
    s_waitcnt vmcnt(9)
    v_mfma_f32_32x32x16_bf16 v[16:31], v[84:87], v[220:223], v[16:31]
    buffer_load_dwordx4 v[96:99], v75, s[24:27], s15 offen offset:2048 sc1
    v_mfma_f32_32x32x16_bf16 v[48:63], v[100:103], v[220:223], v[48:63]
    buffer_load_dwordx4 v[208:211], v74, s[24:27], s15 offen offset:3072 sc1
    v_mfma_f32_32x32x16_bf16 v[32:47], v[100:103], v[216:219], v[32:47]
    buffer_load_dwordx4 v[212:215], v75, s[24:27], s15 offen offset:3072 sc1
    s_waitcnt vmcnt(11)
    v_mfma_f32_32x32x16_bf16 v[0:15], v[88:91], v[224:227], v[0:15]
    s_mov_b32 s15, 8192
    buffer_load_dwordx4 v[84:87], v74, s[24:27], s15 offen offset:0 sc1
    s_waitcnt vmcnt(11)
    v_mfma_f32_32x32x16_bf16 v[16:31], v[88:91], v[228:231], v[16:31]
    buffer_load_dwordx4 v[100:103], v75, s[24:27], s15 offen offset:0 sc1
    v_mfma_f32_32x32x16_bf16 v[48:63], v[104:107], v[228:231], v[48:63]
    buffer_load_dwordx4 v[216:219], v74, s[24:27], s15 offen offset:1024 sc1
    v_mfma_f32_32x32x16_bf16 v[32:47], v[104:107], v[224:227], v[32:47]
    buffer_load_dwordx4 v[220:223], v75, s[24:27], s15 offen offset:1024 sc1
    s_waitcnt vmcnt(13)
    v_mfma_f32_32x32x16_bf16 v[0:15], v[92:95], v[232:235], v[0:15]
    buffer_load_dwordx4 v[88:91], v74, s[24:27], s15 offen offset:2048 sc1
    s_waitcnt vmcnt(13)
    v_mfma_f32_32x32x16_bf16 v[16:31], v[92:95], v[236:239], v[16:31]
    buffer_load_dwordx4 v[104:107], v75, s[24:27], s15 offen offset:2048 sc1
    v_mfma_f32_32x32x16_bf16 v[48:63], v[108:111], v[236:239], v[48:63]
    buffer_load_dwordx4 v[224:227], v74, s[24:27], s15 offen offset:3072 sc1
    v_mfma_f32_32x32x16_bf16 v[32:47], v[108:111], v[232:235], v[32:47]
    buffer_load_dwordx4 v[228:231], v75, s[24:27], s15 offen offset:3072 sc1
    s_waitcnt vmcnt(15)
    v_mfma_f32_32x32x16_bf16 v[0:15], v[112:115], v[240:243], v[0:15]
    s_mov_b32 s15, 12288
    buffer_load_dwordx4 v[92:95], v74, s[24:27], s15 offen offset:0 sc1
    s_waitcnt vmcnt(15)
    v_mfma_f32_32x32x16_bf16 v[16:31], v[112:115], v[244:247], v[16:31]
    buffer_load_dwordx4 v[108:111], v75, s[24:27], s15 offen offset:0 sc1
    v_mfma_f32_32x32x16_bf16 v[48:63], v[128:131], v[244:247], v[48:63]
    buffer_load_dwordx4 v[232:235], v74, s[24:27], s15 offen offset:1024 sc1
    v_mfma_f32_32x32x16_bf16 v[32:47], v[128:131], v[240:243], v[32:47]
    buffer_load_dwordx4 v[236:239], v75, s[24:27], s15 offen offset:1024 sc1
    s_waitcnt vmcnt(17)
    v_mfma_f32_32x32x16_bf16 v[0:15], v[116:119], v[248:251], v[0:15]
    buffer_load_dwordx4 v[112:115], v74, s[24:27], s15 offen offset:2048 sc1
    s_waitcnt vmcnt(17)
    v_mfma_f32_32x32x16_bf16 v[16:31], v[116:119], v[252:255], v[16:31]
    buffer_load_dwordx4 v[128:131], v75, s[24:27], s15 offen offset:2048 sc1
    v_mfma_f32_32x32x16_bf16 v[48:63], v[132:135], v[252:255], v[48:63]
    buffer_load_dwordx4 v[240:243], v74, s[24:27], s15 offen offset:3072 sc1
    v_mfma_f32_32x32x16_bf16 v[32:47], v[132:135], v[248:251], v[32:47]
    buffer_load_dwordx4 v[244:247], v75, s[24:27], s15 offen offset:3072 sc1
    s_waitcnt vmcnt(19)
    v_mfma_f32_32x32x16_bf16 v[0:15], v[120:123], v[80:83], v[0:15]
    s_mov_b32 s15, 16384
    buffer_load_dwordx4 v[116:119], v74, s[24:27], s15 offen offset:0 sc1
    s_waitcnt vmcnt(19)
    v_mfma_f32_32x32x16_bf16 v[16:31], v[120:123], v[96:99], v[16:31]
    buffer_load_dwordx4 v[132:135], v75, s[24:27], s15 offen offset:0 sc1
    v_mfma_f32_32x32x16_bf16 v[48:63], v[136:139], v[96:99], v[48:63]
    buffer_load_dwordx4 v[248:251], v74, s[24:27], s15 offen offset:1024 sc1
    v_mfma_f32_32x32x16_bf16 v[32:47], v[136:139], v[80:83], v[32:47]
    buffer_load_dwordx4 v[252:255], v75, s[24:27], s15 offen offset:1024 sc1
    s_waitcnt vmcnt(21)
    v_mfma_f32_32x32x16_bf16 v[0:15], v[124:127], v[208:211], v[0:15]
    buffer_load_dwordx4 v[120:123], v74, s[24:27], s15 offen offset:2048 sc1
    s_waitcnt vmcnt(21)
    v_mfma_f32_32x32x16_bf16 v[16:31], v[124:127], v[212:215], v[16:31]
    buffer_load_dwordx4 v[136:139], v75, s[24:27], s15 offen offset:2048 sc1
    v_mfma_f32_32x32x16_bf16 v[48:63], v[140:143], v[212:215], v[48:63]
    buffer_load_dwordx4 v[80:83], v74, s[24:27], s15 offen offset:3072 sc1
    v_mfma_f32_32x32x16_bf16 v[32:47], v[140:143], v[208:211], v[32:47]
    buffer_load_dwordx4 v[96:99], v75, s[24:27], s15 offen offset:3072 sc1
    s_waitcnt vmcnt(23)
    v_mfma_f32_32x32x16_bf16 v[0:15], v[144:147], v[84:87], v[0:15]
    s_mov_b32 s15, 20480
    buffer_load_dwordx4 v[124:127], v74, s[24:27], s15 offen offset:0 sc1
    s_waitcnt vmcnt(23)
    v_mfma_f32_32x32x16_bf16 v[16:31], v[144:147], v[100:103], v[16:31]
    buffer_load_dwordx4 v[140:143], v75, s[24:27], s15 offen offset:0 sc1
    v_mfma_f32_32x32x16_bf16 v[48:63], v[160:163], v[100:103], v[48:63]
    buffer_load_dwordx4 v[208:211], v74, s[24:27], s15 offen offset:1024 sc1
    v_mfma_f32_32x32x16_bf16 v[32:47], v[160:163], v[84:87], v[32:47]
    buffer_load_dwordx4 v[212:215], v75, s[24:27], s15 offen offset:1024 sc1
    s_waitcnt vmcnt(25)
    v_mfma_f32_32x32x16_bf16 v[0:15], v[148:151], v[216:219], v[0:15]
    buffer_load_dwordx4 v[144:147], v74, s[24:27], s15 offen offset:2048 sc1
    s_waitcnt vmcnt(25)
    v_mfma_f32_32x32x16_bf16 v[16:31], v[148:151], v[220:223], v[16:31]
    buffer_load_dwordx4 v[160:163], v75, s[24:27], s15 offen offset:2048 sc1
    v_mfma_f32_32x32x16_bf16 v[48:63], v[164:167], v[220:223], v[48:63]
    buffer_load_dwordx4 v[84:87], v74, s[24:27], s15 offen offset:3072 sc1
    v_mfma_f32_32x32x16_bf16 v[32:47], v[164:167], v[216:219], v[32:47]
    buffer_load_dwordx4 v[100:103], v75, s[24:27], s15 offen offset:3072 sc1
    s_waitcnt vmcnt(27)
    v_mfma_f32_32x32x16_bf16 v[0:15], v[152:155], v[88:91], v[0:15]
    s_mov_b32 s15, 24576
    buffer_load_dwordx4 v[148:151], v74, s[24:27], s15 offen offset:0 sc1
    s_waitcnt vmcnt(27)
    v_mfma_f32_32x32x16_bf16 v[16:31], v[152:155], v[104:107], v[16:31]
    buffer_load_dwordx4 v[164:167], v75, s[24:27], s15 offen offset:0 sc1
    v_mfma_f32_32x32x16_bf16 v[48:63], v[168:171], v[104:107], v[48:63]
    buffer_load_dwordx4 v[216:219], v74, s[24:27], s15 offen offset:1024 sc1
    v_mfma_f32_32x32x16_bf16 v[32:47], v[168:171], v[88:91], v[32:47]
    buffer_load_dwordx4 v[220:223], v75, s[24:27], s15 offen offset:1024 sc1
    s_waitcnt vmcnt(29)
    v_mfma_f32_32x32x16_bf16 v[0:15], v[156:159], v[224:227], v[0:15]
    buffer_load_dwordx4 v[152:155], v74, s[24:27], s15 offen offset:2048 sc1
    s_waitcnt vmcnt(29)
    v_mfma_f32_32x32x16_bf16 v[16:31], v[156:159], v[228:231], v[16:31]
    buffer_load_dwordx4 v[168:171], v75, s[24:27], s15 offen offset:2048 sc1
    v_mfma_f32_32x32x16_bf16 v[48:63], v[172:175], v[228:231], v[48:63]
    buffer_load_dwordx4 v[88:91], v74, s[24:27], s15 offen offset:3072 sc1
    v_mfma_f32_32x32x16_bf16 v[32:47], v[172:175], v[224:227], v[32:47]
    buffer_load_dwordx4 v[104:107], v75, s[24:27], s15 offen offset:3072 sc1
    s_waitcnt vmcnt(31)
    v_mfma_f32_32x32x16_bf16 v[0:15], v[176:179], v[92:95], v[0:15]
    s_mov_b32 s15, 28672
    buffer_load_dwordx4 v[156:159], v74, s[24:27], s15 offen offset:0 sc1
    s_waitcnt vmcnt(31)
    v_mfma_f32_32x32x16_bf16 v[16:31], v[176:179], v[108:111], v[16:31]
    buffer_load_dwordx4 v[172:175], v75, s[24:27], s15 offen offset:0 sc1
    v_mfma_f32_32x32x16_bf16 v[48:63], v[192:195], v[108:111], v[48:63]
    buffer_load_dwordx4 v[224:227], v74, s[24:27], s15 offen offset:1024 sc1
    v_mfma_f32_32x32x16_bf16 v[32:47], v[192:195], v[92:95], v[32:47]
    buffer_load_dwordx4 v[228:231], v75, s[24:27], s15 offen offset:1024 sc1
    s_waitcnt vmcnt(33)
    v_mfma_f32_32x32x16_bf16 v[0:15], v[180:183], v[232:235], v[0:15]
    buffer_load_dwordx4 v[176:179], v74, s[24:27], s15 offen offset:2048 sc1
    s_waitcnt vmcnt(33)
    v_mfma_f32_32x32x16_bf16 v[16:31], v[180:183], v[236:239], v[16:31]
    buffer_load_dwordx4 v[192:195], v75, s[24:27], s15 offen offset:2048 sc1
    v_mfma_f32_32x32x16_bf16 v[48:63], v[196:199], v[236:239], v[48:63]
    buffer_load_dwordx4 v[92:95], v74, s[24:27], s15 offen offset:3072 sc1
    v_mfma_f32_32x32x16_bf16 v[32:47], v[196:199], v[232:235], v[32:47]
    buffer_load_dwordx4 v[108:111], v75, s[24:27], s15 offen offset:3072 sc1
    s_waitcnt vmcnt(35)
    v_mfma_f32_32x32x16_bf16 v[0:15], v[184:187], v[112:115], v[0:15]
    v_add_u32 v78, s44, v76
    ds_read_b128 v[180:183], v78 offset:0
    ds_read_b128 v[196:199], v78 offset:16384
    s_mov_b32 s15, 32768
    buffer_load_dwordx4 v[232:235], v74, s[24:27], s15 offen offset:0 sc1
    s_waitcnt vmcnt(35)
    v_mfma_f32_32x32x16_bf16 v[16:31], v[184:187], v[128:131], v[16:31]
    buffer_load_dwordx4 v[236:239], v75, s[24:27], s15 offen offset:0 sc1
    v_mfma_f32_32x32x16_bf16 v[48:63], v[200:203], v[128:131], v[48:63]
    v_mfma_f32_32x32x16_bf16 v[32:47], v[200:203], v[112:115], v[32:47]
    s_waitcnt vmcnt(35)
    v_mfma_f32_32x32x16_bf16 v[0:15], v[188:191], v[240:243], v[0:15]
    ds_read_b128 v[184:187], v78 offset:1024
    ds_read_b128 v[200:203], v78 offset:17408
    s_mov_b32 s16, 32768
    buffer_load_dwordx4 v[112:115], v73, s[24:27], s16 offen offset:0 sc1
    s_waitcnt vmcnt(35)
    v_mfma_f32_32x32x16_bf16 v[16:31], v[188:191], v[244:247], v[16:31]
    buffer_load_dwordx4 v[128:131], v74, s[24:27], s15 offen offset:1024 sc1
    v_mfma_f32_32x32x16_bf16 v[48:63], v[204:207], v[244:247], v[48:63]
    v_mfma_f32_32x32x16_bf16 v[32:47], v[204:207], v[240:243], v[32:47]
    s_waitcnt vmcnt(35) lgkmcnt(3)
    v_mfma_f32_32x32x16_bf16 v[0:15], v[180:183], v[116:119], v[0:15]
    ds_read_b128 v[188:191], v78 offset:2048
    ds_read_b128 v[204:207], v78 offset:18432
    buffer_load_dwordx4 v[240:243], v75, s[24:27], s15 offen offset:1024 sc1
    s_waitcnt vmcnt(35)
    v_mfma_f32_32x32x16_bf16 v[16:31], v[180:183], v[132:135], v[16:31]
    buffer_load_dwordx4 v[244:247], v73, s[24:27], s16 offen offset:1024 sc1
    s_waitcnt lgkmcnt(4)
    v_mfma_f32_32x32x16_bf16 v[48:63], v[196:199], v[132:135], v[48:63]
    v_mfma_f32_32x32x16_bf16 v[32:47], v[196:199], v[116:119], v[32:47]
    s_waitcnt vmcnt(35) lgkmcnt(3)
    v_mfma_f32_32x32x16_bf16 v[0:15], v[184:187], v[248:251], v[0:15]
    ds_read_b128 v[180:183], v78 offset:3072
    ds_read_b128 v[196:199], v78 offset:19456
    buffer_load_dwordx4 v[116:119], v74, s[24:27], s15 offen offset:2048 sc1
    s_waitcnt vmcnt(35)
    v_mfma_f32_32x32x16_bf16 v[16:31], v[184:187], v[252:255], v[16:31]
    buffer_load_dwordx4 v[132:135], v75, s[24:27], s15 offen offset:2048 sc1
    s_waitcnt lgkmcnt(4)
    v_mfma_f32_32x32x16_bf16 v[48:63], v[200:203], v[252:255], v[48:63]
    v_mfma_f32_32x32x16_bf16 v[32:47], v[200:203], v[248:251], v[32:47]
    s_waitcnt vmcnt(35) lgkmcnt(3)
    v_mfma_f32_32x32x16_bf16 v[0:15], v[188:191], v[120:123], v[0:15]
    v_add_u32 v78, s45, v76
    ds_read_b128 v[184:187], v78 offset:0
    ds_read_b128 v[200:203], v78 offset:16384
    buffer_load_dwordx4 v[248:251], v73, s[24:27], s16 offen offset:2048 sc1
    s_waitcnt vmcnt(35)
    v_mfma_f32_32x32x16_bf16 v[16:31], v[188:191], v[136:139], v[16:31]
    buffer_load_dwordx4 v[252:255], v74, s[24:27], s15 offen offset:3072 sc1
    s_waitcnt lgkmcnt(4)
    v_mfma_f32_32x32x16_bf16 v[48:63], v[204:207], v[136:139], v[48:63]
    v_mfma_f32_32x32x16_bf16 v[32:47], v[204:207], v[120:123], v[32:47]
    s_waitcnt vmcnt(35) lgkmcnt(3)
    v_mfma_f32_32x32x16_bf16 v[0:15], v[180:183], v[80:83], v[0:15]
    ds_read_b128 v[188:191], v78 offset:1024
    ds_read_b128 v[204:207], v78 offset:17408
    buffer_load_dwordx4 v[120:123], v75, s[24:27], s15 offen offset:3072 sc1
    s_waitcnt vmcnt(35)
    v_mfma_f32_32x32x16_bf16 v[16:31], v[180:183], v[96:99], v[16:31]
    buffer_load_dwordx4 v[136:139], v73, s[24:27], s16 offen offset:3072 sc1
    s_waitcnt lgkmcnt(4)
    v_mfma_f32_32x32x16_bf16 v[48:63], v[196:199], v[96:99], v[48:63]
    v_mfma_f32_32x32x16_bf16 v[32:47], v[196:199], v[80:83], v[32:47]
    s_waitcnt vmcnt(35) lgkmcnt(3)
    v_mfma_f32_32x32x16_bf16 v[0:15], v[184:187], v[124:127], v[0:15]
    ds_read_b128 v[180:183], v78 offset:2048
    ds_read_b128 v[196:199], v78 offset:18432
    s_mov_b32 s16, 36864
    buffer_load_dwordx4 v[80:83], v72, s[24:27], s16 offen offset:0 sc1
    s_waitcnt vmcnt(35)
    v_mfma_f32_32x32x16_bf16 v[16:31], v[184:187], v[140:143], v[16:31]
    s_mov_b32 s15, 36864
    buffer_load_dwordx4 v[96:99], v74, s[24:27], s15 offen offset:0 sc1
    s_waitcnt lgkmcnt(4)
    v_mfma_f32_32x32x16_bf16 v[48:63], v[200:203], v[140:143], v[48:63]
    v_mfma_f32_32x32x16_bf16 v[32:47], v[200:203], v[124:127], v[32:47]
    s_waitcnt vmcnt(35) lgkmcnt(3)
    v_mfma_f32_32x32x16_bf16 v[0:15], v[188:191], v[208:211], v[0:15]
    ds_read_b128 v[184:187], v78 offset:3072
    ds_read_b128 v[200:203], v78 offset:19456
    buffer_load_dwordx4 v[124:127], v75, s[24:27], s15 offen offset:0 sc1
    s_waitcnt vmcnt(35)
    v_mfma_f32_32x32x16_bf16 v[16:31], v[188:191], v[212:215], v[16:31]
    buffer_load_dwordx4 v[140:143], v73, s[24:27], s16 offen offset:0 sc1
    s_waitcnt lgkmcnt(4)
    v_mfma_f32_32x32x16_bf16 v[48:63], v[204:207], v[212:215], v[48:63]
    v_mfma_f32_32x32x16_bf16 v[32:47], v[204:207], v[208:211], v[32:47]
    s_waitcnt vmcnt(35) lgkmcnt(3)
    v_mfma_f32_32x32x16_bf16 v[0:15], v[180:183], v[144:147], v[0:15]
    v_add_u32 v78, s46, v76
    ds_read_b128 v[188:191], v78 offset:0
    ds_read_b128 v[204:207], v78 offset:16384
    buffer_load_dwordx4 v[208:211], v72, s[24:27], s16 offen offset:1024 sc1
    s_waitcnt vmcnt(35)
    v_mfma_f32_32x32x16_bf16 v[16:31], v[180:183], v[160:163], v[16:31]
    buffer_load_dwordx4 v[212:215], v74, s[24:27], s15 offen offset:1024 sc1
    s_waitcnt lgkmcnt(4)
    v_mfma_f32_32x32x16_bf16 v[48:63], v[196:199], v[160:163], v[48:63]
    v_mfma_f32_32x32x16_bf16 v[32:47], v[196:199], v[144:147], v[32:47]
    s_waitcnt vmcnt(35) lgkmcnt(3)
    v_mfma_f32_32x32x16_bf16 v[0:15], v[184:187], v[84:87], v[0:15]
    ds_read_b128 v[180:183], v78 offset:1024
    ds_read_b128 v[196:199], v78 offset:17408
    buffer_load_dwordx4 v[144:147], v75, s[24:27], s15 offen offset:1024 sc1
    s_waitcnt vmcnt(35)
    v_mfma_f32_32x32x16_bf16 v[16:31], v[184:187], v[100:103], v[16:31]
    buffer_load_dwordx4 v[160:163], v73, s[24:27], s16 offen offset:1024 sc1
    s_waitcnt lgkmcnt(4)
    v_mfma_f32_32x32x16_bf16 v[48:63], v[200:203], v[100:103], v[48:63]
    v_mfma_f32_32x32x16_bf16 v[32:47], v[200:203], v[84:87], v[32:47]
    s_waitcnt vmcnt(35) lgkmcnt(3)
    v_mfma_f32_32x32x16_bf16 v[0:15], v[188:191], v[148:151], v[0:15]
    ds_read_b128 v[184:187], v78 offset:2048
    ds_read_b128 v[200:203], v78 offset:18432
    buffer_load_dwordx4 v[84:87], v72, s[24:27], s16 offen offset:2048 sc1
    s_waitcnt vmcnt(35)
    v_mfma_f32_32x32x16_bf16 v[16:31], v[188:191], v[164:167], v[16:31]
    buffer_load_dwordx4 v[100:103], v74, s[24:27], s15 offen offset:2048 sc1
    s_waitcnt lgkmcnt(4)
    v_mfma_f32_32x32x16_bf16 v[48:63], v[204:207], v[164:167], v[48:63]
    v_mfma_f32_32x32x16_bf16 v[32:47], v[204:207], v[148:151], v[32:47]
    s_waitcnt vmcnt(35) lgkmcnt(3)
    v_mfma_f32_32x32x16_bf16 v[0:15], v[180:183], v[216:219], v[0:15]
    ds_read_b128 v[188:191], v78 offset:3072
    ds_read_b128 v[204:207], v78 offset:19456
    buffer_load_dwordx4 v[148:151], v75, s[24:27], s15 offen offset:2048 sc1
    s_waitcnt vmcnt(35)
    v_mfma_f32_32x32x16_bf16 v[16:31], v[180:183], v[220:223], v[16:31]
    buffer_load_dwordx4 v[164:167], v73, s[24:27], s16 offen offset:2048 sc1
    s_waitcnt lgkmcnt(4)
    v_mfma_f32_32x32x16_bf16 v[48:63], v[196:199], v[220:223], v[48:63]
    v_mfma_f32_32x32x16_bf16 v[32:47], v[196:199], v[216:219], v[32:47]
    s_waitcnt vmcnt(35) lgkmcnt(3)
    v_mfma_f32_32x32x16_bf16 v[0:15], v[184:187], v[152:155], v[0:15]
    v_add_u32 v78, s47, v76
    ds_read_b128 v[180:183], v78 offset:0
    ds_read_b128 v[196:199], v78 offset:16384
    buffer_load_dwordx4 v[216:219], v72, s[24:27], s16 offen offset:3072 sc1
    s_waitcnt vmcnt(35)
    v_mfma_f32_32x32x16_bf16 v[16:31], v[184:187], v[168:171], v[16:31]
    buffer_load_dwordx4 v[220:223], v74, s[24:27], s15 offen offset:3072 sc1
    s_waitcnt lgkmcnt(4)
    v_mfma_f32_32x32x16_bf16 v[48:63], v[200:203], v[168:171], v[48:63]
    v_mfma_f32_32x32x16_bf16 v[32:47], v[200:203], v[152:155], v[32:47]
    s_waitcnt vmcnt(35) lgkmcnt(3)
    v_mfma_f32_32x32x16_bf16 v[0:15], v[188:191], v[88:91], v[0:15]
    ds_read_b128 v[184:187], v78 offset:1024
    ds_read_b128 v[200:203], v78 offset:17408
    buffer_load_dwordx4 v[152:155], v75, s[24:27], s15 offen offset:3072 sc1
    s_waitcnt vmcnt(35)
    v_mfma_f32_32x32x16_bf16 v[16:31], v[188:191], v[104:107], v[16:31]
    buffer_load_dwordx4 v[168:171], v73, s[24:27], s16 offen offset:3072 sc1
    s_waitcnt lgkmcnt(4)
    v_mfma_f32_32x32x16_bf16 v[48:63], v[204:207], v[104:107], v[48:63]
    v_mfma_f32_32x32x16_bf16 v[32:47], v[204:207], v[88:91], v[32:47]
    s_waitcnt vmcnt(35) lgkmcnt(3)
    v_mfma_f32_32x32x16_bf16 v[0:15], v[180:183], v[156:159], v[0:15]
    ds_read_b128 v[188:191], v78 offset:2048
    ds_read_b128 v[204:207], v78 offset:18432
    s_mov_b32 s16, 40960
    buffer_load_dwordx4 v[88:91], v72, s[24:27], s16 offen offset:0 sc1
    s_waitcnt vmcnt(35)
    v_mfma_f32_32x32x16_bf16 v[16:31], v[180:183], v[172:175], v[16:31]
    s_mov_b32 s15, 40960
    buffer_load_dwordx4 v[104:107], v74, s[24:27], s15 offen offset:0 sc1
    s_waitcnt lgkmcnt(4)
    v_mfma_f32_32x32x16_bf16 v[48:63], v[196:199], v[172:175], v[48:63]
    v_mfma_f32_32x32x16_bf16 v[32:47], v[196:199], v[156:159], v[32:47]
    s_waitcnt vmcnt(35) lgkmcnt(3)
    v_mfma_f32_32x32x16_bf16 v[0:15], v[184:187], v[224:227], v[0:15]
    ds_read_b128 v[180:183], v78 offset:3072
    ds_read_b128 v[196:199], v78 offset:19456
    buffer_load_dwordx4 v[156:159], v75, s[24:27], s15 offen offset:0 sc1
    s_waitcnt vmcnt(35)
    v_mfma_f32_32x32x16_bf16 v[16:31], v[184:187], v[228:231], v[16:31]
    buffer_load_dwordx4 v[172:175], v73, s[24:27], s16 offen offset:0 sc1
    s_waitcnt lgkmcnt(4)
    v_mfma_f32_32x32x16_bf16 v[48:63], v[200:203], v[228:231], v[48:63]
    v_mfma_f32_32x32x16_bf16 v[32:47], v[200:203], v[224:227], v[32:47]
    s_waitcnt vmcnt(35) lgkmcnt(3)
    v_mfma_f32_32x32x16_bf16 v[0:15], v[188:191], v[176:179], v[0:15]
    v_add_u32 v78, s33, v76
    ds_read_b128 v[184:187], v78 offset:0
    buffer_load_dwordx4 v[200:203], v72, s[24:27], s16 offen offset:1024 sc1
    s_waitcnt vmcnt(35)
    v_mfma_f32_32x32x16_bf16 v[16:31], v[188:191], v[192:195], v[16:31]
    buffer_load_dwordx4 v[224:227], v74, s[24:27], s15 offen offset:1024 sc1
    s_waitcnt lgkmcnt(3)
    v_mfma_f32_32x32x16_bf16 v[48:63], v[204:207], v[192:195], v[48:63]
    buffer_load_dwordx4 v[228:231], v75, s[24:27], s15 offen offset:1024 sc1
    v_mfma_f32_32x32x16_bf16 v[32:47], v[204:207], v[176:179], v[32:47]
    s_waitcnt vmcnt(36) lgkmcnt(2)
    v_mfma_f32_32x32x16_bf16 v[0:15], v[180:183], v[92:95], v[0:15]
    ds_read_b128 v[188:191], v78 offset:1024
    buffer_load_dwordx4 v[204:207], v73, s[24:27], s16 offen offset:1024 sc1
    s_waitcnt vmcnt(36)
    v_mfma_f32_32x32x16_bf16 v[16:31], v[180:183], v[108:111], v[16:31]
    buffer_load_dwordx4 v[176:179], v72, s[24:27], s16 offen offset:2048 sc1
    s_waitcnt lgkmcnt(2)
    v_mfma_f32_32x32x16_bf16 v[48:63], v[196:199], v[108:111], v[48:63]
    buffer_load_dwordx4 v[192:195], v74, s[24:27], s15 offen offset:2048 sc1
    v_mfma_f32_32x32x16_bf16 v[32:47], v[196:199], v[92:95], v[32:47]
    s_waitcnt vmcnt(37) lgkmcnt(1)
    v_mfma_f32_32x32x16_bf16 v[0:15], v[184:187], v[232:235], v[0:15]
    ds_read_b128 v[180:183], v78 offset:2048
    buffer_load_dwordx4 v[196:199], v75, s[24:27], s15 offen offset:2048 sc1
    s_waitcnt vmcnt(37)
    v_mfma_f32_32x32x16_bf16 v[16:31], v[184:187], v[236:239], v[16:31]
    buffer_load_dwordx4 v[92:95], v73, s[24:27], s16 offen offset:2048 sc1
    s_waitcnt vmcnt(37)
    v_mfma_f32_32x32x16_bf16 v[48:63], v[112:115], v[236:239], v[48:63]
    buffer_load_dwordx4 v[108:111], v72, s[24:27], s16 offen offset:3072 sc1
    v_mfma_f32_32x32x16_bf16 v[32:47], v[112:115], v[232:235], v[32:47]
    s_waitcnt vmcnt(37) lgkmcnt(1)
    v_mfma_f32_32x32x16_bf16 v[0:15], v[188:191], v[128:131], v[0:15]
    ds_read_b128 v[184:187], v78 offset:3072
    buffer_load_dwordx4 v[112:115], v74, s[24:27], s15 offen offset:3072 sc1
    s_waitcnt vmcnt(37)
    v_mfma_f32_32x32x16_bf16 v[16:31], v[188:191], v[240:243], v[16:31]
    buffer_load_dwordx4 v[232:235], v75, s[24:27], s15 offen offset:3072 sc1
    s_waitcnt vmcnt(37)
    v_mfma_f32_32x32x16_bf16 v[48:63], v[244:247], v[240:243], v[48:63]
    buffer_load_dwordx4 v[236:239], v73, s[24:27], s16 offen offset:3072 sc1
    v_mfma_f32_32x32x16_bf16 v[32:47], v[244:247], v[128:131], v[32:47]
    s_waitcnt vmcnt(37) lgkmcnt(1)
    v_mfma_f32_32x32x16_bf16 v[0:15], v[180:183], v[116:119], v[0:15]
    s_mov_b32 s16, 45056
    buffer_load_dwordx4 v[188:191], v72, s[24:27], s16 offen offset:0 sc1
    s_waitcnt vmcnt(37)
    v_mfma_f32_32x32x16_bf16 v[16:31], v[180:183], v[132:135], v[16:31]
    s_mov_b32 s15, 45056
    buffer_load_dwordx4 v[244:247], v74, s[24:27], s15 offen offset:0 sc1
    s_waitcnt vmcnt(37)
    v_mfma_f32_32x32x16_bf16 v[48:63], v[248:251], v[132:135], v[48:63]
    buffer_load_dwordx4 v[128:131], v75, s[24:27], s15 offen offset:0 sc1
    v_mfma_f32_32x32x16_bf16 v[32:47], v[248:251], v[116:119], v[32:47]
    buffer_load_dwordx4 v[240:243], v73, s[24:27], s16 offen offset:0 sc1
    s_waitcnt vmcnt(38) lgkmcnt(0)
    v_mfma_f32_32x32x16_bf16 v[0:15], v[184:187], v[252:255], v[0:15]
    buffer_load_dwordx4 v[180:183], v72, s[24:27], s16 offen offset:1024 sc1
    s_waitcnt vmcnt(38)
    v_mfma_f32_32x32x16_bf16 v[16:31], v[184:187], v[120:123], v[16:31]
    buffer_load_dwordx4 v[248:251], v74, s[24:27], s15 offen offset:1024 sc1
    s_waitcnt vmcnt(38)
    v_mfma_f32_32x32x16_bf16 v[48:63], v[136:139], v[120:123], v[48:63]
    buffer_load_dwordx4 v[116:119], v75, s[24:27], s15 offen offset:1024 sc1
    v_mfma_f32_32x32x16_bf16 v[32:47], v[136:139], v[252:255], v[32:47]
    buffer_load_dwordx4 v[132:135], v73, s[24:27], s16 offen offset:1024 sc1
    s_waitcnt vmcnt(38)
    v_mfma_f32_32x32x16_bf16 v[0:15], v[80:83], v[96:99], v[0:15]
    buffer_load_dwordx4 v[184:187], v72, s[24:27], s16 offen offset:2048 sc1
    s_waitcnt vmcnt(38)
    v_mfma_f32_32x32x16_bf16 v[16:31], v[80:83], v[124:127], v[16:31]
    buffer_load_dwordx4 v[136:139], v74, s[24:27], s15 offen offset:2048 sc1
    s_waitcnt vmcnt(38)
    v_mfma_f32_32x32x16_bf16 v[48:63], v[140:143], v[124:127], v[48:63]
    buffer_load_dwordx4 v[252:255], v75, s[24:27], s15 offen offset:2048 sc1
    v_mfma_f32_32x32x16_bf16 v[32:47], v[140:143], v[96:99], v[32:47]
    buffer_load_dwordx4 v[120:123], v73, s[24:27], s16 offen offset:2048 sc1
    s_waitcnt vmcnt(38)
    v_mfma_f32_32x32x16_bf16 v[0:15], v[208:211], v[212:215], v[0:15]
    buffer_load_dwordx4 v[80:83], v72, s[24:27], s16 offen offset:3072 sc1
    s_waitcnt vmcnt(38)
    v_mfma_f32_32x32x16_bf16 v[16:31], v[208:211], v[144:147], v[16:31]
    buffer_load_dwordx4 v[140:143], v74, s[24:27], s15 offen offset:3072 sc1
    s_waitcnt vmcnt(38)
    v_mfma_f32_32x32x16_bf16 v[48:63], v[160:163], v[144:147], v[48:63]
    buffer_load_dwordx4 v[96:99], v75, s[24:27], s15 offen offset:3072 sc1
    v_mfma_f32_32x32x16_bf16 v[32:47], v[160:163], v[212:215], v[32:47]
    buffer_load_dwordx4 v[124:127], v73, s[24:27], s16 offen offset:3072 sc1
    s_waitcnt vmcnt(38)
    v_mfma_f32_32x32x16_bf16 v[0:15], v[84:87], v[100:103], v[0:15]
    s_mov_b32 s16, 49152
    buffer_load_dwordx4 v[208:211], v72, s[24:27], s16 offen offset:0 sc1
    s_waitcnt vmcnt(38)
    v_mfma_f32_32x32x16_bf16 v[16:31], v[84:87], v[148:151], v[16:31]
    s_mov_b32 s15, 49152
    buffer_load_dwordx4 v[160:163], v74, s[24:27], s15 offen offset:0 sc1
    s_waitcnt vmcnt(38)
    v_mfma_f32_32x32x16_bf16 v[48:63], v[164:167], v[148:151], v[48:63]
    buffer_load_dwordx4 v[212:215], v75, s[24:27], s15 offen offset:0 sc1
    v_mfma_f32_32x32x16_bf16 v[32:47], v[164:167], v[100:103], v[32:47]
    buffer_load_dwordx4 v[144:147], v73, s[24:27], s16 offen offset:0 sc1
    s_waitcnt vmcnt(38)
    v_mfma_f32_32x32x16_bf16 v[0:15], v[216:219], v[220:223], v[0:15]
    buffer_load_dwordx4 v[84:87], v72, s[24:27], s16 offen offset:1024 sc1
    s_waitcnt vmcnt(38)
    v_mfma_f32_32x32x16_bf16 v[16:31], v[216:219], v[152:155], v[16:31]
    buffer_load_dwordx4 v[164:167], v74, s[24:27], s15 offen offset:1024 sc1
    s_waitcnt vmcnt(38)
    v_mfma_f32_32x32x16_bf16 v[48:63], v[168:171], v[152:155], v[48:63]
    buffer_load_dwordx4 v[100:103], v75, s[24:27], s15 offen offset:1024 sc1
    v_mfma_f32_32x32x16_bf16 v[32:47], v[168:171], v[220:223], v[32:47]
    buffer_load_dwordx4 v[148:151], v73, s[24:27], s16 offen offset:1024 sc1
    s_waitcnt vmcnt(38)
    v_mfma_f32_32x32x16_bf16 v[0:15], v[88:91], v[104:107], v[0:15]
    buffer_load_dwordx4 v[216:219], v72, s[24:27], s16 offen offset:2048 sc1
    s_waitcnt vmcnt(38)
    v_mfma_f32_32x32x16_bf16 v[16:31], v[88:91], v[156:159], v[16:31]
    buffer_load_dwordx4 v[168:171], v74, s[24:27], s15 offen offset:2048 sc1
    s_waitcnt vmcnt(38)
    v_mfma_f32_32x32x16_bf16 v[48:63], v[172:175], v[156:159], v[48:63]
    buffer_load_dwordx4 v[220:223], v75, s[24:27], s15 offen offset:2048 sc1
    v_mfma_f32_32x32x16_bf16 v[32:47], v[172:175], v[104:107], v[32:47]
    buffer_load_dwordx4 v[152:155], v73, s[24:27], s16 offen offset:2048 sc1
    s_waitcnt vmcnt(38)
    v_mfma_f32_32x32x16_bf16 v[0:15], v[200:203], v[224:227], v[0:15]
    buffer_load_dwordx4 v[88:91], v72, s[24:27], s16 offen offset:3072 sc1
    s_waitcnt vmcnt(38)
    v_mfma_f32_32x32x16_bf16 v[16:31], v[200:203], v[228:231], v[16:31]
    buffer_load_dwordx4 v[172:175], v74, s[24:27], s15 offen offset:3072 sc1
    s_waitcnt vmcnt(38)
    v_mfma_f32_32x32x16_bf16 v[48:63], v[204:207], v[228:231], v[48:63]
    buffer_load_dwordx4 v[104:107], v75, s[24:27], s15 offen offset:3072 sc1
    v_mfma_f32_32x32x16_bf16 v[32:47], v[204:207], v[224:227], v[32:47]
    buffer_load_dwordx4 v[156:159], v73, s[24:27], s16 offen offset:3072 sc1
    s_waitcnt vmcnt(38)
    v_mfma_f32_32x32x16_bf16 v[0:15], v[176:179], v[192:195], v[0:15]
    s_mov_b32 s16, 53248
    buffer_load_dwordx4 v[200:203], v72, s[24:27], s16 offen offset:0 sc1
    s_waitcnt vmcnt(38)
    v_mfma_f32_32x32x16_bf16 v[16:31], v[176:179], v[196:199], v[16:31]
    s_mov_b32 s15, 53248
    buffer_load_dwordx4 v[204:207], v74, s[24:27], s15 offen offset:0 sc1
    s_waitcnt vmcnt(38)
    v_mfma_f32_32x32x16_bf16 v[48:63], v[92:95], v[196:199], v[48:63]
    buffer_load_dwordx4 v[224:227], v75, s[24:27], s15 offen offset:0 sc1
    v_mfma_f32_32x32x16_bf16 v[32:47], v[92:95], v[192:195], v[32:47]
    buffer_load_dwordx4 v[228:231], v73, s[24:27], s16 offen offset:0 sc1
    s_waitcnt vmcnt(38)
    v_mfma_f32_32x32x16_bf16 v[0:15], v[108:111], v[112:115], v[0:15]
    buffer_load_dwordx4 v[176:179], v72, s[24:27], s16 offen offset:1024 sc1
    s_waitcnt vmcnt(38)
    v_mfma_f32_32x32x16_bf16 v[16:31], v[108:111], v[232:235], v[16:31]
    buffer_load_dwordx4 v[92:95], v74, s[24:27], s15 offen offset:1024 sc1
    s_waitcnt vmcnt(38)
    v_mfma_f32_32x32x16_bf16 v[48:63], v[236:239], v[232:235], v[48:63]
    buffer_load_dwordx4 v[192:195], v75, s[24:27], s15 offen offset:1024 sc1
    v_mfma_f32_32x32x16_bf16 v[32:47], v[236:239], v[112:115], v[32:47]
    buffer_load_dwordx4 v[196:199], v73, s[24:27], s16 offen offset:1024 sc1
    s_waitcnt vmcnt(38)
    v_mfma_f32_32x32x16_bf16 v[0:15], v[188:191], v[244:247], v[0:15]
    buffer_load_dwordx4 v[108:111], v72, s[24:27], s16 offen offset:2048 sc1
    s_waitcnt vmcnt(38)
    v_mfma_f32_32x32x16_bf16 v[16:31], v[188:191], v[128:131], v[16:31]
    buffer_load_dwordx4 v[236:239], v74, s[24:27], s15 offen offset:2048 sc1
    s_waitcnt vmcnt(38)
    v_mfma_f32_32x32x16_bf16 v[48:63], v[240:243], v[128:131], v[48:63]
    buffer_load_dwordx4 v[112:115], v75, s[24:27], s15 offen offset:2048 sc1
    v_mfma_f32_32x32x16_bf16 v[32:47], v[240:243], v[244:247], v[32:47]
    buffer_load_dwordx4 v[232:235], v73, s[24:27], s16 offen offset:2048 sc1
    s_waitcnt vmcnt(38)
    v_mfma_f32_32x32x16_bf16 v[0:15], v[180:183], v[248:251], v[0:15]
    buffer_load_dwordx4 v[188:191], v72, s[24:27], s16 offen offset:3072 sc1
    s_waitcnt vmcnt(38)
    v_mfma_f32_32x32x16_bf16 v[16:31], v[180:183], v[116:119], v[16:31]
    buffer_load_dwordx4 v[240:243], v74, s[24:27], s15 offen offset:3072 sc1
    s_waitcnt vmcnt(38)
    v_mfma_f32_32x32x16_bf16 v[48:63], v[132:135], v[116:119], v[48:63]
    buffer_load_dwordx4 v[244:247], v75, s[24:27], s15 offen offset:3072 sc1
    v_mfma_f32_32x32x16_bf16 v[32:47], v[132:135], v[248:251], v[32:47]
    buffer_load_dwordx4 v[128:131], v73, s[24:27], s16 offen offset:3072 sc1
    s_waitcnt vmcnt(38)
    v_mfma_f32_32x32x16_bf16 v[0:15], v[184:187], v[136:139], v[0:15]
    s_mov_b32 s16, 57344
    buffer_load_dwordx4 v[180:183], v72, s[24:27], s16 offen offset:0 sc1
    s_waitcnt vmcnt(38)
    v_mfma_f32_32x32x16_bf16 v[16:31], v[184:187], v[252:255], v[16:31]
    s_mov_b32 s15, 57344
    buffer_load_dwordx4 v[132:135], v74, s[24:27], s15 offen offset:0 sc1
    s_waitcnt vmcnt(38)
    v_mfma_f32_32x32x16_bf16 v[48:63], v[120:123], v[252:255], v[48:63]
    buffer_load_dwordx4 v[248:251], v75, s[24:27], s15 offen offset:0 sc1
    v_mfma_f32_32x32x16_bf16 v[32:47], v[120:123], v[136:139], v[32:47]
    buffer_load_dwordx4 v[116:119], v73, s[24:27], s16 offen offset:0 sc1
    s_waitcnt vmcnt(38)
    v_mfma_f32_32x32x16_bf16 v[0:15], v[80:83], v[140:143], v[0:15]
    buffer_load_dwordx4 v[184:187], v72, s[24:27], s16 offen offset:1024 sc1
    s_waitcnt vmcnt(38)
    v_mfma_f32_32x32x16_bf16 v[16:31], v[80:83], v[96:99], v[16:31]
    buffer_load_dwordx4 v[120:123], v74, s[24:27], s15 offen offset:1024 sc1
    s_waitcnt vmcnt(38)
    v_mfma_f32_32x32x16_bf16 v[48:63], v[124:127], v[96:99], v[48:63]
    buffer_load_dwordx4 v[136:139], v75, s[24:27], s15 offen offset:1024 sc1
    v_mfma_f32_32x32x16_bf16 v[32:47], v[124:127], v[140:143], v[32:47]
    buffer_load_dwordx4 v[252:255], v73, s[24:27], s16 offen offset:1024 sc1
    s_waitcnt vmcnt(38)
    v_mfma_f32_32x32x16_bf16 v[0:15], v[208:211], v[160:163], v[0:15]
    buffer_load_dwordx4 v[80:83], v72, s[24:27], s16 offen offset:2048 sc1
    s_waitcnt vmcnt(38)
    v_mfma_f32_32x32x16_bf16 v[16:31], v[208:211], v[212:215], v[16:31]
    buffer_load_dwordx4 v[124:127], v74, s[24:27], s15 offen offset:2048 sc1
    s_waitcnt vmcnt(38)
    v_mfma_f32_32x32x16_bf16 v[48:63], v[144:147], v[212:215], v[48:63]
    buffer_load_dwordx4 v[140:143], v75, s[24:27], s15 offen offset:2048 sc1
    v_mfma_f32_32x32x16_bf16 v[32:47], v[144:147], v[160:163], v[32:47]
    buffer_load_dwordx4 v[96:99], v73, s[24:27], s16 offen offset:2048 sc1
    s_waitcnt vmcnt(38)
    v_mfma_f32_32x32x16_bf16 v[0:15], v[84:87], v[164:167], v[0:15]
    buffer_load_dwordx4 v[208:211], v72, s[24:27], s16 offen offset:3072 sc1
    s_waitcnt vmcnt(38)
    v_mfma_f32_32x32x16_bf16 v[16:31], v[84:87], v[100:103], v[16:31]
    buffer_load_dwordx4 v[144:147], v74, s[24:27], s15 offen offset:3072 sc1
    s_waitcnt vmcnt(38)
    v_mfma_f32_32x32x16_bf16 v[48:63], v[148:151], v[100:103], v[48:63]
    buffer_load_dwordx4 v[160:163], v75, s[24:27], s15 offen offset:3072 sc1
    v_mfma_f32_32x32x16_bf16 v[32:47], v[148:151], v[164:167], v[32:47]
    buffer_load_dwordx4 v[212:215], v73, s[24:27], s16 offen offset:3072 sc1
    s_waitcnt vmcnt(38)
    v_mfma_f32_32x32x16_bf16 v[0:15], v[216:219], v[168:171], v[0:15]
    s_mov_b32 s16, 61440
    buffer_load_dwordx4 v[84:87], v72, s[24:27], s16 offen offset:0 sc1
    s_waitcnt vmcnt(38)
    v_mfma_f32_32x32x16_bf16 v[16:31], v[216:219], v[220:223], v[16:31]
    s_mov_b32 s15, 61440
    buffer_load_dwordx4 v[148:151], v74, s[24:27], s15 offen offset:0 sc1
    s_waitcnt vmcnt(38)
    v_mfma_f32_32x32x16_bf16 v[48:63], v[152:155], v[220:223], v[48:63]
    buffer_load_dwordx4 v[164:167], v75, s[24:27], s15 offen offset:0 sc1
    v_mfma_f32_32x32x16_bf16 v[32:47], v[152:155], v[168:171], v[32:47]
    buffer_load_dwordx4 v[100:103], v73, s[24:27], s16 offen offset:0 sc1
    s_waitcnt vmcnt(38)
    v_mfma_f32_32x32x16_bf16 v[0:15], v[88:91], v[172:175], v[0:15]
    buffer_load_dwordx4 v[216:219], v72, s[24:27], s16 offen offset:1024 sc1
    s_waitcnt vmcnt(38)
    v_mfma_f32_32x32x16_bf16 v[16:31], v[88:91], v[104:107], v[16:31]
    buffer_load_dwordx4 v[152:155], v74, s[24:27], s15 offen offset:1024 sc1
    s_waitcnt vmcnt(38)
    v_mfma_f32_32x32x16_bf16 v[48:63], v[156:159], v[104:107], v[48:63]
    buffer_load_dwordx4 v[168:171], v75, s[24:27], s15 offen offset:1024 sc1
    v_mfma_f32_32x32x16_bf16 v[32:47], v[156:159], v[172:175], v[32:47]
    buffer_load_dwordx4 v[220:223], v73, s[24:27], s16 offen offset:1024 sc1
    s_waitcnt vmcnt(38)
    v_mfma_f32_32x32x16_bf16 v[0:15], v[200:203], v[204:207], v[0:15]
    buffer_load_dwordx4 v[88:91], v72, s[24:27], s16 offen offset:2048 sc1
    s_waitcnt vmcnt(38)
    v_mfma_f32_32x32x16_bf16 v[16:31], v[200:203], v[224:227], v[16:31]
    buffer_load_dwordx4 v[156:159], v74, s[24:27], s15 offen offset:2048 sc1
    s_waitcnt vmcnt(38)
    v_mfma_f32_32x32x16_bf16 v[48:63], v[228:231], v[224:227], v[48:63]
    buffer_load_dwordx4 v[172:175], v75, s[24:27], s15 offen offset:2048 sc1
    v_mfma_f32_32x32x16_bf16 v[32:47], v[228:231], v[204:207], v[32:47]
    buffer_load_dwordx4 v[104:107], v73, s[24:27], s16 offen offset:2048 sc1
    s_waitcnt vmcnt(38)
    v_mfma_f32_32x32x16_bf16 v[0:15], v[176:179], v[92:95], v[0:15]
    buffer_load_dwordx4 v[200:203], v72, s[24:27], s16 offen offset:3072 sc1
    s_waitcnt vmcnt(38)
    v_mfma_f32_32x32x16_bf16 v[16:31], v[176:179], v[192:195], v[16:31]
    buffer_load_dwordx4 v[228:231], v74, s[24:27], s15 offen offset:3072 sc1
    s_waitcnt vmcnt(38)
    v_mfma_f32_32x32x16_bf16 v[48:63], v[196:199], v[192:195], v[48:63]
    buffer_load_dwordx4 v[204:207], v75, s[24:27], s15 offen offset:3072 sc1
    v_mfma_f32_32x32x16_bf16 v[32:47], v[196:199], v[92:95], v[32:47]
    buffer_load_dwordx4 v[224:227], v73, s[24:27], s16 offen offset:3072 sc1
    s_waitcnt vmcnt(38)
    v_mfma_f32_32x32x16_bf16 v[0:15], v[108:111], v[236:239], v[0:15]
    s_waitcnt vmcnt(37)
    v_mfma_f32_32x32x16_bf16 v[16:31], v[108:111], v[112:115], v[16:31]
    s_waitcnt vmcnt(36)
    v_mfma_f32_32x32x16_bf16 v[48:63], v[232:235], v[112:115], v[48:63]
    v_mfma_f32_32x32x16_bf16 v[32:47], v[232:235], v[236:239], v[32:47]
    s_waitcnt vmcnt(34)
    v_mfma_f32_32x32x16_bf16 v[0:15], v[188:191], v[240:243], v[0:15]
    s_waitcnt vmcnt(33)
    v_mfma_f32_32x32x16_bf16 v[16:31], v[188:191], v[244:247], v[16:31]
    s_waitcnt vmcnt(32)
    v_mfma_f32_32x32x16_bf16 v[48:63], v[128:131], v[244:247], v[48:63]
    v_mfma_f32_32x32x16_bf16 v[32:47], v[128:131], v[240:243], v[32:47]
    s_waitcnt vmcnt(30)
    v_mfma_f32_32x32x16_bf16 v[0:15], v[180:183], v[132:135], v[0:15]
    s_waitcnt vmcnt(29)
    v_mfma_f32_32x32x16_bf16 v[16:31], v[180:183], v[248:251], v[16:31]
    s_waitcnt vmcnt(28)
    v_mfma_f32_32x32x16_bf16 v[48:63], v[116:119], v[248:251], v[48:63]
    v_mfma_f32_32x32x16_bf16 v[32:47], v[116:119], v[132:135], v[32:47]
    s_waitcnt vmcnt(26)
    v_mfma_f32_32x32x16_bf16 v[0:15], v[184:187], v[120:123], v[0:15]
    s_waitcnt vmcnt(25)
    v_mfma_f32_32x32x16_bf16 v[16:31], v[184:187], v[136:139], v[16:31]
    s_waitcnt vmcnt(24)
    v_mfma_f32_32x32x16_bf16 v[48:63], v[252:255], v[136:139], v[48:63]
    v_mfma_f32_32x32x16_bf16 v[32:47], v[252:255], v[120:123], v[32:47]
    s_waitcnt vmcnt(22)
    v_mfma_f32_32x32x16_bf16 v[0:15], v[80:83], v[124:127], v[0:15]
    s_waitcnt vmcnt(21)
    v_mfma_f32_32x32x16_bf16 v[16:31], v[80:83], v[140:143], v[16:31]
    s_waitcnt vmcnt(20)
    v_mfma_f32_32x32x16_bf16 v[48:63], v[96:99], v[140:143], v[48:63]
    v_mfma_f32_32x32x16_bf16 v[32:47], v[96:99], v[124:127], v[32:47]
    s_waitcnt vmcnt(18)
    v_mfma_f32_32x32x16_bf16 v[0:15], v[208:211], v[144:147], v[0:15]
    s_waitcnt vmcnt(17)
    v_mfma_f32_32x32x16_bf16 v[16:31], v[208:211], v[160:163], v[16:31]
    s_waitcnt vmcnt(16)
    v_mfma_f32_32x32x16_bf16 v[48:63], v[212:215], v[160:163], v[48:63]
    v_mfma_f32_32x32x16_bf16 v[32:47], v[212:215], v[144:147], v[32:47]
    s_waitcnt vmcnt(14)
    v_mfma_f32_32x32x16_bf16 v[0:15], v[84:87], v[148:151], v[0:15]
    s_waitcnt vmcnt(13)
    v_mfma_f32_32x32x16_bf16 v[16:31], v[84:87], v[164:167], v[16:31]
    s_waitcnt vmcnt(12)
    v_mfma_f32_32x32x16_bf16 v[48:63], v[100:103], v[164:167], v[48:63]
    v_mfma_f32_32x32x16_bf16 v[32:47], v[100:103], v[148:151], v[32:47]
    s_waitcnt vmcnt(10)
    v_mfma_f32_32x32x16_bf16 v[0:15], v[216:219], v[152:155], v[0:15]
    s_waitcnt vmcnt(9)
    v_mfma_f32_32x32x16_bf16 v[16:31], v[216:219], v[168:171], v[16:31]
    s_waitcnt vmcnt(8)
    v_mfma_f32_32x32x16_bf16 v[48:63], v[220:223], v[168:171], v[48:63]
    v_mfma_f32_32x32x16_bf16 v[32:47], v[220:223], v[152:155], v[32:47]
    s_waitcnt vmcnt(6)
    v_mfma_f32_32x32x16_bf16 v[0:15], v[88:91], v[156:159], v[0:15]
    s_waitcnt vmcnt(5)
    v_mfma_f32_32x32x16_bf16 v[16:31], v[88:91], v[172:175], v[16:31]
    s_waitcnt vmcnt(4)
    v_mfma_f32_32x32x16_bf16 v[48:63], v[104:107], v[172:175], v[48:63]
    v_mfma_f32_32x32x16_bf16 v[32:47], v[104:107], v[156:159], v[32:47]
    s_waitcnt vmcnt(2)
    v_mfma_f32_32x32x16_bf16 v[0:15], v[200:203], v[228:231], v[0:15]
    s_waitcnt vmcnt(1)
    v_mfma_f32_32x32x16_bf16 v[16:31], v[200:203], v[204:207], v[16:31]
    s_waitcnt vmcnt(0)
    v_mfma_f32_32x32x16_bf16 v[48:63], v[224:227], v[204:207], v[48:63]
    v_mfma_f32_32x32x16_bf16 v[32:47], v[224:227], v[228:231], v[32:47]
    v_add_u32 v78, s44, v76
    s_nop 7
    ds_write_b128 v78, v[16:19] offset:0
    ds_write_b128 v78, v[20:23] offset:1024
    ds_write_b128 v78, v[24:27] offset:2048
    ds_write_b128 v78, v[28:31] offset:3072
    v_add_u32 v78, s45, v76
    ds_write_b128 v78, v[48:51] offset:0
    ds_write_b128 v78, v[52:55] offset:1024
    ds_write_b128 v78, v[56:59] offset:2048
    ds_write_b128 v78, v[60:63] offset:3072
    v_add_u32 v78, s44, v76
    ds_write_b128 v78, v[32:35] offset:16384
    ds_write_b128 v78, v[36:39] offset:17408
    ds_write_b128 v78, v[40:43] offset:18432
    ds_write_b128 v78, v[44:47] offset:19456
    v_permlane32_swap_b32 v64, v66
    v_permlane32_swap_b32 v65, v67
    v_permlane32_swap_b32 v68, v70
    v_permlane32_swap_b32 v69, v71
    v_lshlrev_b32 v128, 16, v64
    v_and_b32 v129, 0xffff0000, v64
    v_lshlrev_b32 v130, 16, v65
    v_and_b32 v131, 0xffff0000, v65
    v_lshlrev_b32 v132, 16, v66
    v_and_b32 v133, 0xffff0000, v66
    v_lshlrev_b32 v134, 16, v67
    v_and_b32 v135, 0xffff0000, v67
    v_lshlrev_b32 v136, 16, v68
    v_and_b32 v137, 0xffff0000, v68
    v_lshlrev_b32 v138, 16, v69
    v_and_b32 v139, 0xffff0000, v69
    v_lshlrev_b32 v140, 16, v70
    v_and_b32 v141, 0xffff0000, v70
    v_lshlrev_b32 v142, 16, v71
    v_and_b32 v143, 0xffff0000, v71
    s_waitcnt lgkmcnt(0)
    s_barrier
    s_xor_b32 s6, s44, 4096
    v_add_u32 v78, s6, v76
    ds_read_b128 v[80:83], v78 offset:0
    ds_read_b128 v[84:87], v78 offset:1024
    ds_read_b128 v[88:91], v78 offset:2048
    ds_read_b128 v[92:95], v78 offset:3072
    s_xor_b32 s6, s44, 8192
    v_add_u32 v78, s6, v76
    ds_read_b128 v[96:99], v78 offset:16384
    ds_read_b128 v[100:103], v78 offset:17408
    ds_read_b128 v[104:107], v78 offset:18432
    ds_read_b128 v[108:111], v78 offset:19456
    s_xor_b32 s6, s45, 12288
    v_add_u32 v78, s6, v76
    ds_read_b128 v[112:115], v78 offset:0
    ds_read_b128 v[116:119], v78 offset:1024
    ds_read_b128 v[120:123], v78 offset:2048
    ds_read_b128 v[124:127], v78 offset:3072
    s_waitcnt lgkmcnt(8)
    v_add_f32 v0, v0, v80
    v_add_f32 v1, v1, v81
    v_add_f32 v2, v2, v82
    v_add_f32 v3, v3, v83
    v_add_f32 v4, v4, v84
    v_add_f32 v5, v5, v85
    v_add_f32 v6, v6, v86
    v_add_f32 v7, v7, v87
    v_add_f32 v8, v8, v88
    v_add_f32 v9, v9, v89
    v_add_f32 v10, v10, v90
    v_add_f32 v11, v11, v91
    v_add_f32 v12, v12, v92
    v_add_f32 v13, v13, v93
    v_add_f32 v14, v14, v94
    v_add_f32 v15, v15, v95
    s_waitcnt lgkmcnt(4)
    v_add_f32 v0, v0, v96
    v_add_f32 v1, v1, v97
    v_add_f32 v2, v2, v98
    v_add_f32 v3, v3, v99
    v_add_f32 v4, v4, v100
    v_add_f32 v5, v5, v101
    v_add_f32 v6, v6, v102
    v_add_f32 v7, v7, v103
    v_add_f32 v8, v8, v104
    v_add_f32 v9, v9, v105
    v_add_f32 v10, v10, v106
    v_add_f32 v11, v11, v107
    v_add_f32 v12, v12, v108
    v_add_f32 v13, v13, v109
    v_add_f32 v14, v14, v110
    v_add_f32 v15, v15, v111
    s_waitcnt lgkmcnt(0)
    v_add_f32 v0, v0, v112
    v_add_f32 v1, v1, v113
    v_add_f32 v2, v2, v114
    v_add_f32 v3, v3, v115
    v_add_f32 v4, v4, v116
    v_add_f32 v5, v5, v117
    v_add_f32 v6, v6, v118
    v_add_f32 v7, v7, v119
    v_add_f32 v8, v8, v120
    v_add_f32 v9, v9, v121
    v_add_f32 v10, v10, v122
    v_add_f32 v11, v11, v123
    v_add_f32 v12, v12, v124
    v_add_f32 v13, v13, v125
    v_add_f32 v14, v14, v126
    v_add_f32 v15, v15, v127
    v_cvt_pk_bf16_f32 v16, v0, v1
    v_cvt_pk_bf16_f32 v17, v2, v3
    v_cvt_pk_bf16_f32 v18, v4, v5
    v_cvt_pk_bf16_f32 v19, v6, v7
    v_cvt_pk_bf16_f32 v20, v8, v9
    v_cvt_pk_bf16_f32 v21, v10, v11
    v_cvt_pk_bf16_f32 v22, v12, v13
    v_cvt_pk_bf16_f32 v23, v14, v15
    v_lshlrev_b32 v0, 16, v16
    v_and_b32 v1, 0xffff0000, v16
    v_lshlrev_b32 v2, 16, v17
    v_and_b32 v3, 0xffff0000, v17
    v_lshlrev_b32 v4, 16, v18
    v_and_b32 v5, 0xffff0000, v18
    v_lshlrev_b32 v6, 16, v19
    v_and_b32 v7, 0xffff0000, v19
    v_lshlrev_b32 v8, 16, v20
    v_and_b32 v9, 0xffff0000, v20
    v_lshlrev_b32 v10, 16, v21
    v_and_b32 v11, 0xffff0000, v21
    v_lshlrev_b32 v12, 16, v22
    v_and_b32 v13, 0xffff0000, v22
    v_lshlrev_b32 v14, 16, v23
    v_and_b32 v15, 0xffff0000, v23
    v_add_f32 v0, v0, v128
    v_add_f32 v1, v1, v129
    v_add_f32 v2, v2, v130
    v_add_f32 v3, v3, v131
    v_add_f32 v4, v4, v132
    v_add_f32 v5, v5, v133
    v_add_f32 v6, v6, v134
    v_add_f32 v7, v7, v135
    v_add_f32 v8, v8, v136
    v_add_f32 v9, v9, v137
    v_add_f32 v10, v10, v138
    v_add_f32 v11, v11, v139
    v_add_f32 v12, v12, v140
    v_add_f32 v13, v13, v141
    v_add_f32 v14, v14, v142
    v_add_f32 v15, v15, v143
    v_cvt_pk_bf16_f32 v64, v0, v1
    v_cvt_pk_bf16_f32 v65, v2, v3
    v_cvt_pk_bf16_f32 v66, v4, v5
    v_cvt_pk_bf16_f32 v67, v6, v7
    v_cvt_pk_bf16_f32 v68, v8, v9
    v_cvt_pk_bf16_f32 v69, v10, v11
    v_cvt_pk_bf16_f32 v70, v12, v13
    v_cvt_pk_bf16_f32 v71, v14, v15
    buffer_store_dwordx4 v[64:67], v76, s[24:27], s18 offen offset:0 sc1
    buffer_store_dwordx4 v[68:71], v76, s[24:27], s18 offen offset:1024 sc1
    v_lshlrev_b32 v0, 16, v64
    v_and_b32 v1, 0xffff0000, v64
    v_lshlrev_b32 v2, 16, v65
    v_and_b32 v3, 0xffff0000, v65
    v_lshlrev_b32 v4, 16, v66
    v_and_b32 v5, 0xffff0000, v66
    v_lshlrev_b32 v6, 16, v67
    v_and_b32 v7, 0xffff0000, v67
    v_lshlrev_b32 v8, 16, v68
    v_and_b32 v9, 0xffff0000, v68
    v_lshlrev_b32 v10, 16, v69
    v_and_b32 v11, 0xffff0000, v69
    v_lshlrev_b32 v12, 16, v70
    v_and_b32 v13, 0xffff0000, v70
    v_lshlrev_b32 v14, 16, v71
    v_and_b32 v15, 0xffff0000, v71
    v_add_f32 v128, v0, v1
    v_add_f32 v129, v2, v3
    v_add_f32 v130, v4, v5
    v_add_f32 v131, v6, v7
    v_add_f32 v132, v8, v9
    v_add_f32 v133, v10, v11
    v_add_f32 v134, v12, v13
    v_add_f32 v135, v14, v15
    v_add_f32 v128, v128, v132
    v_add_f32 v129, v129, v133
    v_add_f32 v130, v130, v134
    v_add_f32 v131, v131, v135
    v_add_f32 v128, v128, v130
    v_add_f32 v129, v129, v131
    v_add_f32 v128, v128, v129
    v_mov_b32 v129, v128
    s_nop 1
    v_permlane32_swap_b32 v128, v129
    v_add_f32 v128, v128, v129
    v_mul_f32 v128, 0x3d000000, v128
    v_sub_f32 v0, v0, v128
    v_sub_f32 v1, v1, v128
    v_sub_f32 v2, v2, v128
    v_sub_f32 v3, v3, v128
    v_sub_f32 v4, v4, v128
    v_sub_f32 v5, v5, v128
    v_sub_f32 v6, v6, v128
    v_sub_f32 v7, v7, v128
    v_sub_f32 v8, v8, v128
    v_sub_f32 v9, v9, v128
    v_sub_f32 v10, v10, v128
    v_sub_f32 v11, v11, v128
    v_sub_f32 v12, v12, v128
    v_sub_f32 v13, v13, v128
    v_sub_f32 v14, v14, v128
    v_sub_f32 v15, v15, v128
    v_mul_f32 v129, v0, v0
    v_mul_f32 v130, v1, v1
    v_fmac_f32 v129, v2, v2
    v_fmac_f32 v130, v3, v3
    v_fmac_f32 v129, v4, v4
    v_fmac_f32 v130, v5, v5
    v_fmac_f32 v129, v6, v6
    v_fmac_f32 v130, v7, v7
    v_fmac_f32 v129, v8, v8
    v_fmac_f32 v130, v9, v9
    v_fmac_f32 v129, v10, v10
    v_fmac_f32 v130, v11, v11
    v_fmac_f32 v129, v12, v12
    v_fmac_f32 v130, v13, v13
    v_fmac_f32 v129, v14, v14
    v_fmac_f32 v130, v15, v15
    v_add_f32 v129, v129, v130
    v_mov_b32 v130, v129
    s_nop 1
    v_permlane32_swap_b32 v129, v130
    v_add_f32 v129, v129, v130
    v_lshrrev_b32 v130, 10, v77
    v_lshlrev_b32 v130, 7, v130
    s_lshl_b32 s6, s14, 12
    s_lshl_b32 s7, s13, 3
    s_add_u32 s6, s6, s7
    s_add_u32 s6, s6, 0x3b00000
    buffer_store_dwordx2 v[128:129], v130, s[24:27], s6 offen sc1
    s_mul_i32 s21, s12, 28672
    s_xor_b32 s7, s13, 0
    s_mul_i32 s6, s7, 114688
    s_add_u32 s6, s6, s21
    s_add_u32 s6, s6, 0x4000000
    v_add_u32 v72, s6, v76
    s_xor_b32 s7, s13, 1
    s_mul_i32 s6, s7, 114688
    s_add_u32 s6, s6, s21
    s_add_u32 s6, s6, 0x4000000
    v_add_u32 v73, s6, v76
    s_xor_b32 s7, s14, 0
    s_mul_i32 s6, s7, 114688
    s_add_u32 s6, s6, s21
    s_add_u32 s6, s6, 0x3400000
    v_add_u32 v74, s6, v76
    s_xor_b32 s7, s14, 1
    s_mul_i32 s6, s7, 114688
    s_add_u32 s6, s6, s21
    s_add_u32 s6, s6, 0x3400000
    v_add_u32 v75, s6, v76
    s_lshl_b32 s6, s14, 7
    s_lshl_b32 s7, s13, 3
    s_add_u32 s6, s6, s7
    s_add_u32 s20, s6, 0x3b9c000
    s_mov_b32 s8, s38
    s_mov_b32 s9, s39
    s_mov_b32 s10, 0x200000
    s_mov_b32 s11, 0x20000
    s_waitcnt vmcnt(0)
    v_mov_b32 v2, s64
    v_mov_b32 v3, s65
    s_mov_b64 exec, 1
    buffer_store_dwordx2 v[2:3], off, s[24:27], s20 sc1
    s_mov_b64 exec, -1
    s_barrier
    s_mul_i32 s7, s12, 224
    s_add_u32 s7, s7, 2048
    v_min_u32 v4, 208, v76
    v_add_u32 v4, s7, v4
    s_lshr_b32 s6, s5, 2
    s_lshl_b32 s6, s6, 3
    s_add_u32 s21, s6, 0x3ba0000
    s_mov_b32 s19, 0x40000
k1f_kernel_rp2:
    buffer_load_dwordx2 v[6:7], v4, s[24:27], s21 offen sc1
k1f_kernel_rp2w:
    s_waitcnt vmcnt(0)
    v_cmp_eq_u64 vcc, s[64:65], v[6:7]
    s_cmp_eq_u64 vcc, -1
    s_cbranch_scc1 k1f_kernel_rp2d
    s_sleep 1
    s_sub_u32 s19, s19, 1
    s_cbranch_scc0 k1f_kernel_rp2
k1f_kernel_rp2d:
    s_add_u32 s44, s42, 0x10000
    s_add_u32 s45, s42, 0x20000
    v_min_u32 v79, 208, v76
    v_lshrrev_b32 v79, 1, v79
    s_lshr_b32 s6, s4, 1
    s_lshl_b32 s6, s6, 9
    s_mul_i32 s7, s12, 112
    s_add_u32 s6, s6, s7
    s_add_u32 s20, s6, 0x3b9e000
    v_lshrrev_b32 v0, 4, v76
    v_and_b32 v1, 31, v0
    v_lshrrev_b32 v0, 5, v0
    v_lshlrev_b32 v2, 7, v1
    v_lshl_add_u32 v2, v0, 6, v2
    s_lshr_b32 s6, s4, 1
    s_lshl_b32 s6, s6, 2
    s_add_u32 s6, s6, s12
    s_lshl_b32 s6, s6, 12
    s_add_u32 s21, s6, 0x3b00000
    s_lshl_b32 s6, s12, 8
    s_add_u32 s6, s6, 0x20000
    v_lshlrev_b32 v1, 3, v1
    v_add_u32 v1, s6, v1
    s_barrier
    buffer_load_dwordx4 v[16:19], v2, s[24:27], s21 offen offset:0 sc1
    buffer_load_dwordx4 v[20:23], v2, s[24:27], s21 offen offset:16 sc1
    buffer_load_dwordx4 v[24:27], v2, s[24:27], s21 offen offset:32 sc1
    buffer_load_dwordx4 v[28:31], v2, s[24:27], s21 offen offset:48 sc1
    s_mov_b32 s16, 0
    buffer_load_dwordx4 v[80:83], v72, s[24:27], s16 offen offset:0 sc1
    buffer_load_dwordx4 v[84:87], v72, s[24:27], s16 offen offset:1024 sc1
    buffer_load_dwordx4 v[88:91], v72, s[24:27], s16 offen offset:2048 sc1
    buffer_load_dwordx4 v[92:95], v72, s[24:27], s16 offen offset:3072 sc1
    s_mov_b32 s16, 0
    buffer_load_dwordx4 v[96:99], v73, s[24:27], s16 offen offset:0 sc1
    buffer_load_dwordx4 v[100:103], v73, s[24:27], s16 offen offset:1024 sc1
    buffer_load_dwordx4 v[104:107], v73, s[24:27], s16 offen offset:2048 sc1
    buffer_load_dwordx4 v[108:111], v73, s[24:27], s16 offen offset:3072 sc1
    s_barrier
    s_mov_b32 s16, 4096
    buffer_load_dwordx4 v[112:115], v72, s[24:27], s16 offen offset:0 sc1
    buffer_load_dwordx4 v[116:119], v72, s[24:27], s16 offen offset:1024 sc1
    buffer_load_dwordx4 v[120:123], v72, s[24:27], s16 offen offset:2048 sc1
    buffer_load_dwordx4 v[124:127], v72, s[24:27], s16 offen offset:3072 sc1
    s_mov_b32 s16, 4096
    buffer_load_dwordx4 v[128:131], v73, s[24:27], s16 offen offset:0 sc1
    buffer_load_dwordx4 v[132:135], v73, s[24:27], s16 offen offset:1024 sc1
    buffer_load_dwordx4 v[136:139], v73, s[24:27], s16 offen offset:2048 sc1
    buffer_load_dwordx4 v[140:143], v73, s[24:27], s16 offen offset:3072 sc1
    s_barrier
    s_mov_b32 s16, 8192
    buffer_load_dwordx4 v[144:147], v72, s[24:27], s16 offen offset:0 sc1
    buffer_load_dwordx4 v[148:151], v72, s[24:27], s16 offen offset:1024 sc1
    buffer_load_dwordx4 v[152:155], v72, s[24:27], s16 offen offset:2048 sc1
    buffer_load_dwordx4 v[156:159], v72, s[24:27], s16 offen offset:3072 sc1
    s_add_u32 m0, s45, 16384
    s_mov_b32 s16, 8192
    buffer_load_dwordx4 v73, s[24:27], s16 offen offset:0 sc1 lds
    buffer_load_dwordx4 v73, s[24:27], s16 offen offset:1024 sc1 lds
    buffer_load_dwordx4 v73, s[24:27], s16 offen offset:2048 sc1 lds
    buffer_load_dwordx4 v73, s[24:27], s16 offen offset:3072 sc1 lds
    s_barrier
    s_add_u32 m0, s42, 0
    s_mov_b32 s16, 12288
    buffer_load_dwordx4 v72, s[24:27], s16 offen offset:0 sc1 lds
    buffer_load_dwordx4 v72, s[24:27], s16 offen offset:1024 sc1 lds
    buffer_load_dwordx4 v72, s[24:27], s16 offen offset:2048 sc1 lds
    buffer_load_dwordx4 v72, s[24:27], s16 offen offset:3072 sc1 lds
    s_add_u32 m0, s42, 16384
    s_mov_b32 s16, 12288
    buffer_load_dwordx4 v73, s[24:27], s16 offen offset:0 sc1 lds
    buffer_load_dwordx4 v73, s[24:27], s16 offen offset:1024 sc1 lds
    buffer_load_dwordx4 v73, s[24:27], s16 offen offset:2048 sc1 lds
    buffer_load_dwordx4 v73, s[24:27], s16 offen offset:3072 sc1 lds
    s_barrier
    s_add_u32 m0, s42, 32768
    s_mov_b32 s16, 16384
    buffer_load_dwordx4 v72, s[24:27], s16 offen offset:0 sc1 lds
    buffer_load_dwordx4 v72, s[24:27], s16 offen offset:1024 sc1 lds
    buffer_load_dwordx4 v72, s[24:27], s16 offen offset:2048 sc1 lds
    buffer_load_dwordx4 v72, s[24:27], s16 offen offset:3072 sc1 lds
    s_barrier
    s_waitcnt vmcnt(36)
    v_add_f32 v8, v16, v18
    v_add_f32 v12, v17, v19
    v_add_f32 v9, v20, v22
    v_add_f32 v13, v21, v23
    v_add_f32 v10, v24, v26
    v_add_f32 v14, v25, v27
    v_add_f32 v11, v28, v30
    v_add_f32 v15, v29, v31
    v_add_f32 v8, v8, v9
    v_add_f32 v10, v10, v11
    v_add_f32 v12, v12, v13
    v_add_f32 v14, v14, v15
    v_add_f32 v8, v8, v10
    v_add_f32 v12, v12, v14
    v_mov_b32 v9, v8
    s_nop 1
    v_permlane32_swap_b32 v8, v9
    v_add_f32 v8, v8, v9
    v_mul_f32 v8, 0x3d800000, v8
    v_sub_f32 v16, v16, v8
    v_sub_f32 v18, v18, v8
    v_sub_f32 v20, v20, v8
    v_sub_f32 v22, v22, v8
    v_sub_f32 v24, v24, v8
    v_sub_f32 v26, v26, v8
    v_sub_f32 v28, v28, v8
    v_sub_f32 v30, v30, v8
    v_mul_f32 v9, v16, v16
    v_fmac_f32 v9, v18, v18
    v_fmac_f32 v9, v20, v20
    v_fmac_f32 v9, v22, v22
    v_fmac_f32 v9, v24, v24
    v_fmac_f32 v9, v26, v26
    v_fmac_f32 v9, v28, v28
    v_fmac_f32 v9, v30, v30
    v_fmac_f32 v12, 0x42000000, v9
    v_mov_b32 v9, v12
    s_nop 1
    v_permlane32_swap_b32 v12, v9
    v_add_f32 v9, v12, v9
    v_mul_f32 v9, 0x3b000000, v9
    v_cvt_pk_bf16_f32 v8, v8, v8
    v_lshlrev_b32 v8, 16, v8
    v_cvt_pk_bf16_f32 v9, v9, v9
    v_lshlrev_b32 v9, 16, v9
    v_add_f32 v9, 0x3727c5ac, v9
    v_cvt_pk_bf16_f32 v9, v9, v9
    v_lshlrev_b32 v9, 16, v9
    v_sqrt_f32 v9, v9
    s_nop 0
    v_cvt_pk_bf16_f32 v9, v9, v9
    v_lshlrev_b32 v9, 16, v9
    v_rcp_f32 v9, v9
    ds_write_b64 v1, v[8:9]
    s_add_u32 m0, s42, 49152
    s_mov_b32 s16, 16384
    buffer_load_dwordx4 v73, s[24:27], s16 offen offset:0 sc1 lds
    buffer_load_dwordx4 v73, s[24:27], s16 offen offset:1024 sc1 lds
    buffer_load_dwordx4 v73, s[24:27], s16 offen offset:2048 sc1 lds
    buffer_load_dwordx4 v73, s[24:27], s16 offen offset:3072 sc1 lds
    s_barrier
    s_add_u32 m0, s44, 0
    s_mov_b32 s16, 20480
    buffer_load_dwordx4 v72, s[24:27], s16 offen offset:0 sc1 lds
    buffer_load_dwordx4 v72, s[24:27], s16 offen offset:1024 sc1 lds
    buffer_load_dwordx4 v72, s[24:27], s16 offen offset:2048 sc1 lds
    buffer_load_dwordx4 v72, s[24:27], s16 offen offset:3072 sc1 lds
    s_waitcnt lgkmcnt(0)
    s_barrier
    s_add_u32 m0, s44, 16384
    s_mov_b32 s16, 20480
    buffer_load_dwordx4 v73, s[24:27], s16 offen offset:0 sc1 lds
    buffer_load_dwordx4 v73, s[24:27], s16 offen offset:1024 sc1 lds
    buffer_load_dwordx4 v73, s[24:27], s16 offen offset:2048 sc1 lds
    buffer_load_dwordx4 v73, s[24:27], s16 offen offset:3072 sc1 lds
    s_barrier
    s_add_u32 m0, s44, 32768
    s_mov_b32 s16, 24576
    buffer_load_dwordx4 v72, s[24:27], s16 offen offset:0 sc1 lds
    buffer_load_dwordx4 v72, s[24:27], s16 offen offset:1024 sc1 lds
    buffer_load_dwordx4 v72, s[24:27], s16 offen offset:2048 sc1 lds
    buffer_load_dwordx4 v72, s[24:27], s16 offen offset:3072 sc1 lds
    s_add_u32 m0, s44, 49152
    s_mov_b32 s16, 24576
    buffer_load_dwordx4 v73, s[24:27], s16 offen offset:0 sc1 lds
    buffer_load_dwordx4 v73, s[24:27], s16 offen offset:1024 sc1 lds
    buffer_load_dwordx4 v73, s[24:27], s16 offen offset:2048 sc1 lds
    buffer_load_dwordx4 v73, s[24:27], s16 offen offset:3072 sc1 lds
    s_mov_b32 s19, 0x40000
k1f_kernel_h1:
    buffer_load_dwordx2 v[0:1], v79, s[24:27], s20 offen sc1
k1f_kernel_h1w:
    s_waitcnt vmcnt(0)
    v_cmp_eq_u64 vcc, s[64:65], v[0:1]
    s_cmp_eq_u64 vcc, -1
    s_cbranch_scc1 k1f_kernel_h1d
    s_sleep 1
    s_sub_u32 s19, s19, 1
    s_cbranch_scc0 k1f_kernel_h1
k1f_kernel_h1d:
    s_mov_b32 s15, 0
    buffer_load_dwordx4 v[160:163], v74, s[24:27], s15 offen offset:0 sc1
    buffer_load_dwordx4 v[164:167], v75, s[24:27], s15 offen offset:0 sc1
    buffer_load_dwordx4 v[168:171], v74, s[24:27], s15 offen offset:1024 sc1
    buffer_load_dwordx4 v[172:175], v75, s[24:27], s15 offen offset:1024 sc1
    buffer_load_dwordx4 v[176:179], v74, s[24:27], s15 offen offset:2048 sc1
    buffer_load_dwordx4 v[180:183], v75, s[24:27], s15 offen offset:2048 sc1
    buffer_load_dwordx4 v[184:187], v74, s[24:27], s15 offen offset:3072 sc1
    buffer_load_dwordx4 v[188:191], v75, s[24:27], s15 offen offset:3072 sc1
    s_mov_b32 s15, 4096
    buffer_load_dwordx4 v[192:195], v74, s[24:27], s15 offen offset:0 sc1
    buffer_load_dwordx4 v[196:199], v75, s[24:27], s15 offen offset:0 sc1
    buffer_load_dwordx4 v[200:203], v74, s[24:27], s15 offen offset:1024 sc1
    buffer_load_dwordx4 v[204:207], v75, s[24:27], s15 offen offset:1024 sc1
    buffer_load_dwordx4 v[208:211], v74, s[24:27], s15 offen offset:2048 sc1
    buffer_load_dwordx4 v[212:215], v75, s[24:27], s15 offen offset:2048 sc1
    buffer_load_dwordx4 v[216:219], v74, s[24:27], s15 offen offset:3072 sc1
    buffer_load_dwordx4 v[220:223], v75, s[24:27], s15 offen offset:3072 sc1
    s_mov_b32 s15, 8192
    buffer_load_dwordx4 v[224:227], v74, s[24:27], s15 offen offset:0 sc1
    buffer_load_dwordx4 v[228:231], v75, s[24:27], s15 offen offset:0 sc1
    buffer_load_dwordx4 v[232:235], v74, s[24:27], s15 offen offset:1024 sc1
    buffer_load_dwordx4 v[236:239], v75, s[24:27], s15 offen offset:1024 sc1
    buffer_load_dwordx4 v[240:243], v74, s[24:27], s15 offen offset:2048 sc1
    buffer_load_dwordx4 v[244:247], v75, s[24:27], s15 offen offset:2048 sc1
    s_waitcnt vmcnt(21)
    v_mfma_f32_32x32x16_bf16 v[0:15], v[80:83], v[160:163], 0
    buffer_load_dwordx4 v[248:251], v74, s[24:27], s15 offen offset:3072 sc1
    s_waitcnt vmcnt(21)
    v_mfma_f32_32x32x16_bf16 v[16:31], v[80:83], v[164:167], 0
    buffer_load_dwordx4 v[252:255], v75, s[24:27], s15 offen offset:3072 sc1
    v_mfma_f32_32x32x16_bf16 v[48:63], v[96:99], v[164:167], 0
    v_mfma_f32_32x32x16_bf16 v[32:47], v[96:99], v[160:163], 0
    s_waitcnt vmcnt(21)
    v_mfma_f32_32x32x16_bf16 v[0:15], v[84:87], v[168:171], v[0:15]
    s_mov_b32 s15, 12288
    buffer_load_dwordx4 v[80:83], v74, s[24:27], s15 offen offset:0 sc1
    s_waitcnt vmcnt(21)
    v_mfma_f32_32x32x16_bf16 v[16:31], v[84:87], v[172:175], v[16:31]
    buffer_load_dwordx4 v[96:99], v75, s[24:27], s15 offen offset:0 sc1
    v_mfma_f32_32x32x16_bf16 v[48:63], v[100:103], v[172:175], v[48:63]
    buffer_load_dwordx4 v[160:163], v74, s[24:27], s15 offen offset:1024 sc1
    v_mfma_f32_32x32x16_bf16 v[32:47], v[100:103], v[168:171], v[32:47]
    buffer_load_dwordx4 v[164:167], v75, s[24:27], s15 offen offset:1024 sc1
    s_waitcnt vmcnt(23)
    v_mfma_f32_32x32x16_bf16 v[0:15], v[88:91], v[176:179], v[0:15]
    buffer_load_dwordx4 v[84:87], v74, s[24:27], s15 offen offset:2048 sc1
    s_waitcnt vmcnt(23)
    v_mfma_f32_32x32x16_bf16 v[16:31], v[88:91], v[180:183], v[16:31]
    buffer_load_dwordx4 v[100:103], v75, s[24:27], s15 offen offset:2048 sc1
    v_mfma_f32_32x32x16_bf16 v[48:63], v[104:107], v[180:183], v[48:63]
    buffer_load_dwordx4 v[168:171], v74, s[24:27], s15 offen offset:3072 sc1
    v_mfma_f32_32x32x16_bf16 v[32:47], v[104:107], v[176:179], v[32:47]
    buffer_load_dwordx4 v[172:175], v75, s[24:27], s15 offen offset:3072 sc1
    s_waitcnt vmcnt(25)
    v_mfma_f32_32x32x16_bf16 v[0:15], v[92:95], v[184:187], v[0:15]
    s_mov_b32 s15, 16384
    buffer_load_dwordx4 v[88:91], v74, s[24:27], s15 offen offset:0 sc1
    s_waitcnt vmcnt(25)
    v_mfma_f32_32x32x16_bf16 v[16:31], v[92:95], v[188:191], v[16:31]
    buffer_load_dwordx4 v[104:107], v75, s[24:27], s15 offen offset:0 sc1
    v_mfma_f32_32x32x16_bf16 v[48:63], v[108:111], v[188:191], v[48:63]
    buffer_load_dwordx4 v[176:179], v74, s[24:27], s15 offen offset:1024 sc1
    v_mfma_f32_32x32x16_bf16 v[32:47], v[108:111], v[184:187], v[32:47]
    buffer_load_dwordx4 v[180:183], v75, s[24:27], s15 offen offset:1024 sc1
    s_waitcnt vmcnt(27)
    v_mfma_f32_32x32x16_bf16 v[0:15], v[112:115], v[192:195], v[0:15]
    buffer_load_dwordx4 v[92:95], v74, s[24:27], s15 offen offset:2048 sc1
    s_waitcnt vmcnt(27)
    v_mfma_f32_32x32x16_bf16 v[16:31], v[112:115], v[196:199], v[16:31]
    buffer_load_dwordx4 v[108:111], v75, s[24:27], s15 offen offset:2048 sc1
    v_mfma_f32_32x32x16_bf16 v[48:63], v[128:131], v[196:199], v[48:63]
    buffer_load_dwordx4 v[184:187], v74, s[24:27], s15 offen offset:3072 sc1
    v_mfma_f32_32x32x16_bf16 v[32:47], v[128:131], v[192:195], v[32:47]
    buffer_load_dwordx4 v[188:191], v75, s[24:27], s15 offen offset:3072 sc1
    s_waitcnt vmcnt(29)
    v_mfma_f32_32x32x16_bf16 v[0:15], v[116:119], v[200:203], v[0:15]
    s_mov_b32 s15, 20480
    buffer_load_dwordx4 v[112:115], v74, s[24:27], s15 offen offset:0 sc1
    s_waitcnt vmcnt(29)
    v_mfma_f32_32x32x16_bf16 v[16:31], v[116:119], v[204:207], v[16:31]
    buffer_load_dwordx4 v[128:131], v75, s[24:27], s15 offen offset:0 sc1
    v_mfma_f32_32x32x16_bf16 v[48:63], v[132:135], v[204:207], v[48:63]
    buffer_load_dwordx4 v[192:195], v74, s[24:27], s15 offen offset:1024 sc1
    v_mfma_f32_32x32x16_bf16 v[32:47], v[132:135], v[200:203], v[32:47]
    buffer_load_dwordx4 v[196:199], v75, s[24:27], s15 offen offset:1024 sc1
    s_waitcnt vmcnt(31)
    v_mfma_f32_32x32x16_bf16 v[0:15], v[120:123], v[208:211], v[0:15]
    v_add_u32 v78, s45, v76
    ds_read_b128 v[116:119], v78 offset:16384
    buffer_load_dwordx4 v[132:135], v74, s[24:27], s15 offen offset:2048 sc1
    s_waitcnt vmcnt(31)
    v_mfma_f32_32x32x16_bf16 v[16:31], v[120:123], v[212:215], v[16:31]
    buffer_load_dwordx4 v[200:203], v75, s[24:27], s15 offen offset:2048 sc1
    v_mfma_f32_32x32x16_bf16 v[48:63], v[136:139], v[212:215], v[48:63]
    buffer_load_dwordx4 v[204:207], v74, s[24:27], s15 offen offset:3072 sc1
    v_mfma_f32_32x32x16_bf16 v[32:47], v[136:139], v[208:211], v[32:47]
    s_waitcnt vmcnt(32)
    v_mfma_f32_32x32x16_bf16 v[0:15], v[124:127], v[216:219], v[0:15]
    ds_read_b128 v[120:123], v78 offset:17408
    buffer_load_dwordx4 v[136:139], v75, s[24:27], s15 offen offset:3072 sc1
    s_waitcnt vmcnt(32)
    v_mfma_f32_32x32x16_bf16 v[16:31], v[124:127], v[220:223], v[16:31]
    s_mov_b32 s15, 24576
    buffer_load_dwordx4 v[208:211], v74, s[24:27], s15 offen offset:0 sc1
    v_mfma_f32_32x32x16_bf16 v[48:63], v[140:143], v[220:223], v[48:63]
    buffer_load_dwordx4 v[212:215], v75, s[24:27], s15 offen offset:0 sc1
    v_mfma_f32_32x32x16_bf16 v[32:47], v[140:143], v[216:219], v[32:47]
    s_waitcnt vmcnt(33)
    v_mfma_f32_32x32x16_bf16 v[0:15], v[144:147], v[224:227], v[0:15]
    ds_read_b128 v[124:127], v78 offset:18432
    buffer_load_dwordx4 v[140:143], v74, s[24:27], s15 offen offset:1024 sc1
    s_waitcnt vmcnt(33)
    v_mfma_f32_32x32x16_bf16 v[16:31], v[144:147], v[228:231], v[16:31]
    buffer_load_dwordx4 v[216:219], v75, s[24:27], s15 offen offset:1024 sc1
    s_waitcnt lgkmcnt(2)
    v_mfma_f32_32x32x16_bf16 v[48:63], v[116:119], v[228:231], v[48:63]
    buffer_load_dwordx4 v[220:223], v74, s[24:27], s15 offen offset:2048 sc1
    v_mfma_f32_32x32x16_bf16 v[32:47], v[116:119], v[224:227], v[32:47]
    s_waitcnt vmcnt(34)
    v_mfma_f32_32x32x16_bf16 v[0:15], v[148:151], v[232:235], v[0:15]
    ds_read_b128 v[144:147], v78 offset:19456
    buffer_load_dwordx4 v[116:119], v75, s[24:27], s15 offen offset:2048 sc1
    s_waitcnt vmcnt(34)
    v_mfma_f32_32x32x16_bf16 v[16:31], v[148:151], v[236:239], v[16:31]
    buffer_load_dwordx4 v[224:227], v74, s[24:27], s15 offen offset:3072 sc1
    s_waitcnt lgkmcnt(2)
    v_mfma_f32_32x32x16_bf16 v[48:63], v[120:123], v[236:239], v[48:63]
    buffer_load_dwordx4 v[228:231], v75, s[24:27], s15 offen offset:3072 sc1
    v_mfma_f32_32x32x16_bf16 v[32:47], v[120:123], v[232:235], v[32:47]
    s_waitcnt vmcnt(35)
    v_mfma_f32_32x32x16_bf16 v[0:15], v[152:155], v[240:243], v[0:15]
    v_add_u32 v78, s42, v76
    ds_read_b128 v[148:151], v78 offset:0
    ds_read_b128 v[120:123], v78 offset:16384
    s_waitcnt vmcnt(34)
    v_mfma_f32_32x32x16_bf16 v[16:31], v[152:155], v[244:247], v[16:31]
    s_waitcnt lgkmcnt(3)
    v_mfma_f32_32x32x16_bf16 v[48:63], v[124:127], v[244:247], v[48:63]
    v_mfma_f32_32x32x16_bf16 v[32:47], v[124:127], v[240:243], v[32:47]
    s_waitcnt vmcnt(33)
    v_mfma_f32_32x32x16_bf16 v[0:15], v[156:159], v[248:251], v[0:15]
    ds_read_b128 v[232:235], v78 offset:1024
    ds_read_b128 v[236:239], v78 offset:17408
    s_waitcnt vmcnt(32)
    v_mfma_f32_32x32x16_bf16 v[16:31], v[156:159], v[252:255], v[16:31]
    s_waitcnt lgkmcnt(4)
    v_mfma_f32_32x32x16_bf16 v[48:63], v[144:147], v[252:255], v[48:63]
    v_mfma_f32_32x32x16_bf16 v[32:47], v[144:147], v[248:251], v[32:47]
    s_waitcnt vmcnt(31) lgkmcnt(3)
    v_mfma_f32_32x32x16_bf16 v[0:15], v[148:151], v[80:83], v[0:15]
    ds_read_b128 v[152:155], v78 offset:2048
    ds_read_b128 v[124:127], v78 offset:18432
    s_waitcnt vmcnt(30)
    v_mfma_f32_32x32x16_bf16 v[16:31], v[148:151], v[96:99], v[16:31]
    s_waitcnt lgkmcnt(4)
    v_mfma_f32_32x32x16_bf16 v[48:63], v[120:123], v[96:99], v[48:63]
    v_mfma_f32_32x32x16_bf16 v[32:47], v[120:123], v[80:83], v[32:47]
    s_waitcnt vmcnt(29) lgkmcnt(3)
    v_mfma_f32_32x32x16_bf16 v[0:15], v[232:235], v[160:163], v[0:15]
    ds_read_b128 v[240:243], v78 offset:3072
    ds_read_b128 v[244:247], v78 offset:19456
    s_waitcnt vmcnt(28)
    v_mfma_f32_32x32x16_bf16 v[16:31], v[232:235], v[164:167], v[16:31]
    s_waitcnt lgkmcnt(4)
    v_mfma_f32_32x32x16_bf16 v[48:63], v[236:239], v[164:167], v[48:63]
    v_mfma_f32_32x32x16_bf16 v[32:47], v[236:239], v[160:163], v[32:47]
    s_waitcnt vmcnt(27) lgkmcnt(3)
    v_mfma_f32_32x32x16_bf16 v[0:15], v[152:155], v[84:87], v[0:15]
    ds_read_b128 v[156:159], v78 offset:32768
    ds_read_b128 v[144:147], v78 offset:49152
    s_waitcnt vmcnt(26)
    v_mfma_f32_32x32x16_bf16 v[16:31], v[152:155], v[100:103], v[16:31]
    s_waitcnt lgkmcnt(4)
    v_mfma_f32_32x32x16_bf16 v[48:63], v[124:127], v[100:103], v[48:63]
    v_mfma_f32_32x32x16_bf16 v[32:47], v[124:127], v[84:87], v[32:47]
    s_waitcnt vmcnt(25) lgkmcnt(3)
    v_mfma_f32_32x32x16_bf16 v[0:15], v[240:243], v[168:171], v[0:15]
    ds_read_b128 v[248:251], v78 offset:33792
    ds_read_b128 v[252:255], v78 offset:50176
    s_waitcnt vmcnt(24)
    v_mfma_f32_32x32x16_bf16 v[16:31], v[240:243], v[172:175], v[16:31]
    s_waitcnt lgkmcnt(4)
    v_mfma_f32_32x32x16_bf16 v[48:63], v[244:247], v[172:175], v[48:63]
    v_mfma_f32_32x32x16_bf16 v[32:47], v[244:247], v[168:171], v[32:47]
    s_waitcnt vmcnt(23) lgkmcnt(3)
    v_mfma_f32_32x32x16_bf16 v[0:15], v[156:159], v[88:91], v[0:15]
    ds_read_b128 v[148:151], v78 offset:34816
    ds_read_b128 v[120:123], v78 offset:51200
    s_waitcnt vmcnt(22)
    v_mfma_f32_32x32x16_bf16 v[16:31], v[156:159], v[104:107], v[16:31]
    s_waitcnt lgkmcnt(4)
    v_mfma_f32_32x32x16_bf16 v[48:63], v[144:147], v[104:107], v[48:63]
    v_mfma_f32_32x32x16_bf16 v[32:47], v[144:147], v[88:91], v[32:47]
    s_waitcnt vmcnt(21) lgkmcnt(3)
    v_mfma_f32_32x32x16_bf16 v[0:15], v[248:251], v[176:179], v[0:15]
    ds_read_b128 v[80:83], v78 offset:35840
    ds_read_b128 v[96:99], v78 offset:52224
    s_waitcnt vmcnt(20)
    v_mfma_f32_32x32x16_bf16 v[16:31], v[248:251], v[180:183], v[16:31]
    s_waitcnt lgkmcnt(4)
    v_mfma_f32_32x32x16_bf16 v[48:63], v[252:255], v[180:183], v[48:63]
    v_mfma_f32_32x32x16_bf16 v[32:47], v[252:255], v[176:179], v[32:47]
    s_waitcnt vmcnt(19) lgkmcnt(3)
    v_mfma_f32_32x32x16_bf16 v[0:15], v[148:151], v[92:95], v[0:15]
    v_add_u32 v78, s44, v76
    ds_read_b128 v[232:235], v78 offset:0
    ds_read_b128 v[236:239], v78 offset:16384
    s_waitcnt vmcnt(18)
    v_mfma_f32_32x32x16_bf16 v[16:31], v[148:151], v[108:111], v[16:31]
    s_waitcnt lgkmcnt(4)
    v_mfma_f32_32x32x16_bf16 v[48:63], v[120:123], v[108:111], v[48:63]
    v_mfma_f32_32x32x16_bf16 v[32:47], v[120:123], v[92:95], v[32:47]
    s_waitcnt vmcnt(17) lgkmcnt(3)
    v_mfma_f32_32x32x16_bf16 v[0:15], v[80:83], v[184:187], v[0:15]
    ds_read_b128 v[160:163], v78 offset:1024
    ds_read_b128 v[164:167], v78 offset:17408
    s_waitcnt vmcnt(16)
    v_mfma_f32_32x32x16_bf16 v[16:31], v[80:83], v[188:191], v[16:31]
    s_waitcnt lgkmcnt(4)
    v_mfma_f32_32x32x16_bf16 v[48:63], v[96:99], v[188:191], v[48:63]
    v_mfma_f32_32x32x16_bf16 v[32:47], v[96:99], v[184:187], v[32:47]
    s_waitcnt vmcnt(15) lgkmcnt(3)
    v_mfma_f32_32x32x16_bf16 v[0:15], v[232:235], v[112:115], v[0:15]
    ds_read_b128 v[152:155], v78 offset:2048
    ds_read_b128 v[124:127], v78 offset:18432
    s_waitcnt vmcnt(14)
    v_mfma_f32_32x32x16_bf16 v[16:31], v[232:235], v[128:131], v[16:31]
    s_waitcnt lgkmcnt(4)
    v_mfma_f32_32x32x16_bf16 v[48:63], v[236:239], v[128:131], v[48:63]
    v_mfma_f32_32x32x16_bf16 v[32:47], v[236:239], v[112:115], v[32:47]
    s_waitcnt vmcnt(13) lgkmcnt(3)
    v_mfma_f32_32x32x16_bf16 v[0:15], v[160:163], v[192:195], v[0:15]
    ds_read_b128 v[84:87], v78 offset:3072
    ds_read_b128 v[100:103], v78 offset:19456
    s_waitcnt vmcnt(12)
    v_mfma_f32_32x32x16_bf16 v[16:31], v[160:163], v[196:199], v[16:31]
    s_waitcnt lgkmcnt(4)
    v_mfma_f32_32x32x16_bf16 v[48:63], v[164:167], v[196:199], v[48:63]
    v_mfma_f32_32x32x16_bf16 v[32:47], v[164:167], v[192:195], v[32:47]
    s_waitcnt vmcnt(11) lgkmcnt(3)
    v_mfma_f32_32x32x16_bf16 v[0:15], v[152:155], v[132:135], v[0:15]
    ds_read_b128 v[240:243], v78 offset:32768
    ds_read_b128 v[244:247], v78 offset:49152
    s_waitcnt vmcnt(10)
    v_mfma_f32_32x32x16_bf16 v[16:31], v[152:155], v[200:203], v[16:31]
    s_waitcnt lgkmcnt(4)
    v_mfma_f32_32x32x16_bf16 v[48:63], v[124:127], v[200:203], v[48:63]
    v_mfma_f32_32x32x16_bf16 v[32:47], v[124:127], v[132:135], v[32:47]
    s_waitcnt vmcnt(9) lgkmcnt(3)
    v_mfma_f32_32x32x16_bf16 v[0:15], v[84:87], v[204:207], v[0:15]
    ds_read_b128 v[168:171], v78 offset:33792
    ds_read_b128 v[172:175], v78 offset:50176
    s_waitcnt vmcnt(8)
    v_mfma_f32_32x32x16_bf16 v[16:31], v[84:87], v[136:139], v[16:31]
    s_waitcnt lgkmcnt(4)
    v_mfma_f32_32x32x16_bf16 v[48:63], v[100:103], v[136:139], v[48:63]
    v_mfma_f32_32x32x16_bf16 v[32:47], v[100:103], v[204:207], v[32:47]
    s_waitcnt vmcnt(7) lgkmcnt(3)
    v_mfma_f32_32x32x16_bf16 v[0:15], v[240:243], v[208:211], v[0:15]
    ds_read_b128 v[156:159], v78 offset:34816
    ds_read_b128 v[144:147], v78 offset:51200
    s_waitcnt vmcnt(6)
    v_mfma_f32_32x32x16_bf16 v[16:31], v[240:243], v[212:215], v[16:31]
    s_waitcnt lgkmcnt(4)
    v_mfma_f32_32x32x16_bf16 v[48:63], v[244:247], v[212:215], v[48:63]
    v_mfma_f32_32x32x16_bf16 v[32:47], v[244:247], v[208:211], v[32:47]
    s_waitcnt vmcnt(5) lgkmcnt(3)
    v_mfma_f32_32x32x16_bf16 v[0:15], v[168:171], v[140:143], v[0:15]
    ds_read_b128 v[88:91], v78 offset:35840
    ds_read_b128 v[104:107], v78 offset:52224
    s_waitcnt vmcnt(4)
    v_mfma_f32_32x32x16_bf16 v[16:31], v[168:171], v[216:219], v[16:31]
    s_waitcnt lgkmcnt(4)
    v_mfma_f32_32x32x16_bf16 v[48:63], v[172:175], v[216:219], v[48:63]
    v_mfma_f32_32x32x16_bf16 v[32:47], v[172:175], v[140:143], v[32:47]
    s_waitcnt vmcnt(3) lgkmcnt(3)
    v_mfma_f32_32x32x16_bf16 v[0:15], v[156:159], v[220:223], v[0:15]
    s_waitcnt vmcnt(2)
    v_mfma_f32_32x32x16_bf16 v[16:31], v[156:159], v[116:119], v[16:31]
    s_waitcnt lgkmcnt(2)
    v_mfma_f32_32x32x16_bf16 v[48:63], v[144:147], v[116:119], v[48:63]
    v_mfma_f32_32x32x16_bf16 v[32:47], v[144:147], v[220:223], v[32:47]
    s_waitcnt vmcnt(1) lgkmcnt(1)
    v_mfma_f32_32x32x16_bf16 v[0:15], v[88:91], v[224:227], v[0:15]
    s_waitcnt vmcnt(0)
    v_mfma_f32_32x32x16_bf16 v[16:31], v[88:91], v[228:231], v[16:31]
    s_waitcnt lgkmcnt(0)
    v_mfma_f32_32x32x16_bf16 v[48:63], v[104:107], v[228:231], v[48:63]
    v_mfma_f32_32x32x16_bf16 v[32:47], v[104:107], v[224:227], v[32:47]
    v_add_u32 v78, s42, v76
    s_nop 7
    ds_write_b128 v78, v[16:19] offset:0
    ds_write_b128 v78, v[20:23] offset:1024
    ds_write_b128 v78, v[24:27] offset:2048
    ds_write_b128 v78, v[28:31] offset:3072
    v_add_u32 v78, s42, v76
    ds_write_b128 v78, v[48:51] offset:32768
    ds_write_b128 v78, v[52:55] offset:33792
    ds_write_b128 v78, v[56:59] offset:34816
    ds_write_b128 v78, v[60:63] offset:35840
    v_add_u32 v78, s42, v76
    ds_write_b128 v78, v[32:35] offset:16384
    ds_write_b128 v78, v[36:39] offset:17408
    ds_write_b128 v78, v[40:43] offset:18432
    ds_write_b128 v78, v[44:47] offset:19456
    v_lshlrev_b32 v128, 16, v64
    v_and_b32 v129, 0xffff0000, v64
    v_lshlrev_b32 v130, 16, v65
    v_and_b32 v131, 0xffff0000, v65
    v_lshlrev_b32 v132, 16, v66
    v_and_b32 v133, 0xffff0000, v66
    v_lshlrev_b32 v134, 16, v67
    v_and_b32 v135, 0xffff0000, v67
    v_lshlrev_b32 v136, 16, v68
    v_and_b32 v137, 0xffff0000, v68
    v_lshlrev_b32 v138, 16, v69
    v_and_b32 v139, 0xffff0000, v69
    v_lshlrev_b32 v140, 16, v70
    v_and_b32 v141, 0xffff0000, v70
    v_lshlrev_b32 v142, 16, v71
    v_and_b32 v143, 0xffff0000, v71
    s_waitcnt lgkmcnt(0)
    s_barrier
    s_xor_b32 s6, s42, 4096
    v_add_u32 v78, s6, v76
    ds_read_b128 v[80:83], v78 offset:0
    ds_read_b128 v[84:87], v78 offset:1024
    ds_read_b128 v[88:91], v78 offset:2048
    ds_read_b128 v[92:95], v78 offset:3072
    s_xor_b32 s6, s42, 8192
    v_add_u32 v78, s6, v76
    ds_read_b128 v[96:99], v78 offset:16384
    ds_read_b128 v[100:103], v78 offset:17408
    ds_read_b128 v[104:107], v78 offset:18432
    ds_read_b128 v[108:111], v78 offset:19456
    s_xor_b32 s6, s42, 12288
    v_add_u32 v78, s6, v76
    ds_read_b128 v[112:115], v78 offset:32768
    ds_read_b128 v[116:119], v78 offset:33792
    ds_read_b128 v[120:123], v78 offset:34816
    ds_read_b128 v[124:127], v78 offset:35840
    s_waitcnt lgkmcnt(8)
    v_add_f32 v0, v0, v80
    v_add_f32 v1, v1, v81
    v_add_f32 v2, v2, v82
    v_add_f32 v3, v3, v83
    v_add_f32 v4, v4, v84
    v_add_f32 v5, v5, v85
    v_add_f32 v6, v6, v86
    v_add_f32 v7, v7, v87
    v_add_f32 v8, v8, v88
    v_add_f32 v9, v9, v89
    v_add_f32 v10, v10, v90
    v_add_f32 v11, v11, v91
    v_add_f32 v12, v12, v92
    v_add_f32 v13, v13, v93
    v_add_f32 v14, v14, v94
    v_add_f32 v15, v15, v95
    s_waitcnt lgkmcnt(4)
    v_add_f32 v0, v0, v96
    v_add_f32 v1, v1, v97
    v_add_f32 v2, v2, v98
    v_add_f32 v3, v3, v99
    v_add_f32 v4, v4, v100
    v_add_f32 v5, v5, v101
    v_add_f32 v6, v6, v102
    v_add_f32 v7, v7, v103
    v_add_f32 v8, v8, v104
    v_add_f32 v9, v9, v105
    v_add_f32 v10, v10, v106
    v_add_f32 v11, v11, v107
    v_add_f32 v12, v12, v108
    v_add_f32 v13, v13, v109
    v_add_f32 v14, v14, v110
    v_add_f32 v15, v15, v111
    s_waitcnt lgkmcnt(0)
    v_add_f32 v0, v0, v112
    v_add_f32 v1, v1, v113
    v_add_f32 v2, v2, v114
    v_add_f32 v3, v3, v115
    v_add_f32 v4, v4, v116
    v_add_f32 v5, v5, v117
    v_add_f32 v6, v6, v118
    v_add_f32 v7, v7, v119
    v_add_f32 v8, v8, v120
    v_add_f32 v9, v9, v121
    v_add_f32 v10, v10, v122
    v_add_f32 v11, v11, v123
    v_add_f32 v12, v12, v124
    v_add_f32 v13, v13, v125
    v_add_f32 v14, v14, v126
    v_add_f32 v15, v15, v127
    v_cvt_pk_bf16_f32 v16, v0, v1
    v_cvt_pk_bf16_f32 v17, v2, v3
    v_cvt_pk_bf16_f32 v18, v4, v5
    v_cvt_pk_bf16_f32 v19, v6, v7
    v_cvt_pk_bf16_f32 v20, v8, v9
    v_cvt_pk_bf16_f32 v21, v10, v11
    v_cvt_pk_bf16_f32 v22, v12, v13
    v_cvt_pk_bf16_f32 v23, v14, v15
    v_lshlrev_b32 v0, 16, v16
    v_and_b32 v1, 0xffff0000, v16
    v_lshlrev_b32 v2, 16, v17
    v_and_b32 v3, 0xffff0000, v17
    v_lshlrev_b32 v4, 16, v18
    v_and_b32 v5, 0xffff0000, v18
    v_lshlrev_b32 v6, 16, v19
    v_and_b32 v7, 0xffff0000, v19
    v_lshlrev_b32 v8, 16, v20
    v_and_b32 v9, 0xffff0000, v20
    v_lshlrev_b32 v10, 16, v21
    v_and_b32 v11, 0xffff0000, v21
    v_lshlrev_b32 v12, 16, v22
    v_and_b32 v13, 0xffff0000, v22
    v_lshlrev_b32 v14, 16, v23
    v_and_b32 v15, 0xffff0000, v23
    v_add_f32 v0, v0, v128
    v_add_f32 v1, v1, v129
    v_add_f32 v2, v2, v130
    v_add_f32 v3, v3, v131
    v_add_f32 v4, v4, v132
    v_add_f32 v5, v5, v133
    v_add_f32 v6, v6, v134
    v_add_f32 v7, v7, v135
    v_add_f32 v8, v8, v136
    v_add_f32 v9, v9, v137
    v_add_f32 v10, v10, v138
    v_add_f32 v11, v11, v139
    v_add_f32 v12, v12, v140
    v_add_f32 v13, v13, v141
    v_add_f32 v14, v14, v142
    v_add_f32 v15, v15, v143
    v_cvt_pk_bf16_f32 v16, v0, v1
    v_cvt_pk_bf16_f32 v17, v2, v3
    v_cvt_pk_bf16_f32 v18, v4, v5
    v_cvt_pk_bf16_f32 v19, v6, v7
    v_cvt_pk_bf16_f32 v20, v8, v9
    v_cvt_pk_bf16_f32 v21, v10, v11
    v_cvt_pk_bf16_f32 v22, v12, v13
    v_cvt_pk_bf16_f32 v23, v14, v15
    v_permlane32_swap_b32 v16, v18
    v_permlane32_swap_b32 v17, v19
    v_permlane32_swap_b32 v20, v22
    v_permlane32_swap_b32 v21, v23
    buffer_store_dwordx4 v[16:19], v77, s[8:11], s17 offen offset:0
    buffer_store_dwordx4 v[20:23], v77, s[8:11], s17 offen offset:32
    s_branch k1f_kernel_fin
k1f_kernel_ta:
    v_mov_b32 v244, v117
    s_lshr_b32 s6, s2, 3
    s_cmp_lg_u32 s6, 28
    s_cbranch_scc1 k1f_kernel_nct
    s_getpc_b64 s[20:21]
k1f_kernel_ct:
    s_sub_u32 s20, s20, k1f_kernel_ct-k1f_kernel_bm
    s_subb_u32 s21, s21, 0
    s_lshl_b32 s6, s3, 13
    v_lshl_add_u32 v250, v244, 3, s6
    v_min_u32 v250, k1f_kernel_fin-k1f_kernel_bm, v250
    v_mov_b32 v251, s21
    v_add_co_u32 v250, vcc, s20, v250
    s_nop 1
    v_addc_co_u32 v251, vcc, 0, v251, vcc
    global_load_dword v252, v[250:251], off
k1f_kernel_nct:
    s_lshr_b32 s8, s4, 1
    s_and_b32 s6, s4, 1
    s_lshl_b32 s7, s5, 1
    s_add_u32 s9, s6, s7
    s_lshl_b32 s6, s9, 2
    s_add_u32 s14, s6, s3
    s_lshl_b32 s10, s14, 15
    s_add_u32 s10, s10, 0x4200000
    s_lshl_b32 s6, s8, 2
    s_add_u32 s15, s6, s3
    s_lshl_b32 s11, s15, 15
    s_add_u32 s11, s11, 0x3200000
    s_lshl_b32 s12, s3, 12
    v_lshrrev_b32 v247, 4, v244
    v_and_b32 v246, 31, v247
    v_add_u32 v245, 0x10000, v244
    v_mov_b32 v240, 0x3f803f80
    v_mov_b32 v241, 0x3f803f80
    v_mov_b32 v242, 0x3f803f80
    v_mov_b32 v243, 0x3f803f80
    v_lshlrev_b32 v246, 3, v246
    v_add_u32 v246, 0x20000, v246
    s_mul_i32 s13, s8, 458752
    s_lshl_b32 s6, s14, 11
    s_add_u32 s13, s13, s6
    s_add_u32 s13, s13, 0x3400000
    v_lshrrev_b32 v247, 1, v244
    v_and_b32 v247, 0x78, v247
    s_lshr_b32 s6, s14, 3
    s_lshl_b32 s6, s6, 7
    s_add_u32 s16, s6, 0x3ba0b80
    s_waitcnt vmcnt(0)
    v_mov_b32 v64, s64
    v_mov_b32 v65, s65
    s_mov_b64 exec, 1
    buffer_store_dwordx2 v[64:65], off, s[24:27], s50 sc1
    s_mov_b64 exec, -1
    s_barrier
    s_cmp_ge_u32 s9, 14
    s_cbranch_scc1 k1f_kernel_fin
    s_mov_b32 s17, 0x40000
k1f_kernel_rpa:
    buffer_load_dwordx2 v[0:1], v247, s[24:27], s16 offen sc1
k1f_kernel_rpaw:
    s_waitcnt vmcnt(0)
    v_cmp_eq_u64 vcc, s[64:65], v[0:1]
    s_cmp_eq_u64 vcc, -1
    s_cbranch_scc1 k1f_kernel_rpad
    s_sleep 1
    s_sub_u32 s17, s17, 1
    s_cbranch_scc0 k1f_kernel_rpa
k1f_kernel_rpad:
    s_lshl_b32 s6, s15, 7
    s_add_u32 s16, s6, 0x3b9c000
    s_barrier
    s_barrier
    buffer_load_dwordx4 v[112:115], v244, s[24:27], s10 offen offset:0 sc1
    buffer_load_dwordx4 v[116:119], v244, s[24:27], s10 offen offset:1024 sc1
    buffer_load_dwordx4 v[120:123], v244, s[24:27], s10 offen offset:2048 sc1
    buffer_load_dwordx4 v[124:127], v244, s[24:27], s10 offen offset:3072 sc1
    s_add_u32 s10, s10, 4096
    buffer_load_dwordx4 v[128:131], v244, s[24:27], s10 offen offset:0 sc1
    buffer_load_dwordx4 v[132:135], v244, s[24:27], s10 offen offset:1024 sc1
    buffer_load_dwordx4 v[136:139], v244, s[24:27], s10 offen offset:2048 sc1
    buffer_load_dwordx4 v[140:143], v244, s[24:27], s10 offen offset:3072 sc1
    s_add_u32 s10, s10, 4096
    buffer_load_dwordx4 v[144:147], v244, s[24:27], s10 offen offset:0 sc1
    buffer_load_dwordx4 v[148:151], v244, s[24:27], s10 offen offset:1024 sc1
    buffer_load_dwordx4 v[152:155], v244, s[24:27], s10 offen offset:2048 sc1
    buffer_load_dwordx4 v[156:159], v244, s[24:27], s10 offen offset:3072 sc1
    s_add_u32 s10, s10, 4096
    buffer_load_dwordx4 v[160:163], v244, s[24:27], s10 offen offset:0 sc1
    buffer_load_dwordx4 v[164:167], v244, s[24:27], s10 offen offset:1024 sc1
    buffer_load_dwordx4 v[168:171], v244, s[24:27], s10 offen offset:2048 sc1
    buffer_load_dwordx4 v[172:175], v244, s[24:27], s10 offen offset:3072 sc1
    s_add_u32 s10, s10, 4096
    buffer_load_dwordx4 v[176:179], v244, s[24:27], s10 offen offset:0 sc1
    buffer_load_dwordx4 v[180:183], v244, s[24:27], s10 offen offset:1024 sc1
    buffer_load_dwordx4 v[184:187], v244, s[24:27], s10 offen offset:2048 sc1
    buffer_load_dwordx4 v[188:191], v244, s[24:27], s10 offen offset:3072 sc1
    s_add_u32 s10, s10, 4096
    buffer_load_dwordx4 v[192:195], v244, s[24:27], s10 offen offset:0 sc1
    buffer_load_dwordx4 v[196:199], v244, s[24:27], s10 offen offset:1024 sc1
    buffer_load_dwordx4 v[200:203], v244, s[24:27], s10 offen offset:2048 sc1
    buffer_load_dwordx4 v[204:207], v244, s[24:27], s10 offen offset:3072 sc1
    s_add_u32 s10, s10, 4096
    buffer_load_dwordx4 v[208:211], v244, s[24:27], s10 offen offset:0 sc1
    buffer_load_dwordx4 v[212:215], v244, s[24:27], s10 offen offset:1024 sc1
    buffer_load_dwordx4 v[216:219], v244, s[24:27], s10 offen offset:2048 sc1
    buffer_load_dwordx4 v[220:223], v244, s[24:27], s10 offen offset:3072 sc1
    s_add_u32 s10, s10, 4096
    buffer_load_dwordx4 v[224:227], v244, s[24:27], s10 offen offset:0 sc1
    buffer_load_dwordx4 v[228:231], v244, s[24:27], s10 offen offset:1024 sc1
    buffer_load_dwordx4 v[232:235], v244, s[24:27], s10 offen offset:2048 sc1
    buffer_load_dwordx4 v[236:239], v244, s[24:27], s10 offen offset:3072 sc1
    s_add_u32 s10, s10, 4096
    s_waitcnt vmcnt(31)
    v_mfma_f32_32x32x16_bf16 v[64:79], v[112:115], v[240:243], 0
    s_waitcnt vmcnt(30)
    v_mfma_f32_32x32x16_bf16 v[64:79], v[116:119], v[240:243], v[64:79]
    s_waitcnt vmcnt(29)
    v_mfma_f32_32x32x16_bf16 v[64:79], v[120:123], v[240:243], v[64:79]
    s_waitcnt vmcnt(28)
    v_mfma_f32_32x32x16_bf16 v[64:79], v[124:127], v[240:243], v[64:79]
    s_waitcnt vmcnt(27)
    v_mfma_f32_32x32x16_bf16 v[64:79], v[128:131], v[240:243], v[64:79]
    s_waitcnt vmcnt(26)
    v_mfma_f32_32x32x16_bf16 v[64:79], v[132:135], v[240:243], v[64:79]
    s_waitcnt vmcnt(25)
    v_mfma_f32_32x32x16_bf16 v[64:79], v[136:139], v[240:243], v[64:79]
    s_waitcnt vmcnt(24)
    v_mfma_f32_32x32x16_bf16 v[64:79], v[140:143], v[240:243], v[64:79]
    s_waitcnt vmcnt(23)
    v_mfma_f32_32x32x16_bf16 v[64:79], v[144:147], v[240:243], v[64:79]
    s_waitcnt vmcnt(22)
    v_mfma_f32_32x32x16_bf16 v[64:79], v[148:151], v[240:243], v[64:79]
    s_waitcnt vmcnt(21)
    v_mfma_f32_32x32x16_bf16 v[64:79], v[152:155], v[240:243], v[64:79]
    s_waitcnt vmcnt(20)
    v_mfma_f32_32x32x16_bf16 v[64:79], v[156:159], v[240:243], v[64:79]
    s_waitcnt vmcnt(19)
    v_mfma_f32_32x32x16_bf16 v[64:79], v[160:163], v[240:243], v[64:79]
    s_waitcnt vmcnt(18)
    v_mfma_f32_32x32x16_bf16 v[64:79], v[164:167], v[240:243], v[64:79]
    s_waitcnt vmcnt(17)
    v_mfma_f32_32x32x16_bf16 v[64:79], v[168:171], v[240:243], v[64:79]
    s_waitcnt vmcnt(16)
    v_mfma_f32_32x32x16_bf16 v[64:79], v[172:175], v[240:243], v[64:79]
    s_waitcnt vmcnt(15)
    v_mfma_f32_32x32x16_bf16 v[64:79], v[176:179], v[240:243], v[64:79]
    s_waitcnt vmcnt(14)
    v_mfma_f32_32x32x16_bf16 v[64:79], v[180:183], v[240:243], v[64:79]
    s_waitcnt vmcnt(13)
    v_mfma_f32_32x32x16_bf16 v[64:79], v[184:187], v[240:243], v[64:79]
    s_waitcnt vmcnt(12)
    v_mfma_f32_32x32x16_bf16 v[64:79], v[188:191], v[240:243], v[64:79]
    s_waitcnt vmcnt(11)
    v_mfma_f32_32x32x16_bf16 v[64:79], v[192:195], v[240:243], v[64:79]
    s_waitcnt vmcnt(10)
    v_mfma_f32_32x32x16_bf16 v[64:79], v[196:199], v[240:243], v[64:79]
    s_waitcnt vmcnt(9)
    v_mfma_f32_32x32x16_bf16 v[64:79], v[200:203], v[240:243], v[64:79]
    s_waitcnt vmcnt(8)
    v_mfma_f32_32x32x16_bf16 v[64:79], v[204:207], v[240:243], v[64:79]
    buffer_load_dwordx2 v[0:1], v247, s[24:27], s16 offen sc1
    s_waitcnt vmcnt(8)
    v_mfma_f32_32x32x16_bf16 v[64:79], v[208:211], v[240:243], v[64:79]
    s_waitcnt vmcnt(7)
    v_mfma_f32_32x32x16_bf16 v[64:79], v[212:215], v[240:243], v[64:79]
    s_waitcnt vmcnt(6)
    v_mfma_f32_32x32x16_bf16 v[64:79], v[216:219], v[240:243], v[64:79]
    s_waitcnt vmcnt(5)
    v_mfma_f32_32x32x16_bf16 v[64:79], v[220:223], v[240:243], v[64:79]
    s_waitcnt vmcnt(4)
    v_mfma_f32_32x32x16_bf16 v[64:79], v[224:227], v[240:243], v[64:79]
    s_waitcnt vmcnt(3)
    v_mfma_f32_32x32x16_bf16 v[64:79], v[228:231], v[240:243], v[64:79]
    s_waitcnt vmcnt(2)
    v_mfma_f32_32x32x16_bf16 v[64:79], v[232:235], v[240:243], v[64:79]
    s_waitcnt vmcnt(1)
    v_mfma_f32_32x32x16_bf16 v[64:79], v[236:239], v[240:243], v[64:79]
    s_mov_b32 s17, 0x40000
    s_branch k1f_kernel_hfw
k1f_kernel_hf:
    buffer_load_dwordx2 v[0:1], v247, s[24:27], s16 offen sc1
k1f_kernel_hfw:
    s_waitcnt vmcnt(0)
    v_cmp_eq_u64 vcc, s[64:65], v[0:1]
    s_cmp_eq_u64 vcc, -1
    s_cbranch_scc1 k1f_kernel_hfd
    s_sleep 1
    s_sub_u32 s17, s17, 1
    s_cbranch_scc0 k1f_kernel_hf
k1f_kernel_hfd:
    s_add_u32 m0, s12, 0
    s_nop 0
    buffer_load_dwordx4 v244, s[24:27], s11 offen offset:0 sc1 lds
    buffer_load_dwordx4 v244, s[24:27], s11 offen offset:1024 sc1 lds
    buffer_load_dwordx4 v244, s[24:27], s11 offen offset:2048 sc1 lds
    buffer_load_dwordx4 v244, s[24:27], s11 offen offset:3072 sc1 lds
    s_add_u32 s11, s11, 4096
    s_add_u32 m0, s12, 16384
    s_nop 0
    buffer_load_dwordx4 v244, s[24:27], s11 offen offset:0 sc1 lds
    buffer_load_dwordx4 v244, s[24:27], s11 offen offset:1024 sc1 lds
    buffer_load_dwordx4 v244, s[24:27], s11 offen offset:2048 sc1 lds
    buffer_load_dwordx4 v244, s[24:27], s11 offen offset:3072 sc1 lds
    s_add_u32 s11, s11, 4096
    s_add_u32 m0, s12, 32768
    s_nop 0
    buffer_load_dwordx4 v244, s[24:27], s11 offen offset:0 sc1 lds
    buffer_load_dwordx4 v244, s[24:27], s11 offen offset:1024 sc1 lds
    buffer_load_dwordx4 v244, s[24:27], s11 offen offset:2048 sc1 lds
    buffer_load_dwordx4 v244, s[24:27], s11 offen offset:3072 sc1 lds
    s_add_u32 s11, s11, 4096
    s_add_u32 m0, s12, 49152
    s_nop 0
    buffer_load_dwordx4 v244, s[24:27], s11 offen offset:0 sc1 lds
    buffer_load_dwordx4 v244, s[24:27], s11 offen offset:1024 sc1 lds
    buffer_load_dwordx4 v244, s[24:27], s11 offen offset:2048 sc1 lds
    buffer_load_dwordx4 v244, s[24:27], s11 offen offset:3072 sc1 lds
    s_add_u32 s11, s11, 4096
    s_add_u32 m0, s12, 65536
    s_nop 0
    buffer_load_dwordx4 v244, s[24:27], s11 offen offset:0 sc1 lds
    buffer_load_dwordx4 v244, s[24:27], s11 offen offset:1024 sc1 lds
    buffer_load_dwordx4 v244, s[24:27], s11 offen offset:2048 sc1 lds
    buffer_load_dwordx4 v244, s[24:27], s11 offen offset:3072 sc1 lds
    s_add_u32 s11, s11, 4096
    s_add_u32 m0, s12, 81920
    s_nop 0
    buffer_load_dwordx4 v244, s[24:27], s11 offen offset:0 sc1 lds
    buffer_load_dwordx4 v244, s[24:27], s11 offen offset:1024 sc1 lds
    buffer_load_dwordx4 v244, s[24:27], s11 offen offset:2048 sc1 lds
    buffer_load_dwordx4 v244, s[24:27], s11 offen offset:3072 sc1 lds
    s_add_u32 s11, s11, 4096
    s_add_u32 m0, s12, 98304
    s_nop 0
    buffer_load_dwordx4 v244, s[24:27], s11 offen offset:0 sc1 lds
    buffer_load_dwordx4 v244, s[24:27], s11 offen offset:1024 sc1 lds
    buffer_load_dwordx4 v244, s[24:27], s11 offen offset:2048 sc1 lds
    buffer_load_dwordx4 v244, s[24:27], s11 offen offset:3072 sc1 lds
    s_add_u32 s11, s11, 4096
    s_add_u32 m0, s12, 114688
    s_nop 0
    buffer_load_dwordx4 v244, s[24:27], s11 offen offset:0 sc1 lds
    buffer_load_dwordx4 v244, s[24:27], s11 offen offset:1024 sc1 lds
    buffer_load_dwordx4 v244, s[24:27], s11 offen offset:2048 sc1 lds
    buffer_load_dwordx4 v244, s[24:27], s11 offen offset:3072 sc1 lds
    s_add_u32 s11, s11, 4096
    s_lshl_b32 s6, s8, 9
    s_lshl_b32 s7, s14, 3
    s_add_u32 s6, s6, s7
    s_add_u32 s16, s6, 0x3b9e000
    s_waitcnt vmcnt(28)
    s_barrier
    ds_read_b128 v[80:83], v244 offset:0
    ds_read_b128 v[84:87], v244 offset:4096
    ds_read_b128 v[88:91], v244 offset:8192
    ds_read_b128 v[92:95], v244 offset:12288
    ds_read_b128 v[96:99], v244 offset:1024
    ds_read_b128 v[100:103], v244 offset:5120
    s_waitcnt lgkmcnt(5)
    v_mfma_f32_32x32x16_bf16 v[0:15], v[112:115], v[80:83], 0
    ds_read_b128 v[104:107], v244 offset:9216
    s_waitcnt lgkmcnt(5)
    v_mfma_f32_32x32x16_bf16 v[16:31], v[112:115], v[84:87], 0
    ds_read_b128 v[108:111], v244 offset:13312
    s_waitcnt lgkmcnt(5)
    v_mfma_f32_32x32x16_bf16 v[32:47], v[112:115], v[88:91], 0
    ds_read_b128 v[80:83], v244 offset:2048
    s_waitcnt lgkmcnt(5)
    v_mfma_f32_32x32x16_bf16 v[48:63], v[112:115], v[92:95], 0
    ds_read_b128 v[84:87], v244 offset:6144
    s_waitcnt lgkmcnt(5)
    v_mfma_f32_32x32x16_bf16 v[0:15], v[116:119], v[96:99], v[0:15]
    ds_read_b128 v[88:91], v244 offset:10240
    s_waitcnt lgkmcnt(5)
    v_mfma_f32_32x32x16_bf16 v[16:31], v[116:119], v[100:103], v[16:31]
    ds_read_b128 v[92:95], v244 offset:14336
    s_waitcnt lgkmcnt(5)
    v_mfma_f32_32x32x16_bf16 v[32:47], v[116:119], v[104:107], v[32:47]
    ds_read_b128 v[96:99], v244 offset:3072
    s_waitcnt lgkmcnt(5)
    v_mfma_f32_32x32x16_bf16 v[48:63], v[116:119], v[108:111], v[48:63]
    ds_read_b128 v[100:103], v244 offset:7168
    s_waitcnt lgkmcnt(5)
    v_mfma_f32_32x32x16_bf16 v[0:15], v[120:123], v[80:83], v[0:15]
    ds_read_b128 v[104:107], v244 offset:11264
    s_waitcnt lgkmcnt(5)
    v_mfma_f32_32x32x16_bf16 v[16:31], v[120:123], v[84:87], v[16:31]
    s_waitcnt vmcnt(24)
    s_barrier
    ds_read_b128 v[108:111], v244 offset:15360
    s_waitcnt lgkmcnt(5)
    v_mfma_f32_32x32x16_bf16 v[32:47], v[120:123], v[88:91], v[32:47]
    ds_read_b128 v[80:83], v244 offset:16384
    s_waitcnt lgkmcnt(5)
    v_mfma_f32_32x32x16_bf16 v[48:63], v[120:123], v[92:95], v[48:63]
    ds_read_b128 v[84:87], v244 offset:20480
    s_waitcnt lgkmcnt(5)
    v_mfma_f32_32x32x16_bf16 v[0:15], v[124:127], v[96:99], v[0:15]
    ds_read_b128 v[88:91], v244 offset:24576
    s_waitcnt lgkmcnt(5)
    v_mfma_f32_32x32x16_bf16 v[16:31], v[124:127], v[100:103], v[16:31]
    ds_read_b128 v[92:95], v244 offset:28672
    s_waitcnt lgkmcnt(5)
    v_mfma_f32_32x32x16_bf16 v[32:47], v[124:127], v[104:107], v[32:47]
    ds_read_b128 v[96:99], v244 offset:17408
    s_waitcnt lgkmcnt(5)
    v_mfma_f32_32x32x16_bf16 v[48:63], v[124:127], v[108:111], v[48:63]
    ds_read_b128 v[100:103], v244 offset:21504
    s_waitcnt lgkmcnt(5)
    v_mfma_f32_32x32x16_bf16 v[0:15], v[128:131], v[80:83], v[0:15]
    ds_read_b128 v[104:107], v244 offset:25600
    s_waitcnt lgkmcnt(5)
    v_mfma_f32_32x32x16_bf16 v[16:31], v[128:131], v[84:87], v[16:31]
    ds_read_b128 v[108:111], v244 offset:29696
    s_waitcnt lgkmcnt(5)
    v_mfma_f32_32x32x16_bf16 v[32:47], v[128:131], v[88:91], v[32:47]
    ds_read_b128 v[80:83], v244 offset:18432
    s_waitcnt lgkmcnt(5)
    v_mfma_f32_32x32x16_bf16 v[48:63], v[128:131], v[92:95], v[48:63]
    ds_read_b128 v[84:87], v244 offset:22528
    s_waitcnt lgkmcnt(5)
    v_mfma_f32_32x32x16_bf16 v[0:15], v[132:135], v[96:99], v[0:15]
    ds_read_b128 v[88:91], v244 offset:26624
    s_waitcnt lgkmcnt(5)
    v_mfma_f32_32x32x16_bf16 v[16:31], v[132:135], v[100:103], v[16:31]
    ds_read_b128 v[92:95], v244 offset:30720
    s_waitcnt lgkmcnt(5)
    v_mfma_f32_32x32x16_bf16 v[32:47], v[132:135], v[104:107], v[32:47]
    ds_read_b128 v[96:99], v244 offset:19456
    s_waitcnt lgkmcnt(5)
    v_mfma_f32_32x32x16_bf16 v[48:63], v[132:135], v[108:111], v[48:63]
    ds_read_b128 v[100:103], v244 offset:23552
    s_waitcnt lgkmcnt(5)
    v_mfma_f32_32x32x16_bf16 v[0:15], v[136:139], v[80:83], v[0:15]
    ds_read_b128 v[104:107], v244 offset:27648
    s_waitcnt lgkmcnt(5)
    v_mfma_f32_32x32x16_bf16 v[16:31], v[136:139], v[84:87], v[16:31]
    s_waitcnt vmcnt(20)
    s_barrier
    ds_read_b128 v[108:111], v244 offset:31744
    s_waitcnt lgkmcnt(5)
    v_mfma_f32_32x32x16_bf16 v[32:47], v[136:139], v[88:91], v[32:47]
    ds_read_b128 v[80:83], v244 offset:32768
    s_waitcnt lgkmcnt(5)
    v_mfma_f32_32x32x16_bf16 v[48:63], v[136:139], v[92:95], v[48:63]
    ds_read_b128 v[84:87], v244 offset:36864
    s_waitcnt lgkmcnt(5)
    v_mfma_f32_32x32x16_bf16 v[0:15], v[140:143], v[96:99], v[0:15]
    ds_read_b128 v[88:91], v244 offset:40960
    s_waitcnt lgkmcnt(5)
    v_mfma_f32_32x32x16_bf16 v[16:31], v[140:143], v[100:103], v[16:31]
    ds_read_b128 v[92:95], v244 offset:45056
    s_waitcnt lgkmcnt(5)
    v_mfma_f32_32x32x16_bf16 v[32:47], v[140:143], v[104:107], v[32:47]
    ds_read_b128 v[96:99], v244 offset:33792
    s_waitcnt lgkmcnt(5)
    v_mfma_f32_32x32x16_bf16 v[48:63], v[140:143], v[108:111], v[48:63]
    ds_read_b128 v[100:103], v244 offset:37888
    s_waitcnt lgkmcnt(5)
    v_mfma_f32_32x32x16_bf16 v[0:15], v[144:147], v[80:83], v[0:15]
    ds_read_b128 v[104:107], v244 offset:41984
    s_waitcnt lgkmcnt(5)
    v_mfma_f32_32x32x16_bf16 v[16:31], v[144:147], v[84:87], v[16:31]
    ds_read_b128 v[108:111], v244 offset:46080
    s_waitcnt lgkmcnt(5)
    v_mfma_f32_32x32x16_bf16 v[32:47], v[144:147], v[88:91], v[32:47]
    ds_read_b128 v[80:83], v244 offset:34816
    s_waitcnt lgkmcnt(5)
    v_mfma_f32_32x32x16_bf16 v[48:63], v[144:147], v[92:95], v[48:63]
    ds_read_b128 v[84:87], v244 offset:38912
    s_waitcnt lgkmcnt(5)
    v_mfma_f32_32x32x16_bf16 v[0:15], v[148:151], v[96:99], v[0:15]
    ds_read_b128 v[88:91], v244 offset:43008
    s_waitcnt lgkmcnt(5)
    v_mfma_f32_32x32x16_bf16 v[16:31], v[148:151], v[100:103], v[16:31]
    ds_read_b128 v[92:95], v244 offset:47104
    s_waitcnt lgkmcnt(5)
    v_mfma_f32_32x32x16_bf16 v[32:47], v[148:151], v[104:107], v[32:47]
    ds_read_b128 v[96:99], v244 offset:35840
    s_waitcnt lgkmcnt(5)
    v_mfma_f32_32x32x16_bf16 v[48:63], v[148:151], v[108:111], v[48:63]
    ds_read_b128 v[100:103], v244 offset:39936
    s_waitcnt lgkmcnt(5)
    v_mfma_f32_32x32x16_bf16 v[0:15], v[152:155], v[80:83], v[0:15]
    ds_read_b128 v[104:107], v244 offset:44032
    s_waitcnt lgkmcnt(5)
    v_mfma_f32_32x32x16_bf16 v[16:31], v[152:155], v[84:87], v[16:31]
    s_waitcnt vmcnt(16)
    s_barrier
    ds_read_b128 v[108:111], v244 offset:48128
    s_waitcnt lgkmcnt(5)
    v_mfma_f32_32x32x16_bf16 v[32:47], v[152:155], v[88:91], v[32:47]
    ds_read_b128 v[80:83], v244 offset:49152
    s_waitcnt lgkmcnt(5)
    v_mfma_f32_32x32x16_bf16 v[48:63], v[152:155], v[92:95], v[48:63]
    ds_read_b128 v[84:87], v244 offset:53248
    s_waitcnt lgkmcnt(5)
    v_mfma_f32_32x32x16_bf16 v[0:15], v[156:159], v[96:99], v[0:15]
    ds_read_b128 v[88:91], v244 offset:57344
    s_waitcnt lgkmcnt(5)
    v_mfma_f32_32x32x16_bf16 v[16:31], v[156:159], v[100:103], v[16:31]
    ds_read_b128 v[92:95], v244 offset:61440
    s_waitcnt lgkmcnt(5)
    v_mfma_f32_32x32x16_bf16 v[32:47], v[156:159], v[104:107], v[32:47]
    ds_read_b128 v[96:99], v244 offset:50176
    s_waitcnt lgkmcnt(5)
    v_mfma_f32_32x32x16_bf16 v[48:63], v[156:159], v[108:111], v[48:63]
    ds_read_b128 v[100:103], v244 offset:54272
    s_waitcnt lgkmcnt(5)
    v_mfma_f32_32x32x16_bf16 v[0:15], v[160:163], v[80:83], v[0:15]
    ds_read_b128 v[104:107], v244 offset:58368
    s_waitcnt lgkmcnt(5)
    v_mfma_f32_32x32x16_bf16 v[16:31], v[160:163], v[84:87], v[16:31]
    ds_read_b128 v[108:111], v244 offset:62464
    s_waitcnt lgkmcnt(5)
    v_mfma_f32_32x32x16_bf16 v[32:47], v[160:163], v[88:91], v[32:47]
    ds_read_b128 v[80:83], v244 offset:51200
    s_waitcnt lgkmcnt(5)
    v_mfma_f32_32x32x16_bf16 v[48:63], v[160:163], v[92:95], v[48:63]
    ds_read_b128 v[84:87], v244 offset:55296
    s_waitcnt lgkmcnt(5)
    v_mfma_f32_32x32x16_bf16 v[0:15], v[164:167], v[96:99], v[0:15]
    ds_read_b128 v[88:91], v244 offset:59392
    s_waitcnt lgkmcnt(5)
    v_mfma_f32_32x32x16_bf16 v[16:31], v[164:167], v[100:103], v[16:31]
    ds_read_b128 v[92:95], v244 offset:63488
    s_waitcnt lgkmcnt(5)
    v_mfma_f32_32x32x16_bf16 v[32:47], v[164:167], v[104:107], v[32:47]
    ds_read_b128 v[96:99], v244 offset:52224
    s_waitcnt lgkmcnt(5)
    v_mfma_f32_32x32x16_bf16 v[48:63], v[164:167], v[108:111], v[48:63]
    ds_read_b128 v[100:103], v244 offset:56320
    s_waitcnt lgkmcnt(5)
    v_mfma_f32_32x32x16_bf16 v[0:15], v[168:171], v[80:83], v[0:15]
    ds_read_b128 v[104:107], v244 offset:60416
    s_waitcnt lgkmcnt(5)
    v_mfma_f32_32x32x16_bf16 v[16:31], v[168:171], v[84:87], v[16:31]
    s_waitcnt vmcnt(12)
    s_barrier
    ds_read_b128 v[108:111], v244 offset:64512
    s_waitcnt lgkmcnt(5)
    v_mfma_f32_32x32x16_bf16 v[32:47], v[168:171], v[88:91], v[32:47]
    ds_read_b128 v[80:83], v245 offset:0
    s_waitcnt lgkmcnt(5)
    v_mfma_f32_32x32x16_bf16 v[48:63], v[168:171], v[92:95], v[48:63]
    ds_read_b128 v[84:87], v245 offset:4096
    s_waitcnt lgkmcnt(5)
    v_mfma_f32_32x32x16_bf16 v[0:15], v[172:175], v[96:99], v[0:15]
    ds_read_b128 v[88:91], v245 offset:8192
    s_waitcnt lgkmcnt(5)
    v_mfma_f32_32x32x16_bf16 v[16:31], v[172:175], v[100:103], v[16:31]
    ds_read_b128 v[92:95], v245 offset:12288
    s_waitcnt lgkmcnt(5)
    v_mfma_f32_32x32x16_bf16 v[32:47], v[172:175], v[104:107], v[32:47]
    ds_read_b128 v[96:99], v245 offset:1024
    s_waitcnt lgkmcnt(5)
    v_mfma_f32_32x32x16_bf16 v[48:63], v[172:175], v[108:111], v[48:63]
    ds_read_b128 v[100:103], v245 offset:5120
    s_waitcnt lgkmcnt(5)
    v_mfma_f32_32x32x16_bf16 v[0:15], v[176:179], v[80:83], v[0:15]
    ds_read_b128 v[104:107], v245 offset:9216
    s_waitcnt lgkmcnt(5)
    v_mfma_f32_32x32x16_bf16 v[16:31], v[176:179], v[84:87], v[16:31]
    ds_read_b128 v[108:111], v245 offset:13312
    s_waitcnt lgkmcnt(5)
    v_mfma_f32_32x32x16_bf16 v[32:47], v[176:179], v[88:91], v[32:47]
    ds_read_b128 v[80:83], v245 offset:2048
    s_waitcnt lgkmcnt(5)
    v_mfma_f32_32x32x16_bf16 v[48:63], v[176:179], v[92:95], v[48:63]
    ds_read_b128 v[84:87], v245 offset:6144
    s_waitcnt lgkmcnt(5)
    v_mfma_f32_32x32x16_bf16 v[0:15], v[180:183], v[96:99], v[0:15]
    ds_read_b128 v[88:91], v245 offset:10240
    s_waitcnt lgkmcnt(5)
    v_mfma_f32_32x32x16_bf16 v[16:31], v[180:183], v[100:103], v[16:31]
    ds_read_b128 v[92:95], v245 offset:14336
    s_waitcnt lgkmcnt(5)
    v_mfma_f32_32x32x16_bf16 v[32:47], v[180:183], v[104:107], v[32:47]
    ds_read_b128 v[96:99], v245 offset:3072
    s_waitcnt lgkmcnt(5)
    v_mfma_f32_32x32x16_bf16 v[48:63], v[180:183], v[108:111], v[48:63]
    ds_read_b128 v[100:103], v245 offset:7168
    s_waitcnt lgkmcnt(5)
    v_mfma_f32_32x32x16_bf16 v[0:15], v[184:187], v[80:83], v[0:15]
    ds_read_b128 v[104:107], v245 offset:11264
    s_waitcnt lgkmcnt(5)
    v_mfma_f32_32x32x16_bf16 v[16:31], v[184:187], v[84:87], v[16:31]
    s_waitcnt vmcnt(8)
    s_barrier
    ds_read_b128 v[108:111], v245 offset:15360
    s_waitcnt lgkmcnt(5)
    v_mfma_f32_32x32x16_bf16 v[32:47], v[184:187], v[88:91], v[32:47]
    ds_read_b128 v[80:83], v245 offset:16384
    s_waitcnt lgkmcnt(5)
    v_mfma_f32_32x32x16_bf16 v[48:63], v[184:187], v[92:95], v[48:63]
    ds_read_b128 v[84:87], v245 offset:20480
    s_waitcnt lgkmcnt(5)
    v_mfma_f32_32x32x16_bf16 v[0:15], v[188:191], v[96:99], v[0:15]
    ds_read_b128 v[88:91], v245 offset:24576
    s_waitcnt lgkmcnt(5)
    v_mfma_f32_32x32x16_bf16 v[16:31], v[188:191], v[100:103], v[16:31]
    ds_read_b128 v[92:95], v245 offset:28672
    s_waitcnt lgkmcnt(5)
    v_mfma_f32_32x32x16_bf16 v[32:47], v[188:191], v[104:107], v[32:47]
    ds_read_b128 v[96:99], v245 offset:17408
    s_waitcnt lgkmcnt(5)
    v_mfma_f32_32x32x16_bf16 v[48:63], v[188:191], v[108:111], v[48:63]
    ds_read_b128 v[100:103], v245 offset:21504
    s_waitcnt lgkmcnt(5)
    v_mfma_f32_32x32x16_bf16 v[0:15], v[192:195], v[80:83], v[0:15]
    ds_read_b128 v[104:107], v245 offset:25600
    s_waitcnt lgkmcnt(5)
    v_mfma_f32_32x32x16_bf16 v[16:31], v[192:195], v[84:87], v[16:31]
    ds_read_b128 v[108:111], v245 offset:29696
    s_waitcnt lgkmcnt(5)
    v_mfma_f32_32x32x16_bf16 v[32:47], v[192:195], v[88:91], v[32:47]
    ds_read_b128 v[80:83], v245 offset:18432
    s_waitcnt lgkmcnt(5)
    v_mfma_f32_32x32x16_bf16 v[48:63], v[192:195], v[92:95], v[48:63]
    ds_read_b128 v[84:87], v245 offset:22528
    s_waitcnt lgkmcnt(5)
    v_mfma_f32_32x32x16_bf16 v[0:15], v[196:199], v[96:99], v[0:15]
    ds_read_b128 v[88:91], v245 offset:26624
    s_waitcnt lgkmcnt(5)
    v_mfma_f32_32x32x16_bf16 v[16:31], v[196:199], v[100:103], v[16:31]
    ds_read_b128 v[92:95], v245 offset:30720
    s_waitcnt lgkmcnt(5)
    v_mfma_f32_32x32x16_bf16 v[32:47], v[196:199], v[104:107], v[32:47]
    ds_read_b128 v[96:99], v245 offset:19456
    s_waitcnt lgkmcnt(5)
    v_mfma_f32_32x32x16_bf16 v[48:63], v[196:199], v[108:111], v[48:63]
    ds_read_b128 v[100:103], v245 offset:23552
    s_waitcnt lgkmcnt(5)
    v_mfma_f32_32x32x16_bf16 v[0:15], v[200:203], v[80:83], v[0:15]
    ds_read_b128 v[104:107], v245 offset:27648
    s_waitcnt lgkmcnt(5)
    v_mfma_f32_32x32x16_bf16 v[16:31], v[200:203], v[84:87], v[16:31]
    s_waitcnt vmcnt(4)
    s_barrier
    ds_read_b128 v[108:111], v245 offset:31744
    s_waitcnt lgkmcnt(5)
    v_mfma_f32_32x32x16_bf16 v[32:47], v[200:203], v[88:91], v[32:47]
    ds_read_b128 v[80:83], v245 offset:32768
    s_waitcnt lgkmcnt(5)
    v_mfma_f32_32x32x16_bf16 v[48:63], v[200:203], v[92:95], v[48:63]
    ds_read_b128 v[84:87], v245 offset:36864
    s_waitcnt lgkmcnt(5)
    v_mfma_f32_32x32x16_bf16 v[0:15], v[204:207], v[96:99], v[0:15]
    ds_read_b128 v[88:91], v245 offset:33792
    s_waitcnt lgkmcnt(5)
    v_mfma_f32_32x32x16_bf16 v[16:31], v[204:207], v[100:103], v[16:31]
    ds_read_b128 v[92:95], v245 offset:37888
    s_waitcnt lgkmcnt(5)
    v_mfma_f32_32x32x16_bf16 v[32:47], v[204:207], v[104:107], v[32:47]
    ds_read_b128 v[96:99], v245 offset:34816
    s_waitcnt lgkmcnt(5)
    v_mfma_f32_32x32x16_bf16 v[48:63], v[204:207], v[108:111], v[48:63]
    ds_read_b128 v[100:103], v245 offset:38912
    s_waitcnt lgkmcnt(5)
    v_mfma_f32_32x32x16_bf16 v[0:15], v[208:211], v[80:83], v[0:15]
    ds_read_b128 v[104:107], v245 offset:35840
    s_waitcnt lgkmcnt(5)
    v_mfma_f32_32x32x16_bf16 v[16:31], v[208:211], v[84:87], v[16:31]
    s_waitcnt vmcnt(0)
    s_barrier
    ds_read_b128 v[108:111], v245 offset:39936
    s_waitcnt lgkmcnt(5)
    v_mfma_f32_32x32x16_bf16 v[0:15], v[212:215], v[88:91], v[0:15]
    ds_read_b128 v[80:83], v245 offset:49152
    s_waitcnt lgkmcnt(5)
    v_mfma_f32_32x32x16_bf16 v[16:31], v[212:215], v[92:95], v[16:31]
    ds_read_b128 v[84:87], v245 offset:53248
    s_waitcnt lgkmcnt(5)
    v_mfma_f32_32x32x16_bf16 v[0:15], v[216:219], v[96:99], v[0:15]
    ds_read_b128 v[88:91], v245 offset:50176
    ds_read_b64 v[112:113], v246 offset:0
    ds_read_b64 v[114:115], v246 offset:256
    ds_read_b64 v[116:117], v246 offset:512
    ds_read_b64 v[118:119], v246 offset:768
    s_waitcnt lgkmcnt(9)
    v_mfma_f32_32x32x16_bf16 v[16:31], v[216:219], v[100:103], v[16:31]
    ds_read_b128 v[92:95], v245 offset:54272
    s_waitcnt lgkmcnt(9)
    v_mfma_f32_32x32x16_bf16 v[0:15], v[220:223], v[104:107], v[0:15]
    ds_read_b128 v[96:99], v245 offset:51200
    s_waitcnt lgkmcnt(9)
    v_mfma_f32_32x32x16_bf16 v[16:31], v[220:223], v[108:111], v[16:31]
    ds_read_b128 v[100:103], v245 offset:55296
    s_waitcnt lgkmcnt(9)
    v_mfma_f32_32x32x16_bf16 v[0:15], v[224:227], v[80:83], v[0:15]
    ds_read_b128 v[104:107], v245 offset:52224
    s_waitcnt lgkmcnt(9)
    v_mfma_f32_32x32x16_bf16 v[16:31], v[224:227], v[84:87], v[16:31]
    ds_read_b128 v[108:111], v245 offset:56320
    s_waitcnt lgkmcnt(9)
    v_mfma_f32_32x32x16_bf16 v[0:15], v[228:231], v[88:91], v[0:15]
    ds_read_b128 v[80:83], v245 offset:40960
    s_waitcnt lgkmcnt(5)
    v_mfma_f32_32x32x16_bf16 v[16:31], v[228:231], v[92:95], v[16:31]
    ds_read_b128 v[84:87], v245 offset:45056
    s_waitcnt lgkmcnt(5)
    v_mfma_f32_32x32x16_bf16 v[0:15], v[232:235], v[96:99], v[0:15]
    ds_read_b128 v[88:91], v245 offset:41984
    s_waitcnt lgkmcnt(5)
    v_mfma_f32_32x32x16_bf16 v[16:31], v[232:235], v[100:103], v[16:31]
    ds_read_b128 v[92:95], v245 offset:46080
    s_waitcnt lgkmcnt(5)
    v_mfma_f32_32x32x16_bf16 v[0:15], v[236:239], v[104:107], v[0:15]
    ds_read_b128 v[96:99], v245 offset:43008
    s_waitcnt lgkmcnt(5)
    v_mfma_f32_32x32x16_bf16 v[16:31], v[236:239], v[108:111], v[16:31]
    ds_read_b128 v[100:103], v245 offset:47104
    s_waitcnt lgkmcnt(5)
    v_mfma_f32_32x32x16_bf16 v[32:47], v[208:211], v[80:83], v[32:47]
    ds_read_b128 v[104:107], v245 offset:44032
    s_waitcnt lgkmcnt(5)
    v_mfma_f32_32x32x16_bf16 v[48:63], v[208:211], v[84:87], v[48:63]
    ds_read_b128 v[108:111], v245 offset:48128
    s_nop 1
    v_pk_fma_f32 v[0:1], v[64:65], v[112:113], v[0:1] op_sel_hi:[1,0,1] neg_lo:[0,1,0] neg_hi:[0,1,0]
    v_pk_fma_f32 v[2:3], v[66:67], v[112:113], v[2:3] op_sel_hi:[1,0,1] neg_lo:[0,1,0] neg_hi:[0,1,0]
    v_pk_fma_f32 v[4:5], v[68:69], v[112:113], v[4:5] op_sel_hi:[1,0,1] neg_lo:[0,1,0] neg_hi:[0,1,0]
    v_pk_fma_f32 v[6:7], v[70:71], v[112:113], v[6:7] op_sel_hi:[1,0,1] neg_lo:[0,1,0] neg_hi:[0,1,0]
    v_pk_fma_f32 v[8:9], v[72:73], v[112:113], v[8:9] op_sel_hi:[1,0,1] neg_lo:[0,1,0] neg_hi:[0,1,0]
    s_waitcnt lgkmcnt(5)
    v_mfma_f32_32x32x16_bf16 v[32:47], v[212:215], v[88:91], v[32:47]
    ds_read_b128 v[80:83], v245 offset:57344
    v_pk_fma_f32 v[10:11], v[74:75], v[112:113], v[10:11] op_sel_hi:[1,0,1] neg_lo:[0,1,0] neg_hi:[0,1,0]
    v_pk_fma_f32 v[12:13], v[76:77], v[112:113], v[12:13] op_sel_hi:[1,0,1] neg_lo:[0,1,0] neg_hi:[0,1,0]
    v_pk_fma_f32 v[14:15], v[78:79], v[112:113], v[14:15] op_sel_hi:[1,0,1] neg_lo:[0,1,0] neg_hi:[0,1,0]
    v_pk_mul_f32 v[0:1], v[0:1], v[112:113] op_sel:[0,1] op_sel_hi:[1,1]
    v_pk_mul_f32 v[2:3], v[2:3], v[112:113] op_sel:[0,1] op_sel_hi:[1,1]
    s_waitcnt lgkmcnt(5)
    v_mfma_f32_32x32x16_bf16 v[48:63], v[212:215], v[92:95], v[48:63]
    ds_read_b128 v[84:87], v245 offset:61440
    v_pk_mul_f32 v[4:5], v[4:5], v[112:113] op_sel:[0,1] op_sel_hi:[1,1]
    v_pk_mul_f32 v[6:7], v[6:7], v[112:113] op_sel:[0,1] op_sel_hi:[1,1]
    v_pk_mul_f32 v[8:9], v[8:9], v[112:113] op_sel:[0,1] op_sel_hi:[1,1]
    v_pk_mul_f32 v[10:11], v[10:11], v[112:113] op_sel:[0,1] op_sel_hi:[1,1]
    v_pk_mul_f32 v[12:13], v[12:13], v[112:113] op_sel:[0,1] op_sel_hi:[1,1]
    s_waitcnt lgkmcnt(5)
    v_mfma_f32_32x32x16_bf16 v[32:47], v[216:219], v[96:99], v[32:47]
    ds_read_b128 v[88:91], v245 offset:58368
    v_pk_mul_f32 v[14:15], v[14:15], v[112:113] op_sel:[0,1] op_sel_hi:[1,1]
    v_cvt_pk_bf16_f32 v0, v0, v1
    v_cvt_pk_bf16_f32 v1, v2, v3
    v_cvt_pk_bf16_f32 v2, v4, v5
    v_cvt_pk_bf16_f32 v3, v6, v7
    s_waitcnt lgkmcnt(5)
    v_mfma_f32_32x32x16_bf16 v[48:63], v[216:219], v[100:103], v[48:63]
    ds_read_b128 v[92:95], v245 offset:62464
    v_cvt_pk_bf16_f32 v4, v8, v9
    v_cvt_pk_bf16_f32 v5, v10, v11
    v_cvt_pk_bf16_f32 v6, v12, v13
    v_cvt_pk_bf16_f32 v7, v14, v15
    v_pk_max_i16 v0, v0, 0
    s_waitcnt lgkmcnt(5)
    v_mfma_f32_32x32x16_bf16 v[32:47], v[220:223], v[104:107], v[32:47]
    ds_read_b128 v[96:99], v245 offset:59392
    v_pk_max_i16 v1, v1, 0
    v_pk_max_i16 v2, v2, 0
    v_pk_max_i16 v3, v3, 0
    v_pk_max_i16 v4, v4, 0
    v_pk_max_i16 v5, v5, 0
    s_waitcnt lgkmcnt(5)
    v_mfma_f32_32x32x16_bf16 v[48:63], v[220:223], v[108:111], v[48:63]
    ds_read_b128 v[100:103], v245 offset:63488
    v_pk_max_i16 v6, v6, 0
    v_pk_max_i16 v7, v7, 0
    buffer_store_dwordx4 v[0:3], v244, s[24:27], s13 offen offset:0 sc1
    buffer_store_dwordx4 v[4:7], v244, s[24:27], s13 offen offset:1024 sc1
    s_add_u32 s13, s13, 114688
    s_waitcnt lgkmcnt(5)
    v_mfma_f32_32x32x16_bf16 v[32:47], v[224:227], v[80:83], v[32:47]
    ds_read_b128 v[104:107], v245 offset:60416
    v_pk_fma_f32 v[16:17], v[64:65], v[114:115], v[16:17] op_sel_hi:[1,0,1] neg_lo:[0,1,0] neg_hi:[0,1,0]
    v_pk_fma_f32 v[18:19], v[66:67], v[114:115], v[18:19] op_sel_hi:[1,0,1] neg_lo:[0,1,0] neg_hi:[0,1,0]
    v_pk_fma_f32 v[20:21], v[68:69], v[114:115], v[20:21] op_sel_hi:[1,0,1] neg_lo:[0,1,0] neg_hi:[0,1,0]
    v_pk_fma_f32 v[22:23], v[70:71], v[114:115], v[22:23] op_sel_hi:[1,0,1] neg_lo:[0,1,0] neg_hi:[0,1,0]
    v_pk_fma_f32 v[24:25], v[72:73], v[114:115], v[24:25] op_sel_hi:[1,0,1] neg_lo:[0,1,0] neg_hi:[0,1,0]
    s_waitcnt lgkmcnt(5)
    v_mfma_f32_32x32x16_bf16 v[48:63], v[224:227], v[84:87], v[48:63]
    ds_read_b128 v[108:111], v245 offset:64512
    v_pk_fma_f32 v[26:27], v[74:75], v[114:115], v[26:27] op_sel_hi:[1,0,1] neg_lo:[0,1,0] neg_hi:[0,1,0]
    v_pk_fma_f32 v[28:29], v[76:77], v[114:115], v[28:29] op_sel_hi:[1,0,1] neg_lo:[0,1,0] neg_hi:[0,1,0]
    v_pk_fma_f32 v[30:31], v[78:79], v[114:115], v[30:31] op_sel_hi:[1,0,1] neg_lo:[0,1,0] neg_hi:[0,1,0]
    v_pk_mul_f32 v[16:17], v[16:17], v[114:115] op_sel:[0,1] op_sel_hi:[1,1]
    v_pk_mul_f32 v[18:19], v[18:19], v[114:115] op_sel:[0,1] op_sel_hi:[1,1]
    s_waitcnt lgkmcnt(5)
    v_mfma_f32_32x32x16_bf16 v[32:47], v[228:231], v[88:91], v[32:47]
    v_pk_mul_f32 v[20:21], v[20:21], v[114:115] op_sel:[0,1] op_sel_hi:[1,1]
    v_pk_mul_f32 v[22:23], v[22:23], v[114:115] op_sel:[0,1] op_sel_hi:[1,1]
    v_pk_mul_f32 v[24:25], v[24:25], v[114:115] op_sel:[0,1] op_sel_hi:[1,1]
    v_pk_mul_f32 v[26:27], v[26:27], v[114:115] op_sel:[0,1] op_sel_hi:[1,1]
    v_pk_mul_f32 v[28:29], v[28:29], v[114:115] op_sel:[0,1] op_sel_hi:[1,1]
    s_waitcnt lgkmcnt(4)
    v_mfma_f32_32x32x16_bf16 v[48:63], v[228:231], v[92:95], v[48:63]
    v_pk_mul_f32 v[30:31], v[30:31], v[114:115] op_sel:[0,1] op_sel_hi:[1,1]
    v_cvt_pk_bf16_f32 v16, v16, v17
    v_cvt_pk_bf16_f32 v17, v18, v19
    v_cvt_pk_bf16_f32 v18, v20, v21
    v_cvt_pk_bf16_f32 v19, v22, v23
    s_waitcnt lgkmcnt(3)
    v_mfma_f32_32x32x16_bf16 v[32:47], v[232:235], v[96:99], v[32:47]
    v_cvt_pk_bf16_f32 v20, v24, v25
    v_cvt_pk_bf16_f32 v21, v26, v27
    v_cvt_pk_bf16_f32 v22, v28, v29
    v_cvt_pk_bf16_f32 v23, v30, v31
    v_pk_max_i16 v16, v16, 0
    s_waitcnt lgkmcnt(2)
    v_mfma_f32_32x32x16_bf16 v[48:63], v[232:235], v[100:103], v[48:63]
    v_pk_max_i16 v17, v17, 0
    v_pk_max_i16 v18, v18, 0
    v_pk_max_i16 v19, v19, 0
    v_pk_max_i16 v20, v20, 0
    v_pk_max_i16 v21, v21, 0
    s_waitcnt lgkmcnt(1)
    v_mfma_f32_32x32x16_bf16 v[32:47], v[236:239], v[104:107], v[32:47]
    v_pk_max_i16 v22, v22, 0
    v_pk_max_i16 v23, v23, 0
    buffer_store_dwordx4 v[16:19], v244, s[24:27], s13 offen offset:0 sc1
    buffer_store_dwordx4 v[20:23], v244, s[24:27], s13 offen offset:1024 sc1
    s_add_u32 s13, s13, 114688
    s_waitcnt lgkmcnt(0)
    v_mfma_f32_32x32x16_bf16 v[48:63], v[236:239], v[108:111], v[48:63]
    s_nop 4
    v_pk_fma_f32 v[32:33], v[64:65], v[116:117], v[32:33] op_sel_hi:[1,0,1] neg_lo:[0,1,0] neg_hi:[0,1,0]
    v_pk_fma_f32 v[34:35], v[66:67], v[116:117], v[34:35] op_sel_hi:[1,0,1] neg_lo:[0,1,0] neg_hi:[0,1,0]
    v_pk_fma_f32 v[36:37], v[68:69], v[116:117], v[36:37] op_sel_hi:[1,0,1] neg_lo:[0,1,0] neg_hi:[0,1,0]
    v_pk_fma_f32 v[38:39], v[70:71], v[116:117], v[38:39] op_sel_hi:[1,0,1] neg_lo:[0,1,0] neg_hi:[0,1,0]
    v_pk_fma_f32 v[40:41], v[72:73], v[116:117], v[40:41] op_sel_hi:[1,0,1] neg_lo:[0,1,0] neg_hi:[0,1,0]
    v_pk_fma_f32 v[42:43], v[74:75], v[116:117], v[42:43] op_sel_hi:[1,0,1] neg_lo:[0,1,0] neg_hi:[0,1,0]
    v_pk_fma_f32 v[44:45], v[76:77], v[116:117], v[44:45] op_sel_hi:[1,0,1] neg_lo:[0,1,0] neg_hi:[0,1,0]
    v_pk_fma_f32 v[46:47], v[78:79], v[116:117], v[46:47] op_sel_hi:[1,0,1] neg_lo:[0,1,0] neg_hi:[0,1,0]
    v_pk_mul_f32 v[32:33], v[32:33], v[116:117] op_sel:[0,1] op_sel_hi:[1,1]
    v_pk_mul_f32 v[34:35], v[34:35], v[116:117] op_sel:[0,1] op_sel_hi:[1,1]
    v_pk_mul_f32 v[36:37], v[36:37], v[116:117] op_sel:[0,1] op_sel_hi:[1,1]
    v_pk_mul_f32 v[38:39], v[38:39], v[116:117] op_sel:[0,1] op_sel_hi:[1,1]
    v_pk_mul_f32 v[40:41], v[40:41], v[116:117] op_sel:[0,1] op_sel_hi:[1,1]
    v_pk_mul_f32 v[42:43], v[42:43], v[116:117] op_sel:[0,1] op_sel_hi:[1,1]
    v_pk_mul_f32 v[44:45], v[44:45], v[116:117] op_sel:[0,1] op_sel_hi:[1,1]
    v_pk_mul_f32 v[46:47], v[46:47], v[116:117] op_sel:[0,1] op_sel_hi:[1,1]
    v_cvt_pk_bf16_f32 v32, v32, v33
    v_cvt_pk_bf16_f32 v33, v34, v35
    v_cvt_pk_bf16_f32 v34, v36, v37
    v_cvt_pk_bf16_f32 v35, v38, v39
    v_cvt_pk_bf16_f32 v36, v40, v41
    v_cvt_pk_bf16_f32 v37, v42, v43
    v_cvt_pk_bf16_f32 v38, v44, v45
    v_cvt_pk_bf16_f32 v39, v46, v47
    v_pk_max_i16 v32, v32, 0
    v_pk_max_i16 v33, v33, 0
    v_pk_max_i16 v34, v34, 0
    v_pk_max_i16 v35, v35, 0
    v_pk_max_i16 v36, v36, 0
    v_pk_max_i16 v37, v37, 0
    v_pk_max_i16 v38, v38, 0
    v_pk_max_i16 v39, v39, 0
    buffer_store_dwordx4 v[32:35], v244, s[24:27], s13 offen offset:0 sc1
    buffer_store_dwordx4 v[36:39], v244, s[24:27], s13 offen offset:1024 sc1
    s_add_u32 s13, s13, 114688
    v_pk_fma_f32 v[48:49], v[64:65], v[118:119], v[48:49] op_sel_hi:[1,0,1] neg_lo:[0,1,0] neg_hi:[0,1,0]
    v_pk_fma_f32 v[50:51], v[66:67], v[118:119], v[50:51] op_sel_hi:[1,0,1] neg_lo:[0,1,0] neg_hi:[0,1,0]
    v_pk_fma_f32 v[52:53], v[68:69], v[118:119], v[52:53] op_sel_hi:[1,0,1] neg_lo:[0,1,0] neg_hi:[0,1,0]
    v_pk_fma_f32 v[54:55], v[70:71], v[118:119], v[54:55] op_sel_hi:[1,0,1] neg_lo:[0,1,0] neg_hi:[0,1,0]
    v_pk_fma_f32 v[56:57], v[72:73], v[118:119], v[56:57] op_sel_hi:[1,0,1] neg_lo:[0,1,0] neg_hi:[0,1,0]
    v_pk_fma_f32 v[58:59], v[74:75], v[118:119], v[58:59] op_sel_hi:[1,0,1] neg_lo:[0,1,0] neg_hi:[0,1,0]
    v_pk_fma_f32 v[60:61], v[76:77], v[118:119], v[60:61] op_sel_hi:[1,0,1] neg_lo:[0,1,0] neg_hi:[0,1,0]
    v_pk_fma_f32 v[62:63], v[78:79], v[118:119], v[62:63] op_sel_hi:[1,0,1] neg_lo:[0,1,0] neg_hi:[0,1,0]
    v_pk_mul_f32 v[48:49], v[48:49], v[118:119] op_sel:[0,1] op_sel_hi:[1,1]
    v_pk_mul_f32 v[50:51], v[50:51], v[118:119] op_sel:[0,1] op_sel_hi:[1,1]
    v_pk_mul_f32 v[52:53], v[52:53], v[118:119] op_sel:[0,1] op_sel_hi:[1,1]
    v_pk_mul_f32 v[54:55], v[54:55], v[118:119] op_sel:[0,1] op_sel_hi:[1,1]
    v_pk_mul_f32 v[56:57], v[56:57], v[118:119] op_sel:[0,1] op_sel_hi:[1,1]
    v_pk_mul_f32 v[58:59], v[58:59], v[118:119] op_sel:[0,1] op_sel_hi:[1,1]
    v_pk_mul_f32 v[60:61], v[60:61], v[118:119] op_sel:[0,1] op_sel_hi:[1,1]
    v_pk_mul_f32 v[62:63], v[62:63], v[118:119] op_sel:[0,1] op_sel_hi:[1,1]
    v_cvt_pk_bf16_f32 v48, v48, v49
    v_cvt_pk_bf16_f32 v49, v50, v51
    v_cvt_pk_bf16_f32 v50, v52, v53
    v_cvt_pk_bf16_f32 v51, v54, v55
    v_cvt_pk_bf16_f32 v52, v56, v57
    v_cvt_pk_bf16_f32 v53, v58, v59
    v_cvt_pk_bf16_f32 v54, v60, v61
    v_cvt_pk_bf16_f32 v55, v62, v63
    v_pk_max_i16 v48, v48, 0
    v_pk_max_i16 v49, v49, 0
    v_pk_max_i16 v50, v50, 0
    v_pk_max_i16 v51, v51, 0
    v_pk_max_i16 v52, v52, 0
    v_pk_max_i16 v53, v53, 0
    v_pk_max_i16 v54, v54, 0
    v_pk_max_i16 v55, v55, 0
    buffer_store_dwordx4 v[48:51], v244, s[24:27], s13 offen offset:0 sc1
    buffer_store_dwordx4 v[52:55], v244, s[24:27], s13 offen offset:1024 sc1
    s_waitcnt vmcnt(0)
    v_mov_b32 v80, s64
    v_mov_b32 v81, s65
    s_mov_b64 exec, 1
    buffer_store_dwordx2 v[80:81], off, s[24:27], s16 sc1
    s_mov_b64 exec, -1
    s_barrier
k1f_kernel_fin:
k1f_kernel_end:
    s_endpgm
k1f_kernel_E_slow:
    s_nop 15
    v_mov_b32 v115, v113
    s_nop 1
    v_permlane32_swap_b32 v113, v115
    v_max3_f32 v115, v113, v115, 0
    v_exp_f32 v116, -v115
    v_sub_f32 v128, v128, v115
    v_sub_f32 v129, v129, v115
    v_sub_f32 v130, v130, v115
    v_sub_f32 v131, v131, v115
    v_sub_f32 v132, v132, v115
    v_sub_f32 v133, v133, v115
    v_sub_f32 v134, v134, v115
    v_sub_f32 v135, v135, v115
    v_sub_f32 v136, v136, v115
    v_sub_f32 v137, v137, v115
    v_sub_f32 v138, v138, v115
    v_sub_f32 v139, v139, v115
    v_sub_f32 v140, v140, v115
    v_sub_f32 v141, v141, v115
    v_sub_f32 v142, v142, v115
    v_sub_f32 v143, v143, v115
    v_mul_f32 v0, v0, v116
    v_mul_f32 v1, v1, v116
    v_mul_f32 v2, v2, v116
    v_mul_f32 v3, v3, v116
    v_mul_f32 v4, v4, v116
    v_mul_f32 v5, v5, v116
    v_mul_f32 v6, v6, v116
    v_mul_f32 v7, v7, v116
    v_mul_f32 v8, v8, v116
    v_mul_f32 v9, v9, v116
    v_mul_f32 v10, v10, v116
    v_mul_f32 v11, v11, v116
    v_mul_f32 v12, v12, v116
    v_mul_f32 v13, v13, v116
    v_mul_f32 v14, v14, v116
    v_mul_f32 v15, v15, v116
    v_mul_f32 v16, v16, v116
    v_mul_f32 v17, v17, v116
    v_mul_f32 v18, v18, v116
    v_mul_f32 v19, v19, v116
    v_mul_f32 v20, v20, v116
    v_mul_f32 v21, v21, v116
    v_mul_f32 v22, v22, v116
    v_mul_f32 v23, v23, v116
    v_mul_f32 v24, v24, v116
    v_mul_f32 v25, v25, v116
    v_mul_f32 v26, v26, v116
    v_mul_f32 v27, v27, v116
    v_mul_f32 v28, v28, v116
    v_mul_f32 v29, v29, v116
    v_mul_f32 v30, v30, v116
    v_mul_f32 v31, v31, v116
    v_mul_f32 v32, v32, v116
    v_mul_f32 v33, v33, v116
    v_mul_f32 v34, v34, v116
    v_mul_f32 v35, v35, v116
    v_mul_f32 v36, v36, v116
    v_mul_f32 v37, v37, v116
    v_mul_f32 v38, v38, v116
    v_mul_f32 v39, v39, v116
    v_mul_f32 v40, v40, v116
    v_mul_f32 v41, v41, v116
    v_mul_f32 v42, v42, v116
    v_mul_f32 v43, v43, v116
    v_mul_f32 v44, v44, v116
    v_mul_f32 v45, v45, v116
    v_mul_f32 v46, v46, v116
    v_mul_f32 v47, v47, v116
    v_mul_f32 v48, v48, v116
    v_mul_f32 v49, v49, v116
    v_mul_f32 v50, v50, v116
    v_mul_f32 v51, v51, v116
    v_mul_f32 v52, v52, v116
    v_mul_f32 v53, v53, v116
    v_mul_f32 v54, v54, v116
    v_mul_f32 v55, v55, v116
    v_mul_f32 v56, v56, v116
    v_mul_f32 v57, v57, v116
    v_mul_f32 v58, v58, v116
    v_mul_f32 v59, v59, v116
    v_mul_f32 v60, v60, v116
    v_mul_f32 v61, v61, v116
    v_mul_f32 v62, v62, v116
    v_mul_f32 v63, v63, v116
    v_mul_f32 v110, v110, v116
    v_mul_f32 v111, v111, v116
    v_sub_f32 v224, v224, v115
    v_sub_f32 v225, v225, v115
    v_sub_f32 v226, v226, v115
    v_sub_f32 v227, v227, v115
    v_sub_f32 v228, v228, v115
    v_sub_f32 v229, v229, v115
    v_sub_f32 v230, v230, v115
    v_sub_f32 v231, v231, v115
    v_sub_f32 v232, v232, v115
    v_sub_f32 v233, v233, v115
    v_sub_f32 v234, v234, v115
    v_sub_f32 v235, v235, v115
    v_sub_f32 v236, v236, v115
    v_sub_f32 v237, v237, v115
    v_sub_f32 v238, v238, v115
    v_sub_f32 v239, v239, v115
    v_sub_f32 v240, v240, v115
    v_sub_f32 v241, v241, v115
    v_sub_f32 v242, v242, v115
    v_sub_f32 v243, v243, v115
    v_sub_f32 v244, v244, v115
    v_sub_f32 v245, v245, v115
    v_sub_f32 v246, v246, v115
    v_sub_f32 v247, v247, v115
    v_sub_f32 v248, v248, v115
    v_sub_f32 v249, v249, v115
    v_sub_f32 v250, v250, v115
    v_sub_f32 v251, v251, v115
    v_sub_f32 v252, v252, v115
    v_sub_f32 v253, v253, v115
    v_sub_f32 v254, v254, v115
    v_sub_f32 v255, v255, v115
    s_nop 1
    s_branch k1f_kernel_E_ret
k1f_kernel_O_slow:
    s_nop 15
    v_mov_b32 v115, v113
    s_nop 1
    v_permlane32_swap_b32 v113, v115
    v_max3_f32 v115, v113, v115, 0
    v_exp_f32 v116, -v115
    v_sub_f32 v128, v128, v115
    v_sub_f32 v129, v129, v115
    v_sub_f32 v130, v130, v115
    v_sub_f32 v131, v131, v115
    v_sub_f32 v132, v132, v115
    v_sub_f32 v133, v133, v115
    v_sub_f32 v134, v134, v115
    v_sub_f32 v135, v135, v115
    v_sub_f32 v136, v136, v115
    v_sub_f32 v137, v137, v115
    v_sub_f32 v138, v138, v115
    v_sub_f32 v139, v139, v115
    v_sub_f32 v140, v140, v115
    v_sub_f32 v141, v141, v115
    v_sub_f32 v142, v142, v115
    v_sub_f32 v143, v143, v115
    v_mul_f32 v0, v0, v116
    v_mul_f32 v1, v1, v116
    v_mul_f32 v2, v2, v116
    v_mul_f32 v3, v3, v116
    v_mul_f32 v4, v4, v116
    v_mul_f32 v5, v5, v116
    v_mul_f32 v6, v6, v116
    v_mul_f32 v7, v7, v116
    v_mul_f32 v8, v8, v116
    v_mul_f32 v9, v9, v116
    v_mul_f32 v10, v10, v116
    v_mul_f32 v11, v11, v116
    v_mul_f32 v12, v12, v116
    v_mul_f32 v13, v13, v116
    v_mul_f32 v14, v14, v116
    v_mul_f32 v15, v15, v116
    v_mul_f32 v16, v16, v116
    v_mul_f32 v17, v17, v116
    v_mul_f32 v18, v18, v116
    v_mul_f32 v19, v19, v116
    v_mul_f32 v20, v20, v116
    v_mul_f32 v21, v21, v116
    v_mul_f32 v22, v22, v116
    v_mul_f32 v23, v23, v116
    v_mul_f32 v24, v24, v116
    v_mul_f32 v25, v25, v116
    v_mul_f32 v26, v26, v116
    v_mul_f32 v27, v27, v116
    v_mul_f32 v28, v28, v116
    v_mul_f32 v29, v29, v116
    v_mul_f32 v30, v30, v116
    v_mul_f32 v31, v31, v116
    v_mul_f32 v32, v32, v116
    v_mul_f32 v33, v33, v116
    v_mul_f32 v34, v34, v116
    v_mul_f32 v35, v35, v116
    v_mul_f32 v36, v36, v116
    v_mul_f32 v37, v37, v116
    v_mul_f32 v38, v38, v116
    v_mul_f32 v39, v39, v116
    v_mul_f32 v40, v40, v116
    v_mul_f32 v41, v41, v116
    v_mul_f32 v42, v42, v116
    v_mul_f32 v43, v43, v116
    v_mul_f32 v44, v44, v116
    v_mul_f32 v45, v45, v116
    v_mul_f32 v46, v46, v116
    v_mul_f32 v47, v47, v116
    v_mul_f32 v48, v48, v116
    v_mul_f32 v49, v49, v116
    v_mul_f32 v50, v50, v116
    v_mul_f32 v51, v51, v116
    v_mul_f32 v52, v52, v116
    v_mul_f32 v53, v53, v116
    v_mul_f32 v54, v54, v116
    v_mul_f32 v55, v55, v116
    v_mul_f32 v56, v56, v116
    v_mul_f32 v57, v57, v116
    v_mul_f32 v58, v58, v116
    v_mul_f32 v59, v59, v116
    v_mul_f32 v60, v60, v116
    v_mul_f32 v61, v61, v116
    v_mul_f32 v62, v62, v116
    v_mul_f32 v63, v63, v116
    v_mul_f32 v110, v110, v116
    v_mul_f32 v111, v111, v116
    v_sub_f32 v64, v64, v115
    v_sub_f32 v65, v65, v115
    v_sub_f32 v66, v66, v115
    v_sub_f32 v67, v67, v115
    v_sub_f32 v68, v68, v115
    v_sub_f32 v69, v69, v115
    v_sub_f32 v70, v70, v115
    v_sub_f32 v71, v71, v115
    v_sub_f32 v72, v72, v115
    v_sub_f32 v73, v73, v115
    v_sub_f32 v74, v74, v115
    v_sub_f32 v75, v75, v115
    v_sub_f32 v76, v76, v115
    v_sub_f32 v77, v77, v115
    v_sub_f32 v78, v78, v115
    v_sub_f32 v79, v79, v115
    v_sub_f32 v80, v80, v115
    v_sub_f32 v81, v81, v115
    v_sub_f32 v82, v82, v115
    v_sub_f32 v83, v83, v115
    v_sub_f32 v84, v84, v115
    v_sub_f32 v85, v85, v115
    v_sub_f32 v86, v86, v115
    v_sub_f32 v87, v87, v115
    v_sub_f32 v88, v88, v115
    v_sub_f32 v89, v89, v115
    v_sub_f32 v90, v90, v115
    v_sub_f32 v91, v91, v115
    v_sub_f32 v92, v92, v115
    v_sub_f32 v93, v93, v115
    v_sub_f32 v94, v94, v115
    v_sub_f32 v95, v95, v115
    s_nop 1
    s_branch k1f_kernel_O_ret
k1f_kernel_Om_slow:
    s_nop 15
    v_mov_b32 v115, v113
    s_nop 1
    v_permlane32_swap_b32 v113, v115
    v_max3_f32 v115, v113, v115, 0
    v_exp_f32 v116, -v115
    v_sub_f32 v128, v128, v115
    v_sub_f32 v129, v129, v115
    v_sub_f32 v130, v130, v115
    v_sub_f32 v131, v131, v115
    v_sub_f32 v132, v132, v115
    v_sub_f32 v133, v133, v115
    v_sub_f32 v134, v134, v115
    v_sub_f32 v135, v135, v115
    v_sub_f32 v136, v136, v115
    v_sub_f32 v137, v137, v115
    v_sub_f32 v138, v138, v115
    v_sub_f32 v139, v139, v115
    v_sub_f32 v140, v140, v115
    v_sub_f32 v141, v141, v115
    v_sub_f32 v142, v142, v115
    v_sub_f32 v143, v143, v115
    v_mul_f32 v0, v0, v116
    v_mul_f32 v1, v1, v116
    v_mul_f32 v2, v2, v116
    v_mul_f32 v3, v3, v116
    v_mul_f32 v4, v4, v116
    v_mul_f32 v5, v5, v116
    v_mul_f32 v6, v6, v116
    v_mul_f32 v7, v7, v116
    v_mul_f32 v8, v8, v116
    v_mul_f32 v9, v9, v116
    v_mul_f32 v10, v10, v116
    v_mul_f32 v11, v11, v116
    v_mul_f32 v12, v12, v116
    v_mul_f32 v13, v13, v116
    v_mul_f32 v14, v14, v116
    v_mul_f32 v15, v15, v116
    v_mul_f32 v16, v16, v116
    v_mul_f32 v17, v17, v116
    v_mul_f32 v18, v18, v116
    v_mul_f32 v19, v19, v116
    v_mul_f32 v20, v20, v116
    v_mul_f32 v21, v21, v116
    v_mul_f32 v22, v22, v116
    v_mul_f32 v23, v23, v116
    v_mul_f32 v24, v24, v116
    v_mul_f32 v25, v25, v116
    v_mul_f32 v26, v26, v116
    v_mul_f32 v27, v27, v116
    v_mul_f32 v28, v28, v116
    v_mul_f32 v29, v29, v116
    v_mul_f32 v30, v30, v116
    v_mul_f32 v31, v31, v116
    v_mul_f32 v32, v32, v116
    v_mul_f32 v33, v33, v116
    v_mul_f32 v34, v34, v116
    v_mul_f32 v35, v35, v116
    v_mul_f32 v36, v36, v116
    v_mul_f32 v37, v37, v116
    v_mul_f32 v38, v38, v116
    v_mul_f32 v39, v39, v116
    v_mul_f32 v40, v40, v116
    v_mul_f32 v41, v41, v116
    v_mul_f32 v42, v42, v116
    v_mul_f32 v43, v43, v116
    v_mul_f32 v44, v44, v116
    v_mul_f32 v45, v45, v116
    v_mul_f32 v46, v46, v116
    v_mul_f32 v47, v47, v116
    v_mul_f32 v48, v48, v116
    v_mul_f32 v49, v49, v116
    v_mul_f32 v50, v50, v116
    v_mul_f32 v51, v51, v116
    v_mul_f32 v52, v52, v116
    v_mul_f32 v53, v53, v116
    v_mul_f32 v54, v54, v116
    v_mul_f32 v55, v55, v116
    v_mul_f32 v56, v56, v116
    v_mul_f32 v57, v57, v116
    v_mul_f32 v58, v58, v116
    v_mul_f32 v59, v59, v116
    v_mul_f32 v60, v60, v116
    v_mul_f32 v61, v61, v116
    v_mul_f32 v62, v62, v116
    v_mul_f32 v63, v63, v116
    v_mul_f32 v110, v110, v116
    v_mul_f32 v111, v111, v116
    v_sub_f32 v64, v64, v115
    v_sub_f32 v65, v65, v115
    v_sub_f32 v66, v66, v115
    v_sub_f32 v67, v67, v115
    v_sub_f32 v68, v68, v115
    v_sub_f32 v69, v69, v115
    v_sub_f32 v70, v70, v115
    v_sub_f32 v71, v71, v115
    v_sub_f32 v72, v72, v115
    v_sub_f32 v73, v73, v115
    v_sub_f32 v74, v74, v115
    v_sub_f32 v75, v75, v115
    v_sub_f32 v76, v76, v115
    v_sub_f32 v77, v77, v115
    v_sub_f32 v78, v78, v115
    v_sub_f32 v79, v79, v115
    v_sub_f32 v80, v80, v115
    v_sub_f32 v81, v81, v115
    v_sub_f32 v82, v82, v115
    v_sub_f32 v83, v83, v115
    v_sub_f32 v84, v84, v115
    v_sub_f32 v85, v85, v115
    v_sub_f32 v86, v86, v115
    v_sub_f32 v87, v87, v115
    v_sub_f32 v88, v88, v115
    v_sub_f32 v89, v89, v115
    v_sub_f32 v90, v90, v115
    v_sub_f32 v91, v91, v115
    v_sub_f32 v92, v92, v115
    v_sub_f32 v93, v93, v115
    v_sub_f32 v94, v94, v115
    v_sub_f32 v95, v95, v115
    s_nop 1
    s_branch k1f_kernel_Om_ret
k1f_kernel_tks:
    s_mov_b32 s61, 0x40000
k1f_kernel_tkl:
    s_sleep 2
    buffer_load_dwordx2 v[110:111], off, s[76:79], 0 sc1
    s_waitcnt vmcnt(0)
    v_readfirstlane_b32 s64, v110
    v_readfirstlane_b32 s65, v111
    s_cmp_lg_u32 s64, 0
    s_cbranch_scc1 k1f_kernel_tkc
    s_sub_u32 s61, s61, 1
    s_cbranch_scc0 k1f_kernel_tkl
    s_branch k1f_kernel_tkc
k1f_kernel_xcs:
    s_mov_b32 s61, 0x40000
    s_lshl_b32 s6, s5, 11
    s_sub_u32 s7, 30720, s6
    v_mov_b32 v110, s6
    v_mov_b32 v111, s7
    v_and_b32 v125, 16, v118
    v_cmp_eq_u32 vcc, 0, v125
    s_nop 1
    v_cndmask_b32 v110, v110, v111, vcc
    v_and_b32 v125, 15, v118
    v_lshl_add_u32 v125, v125, 7, v110
    s_mov_b32 s6, 0x3b80000
k1f_kernel_xcl:
    s_sleep 2
    buffer_load_dwordx2 v[110:111], v125, s[24:27], s6 offen sc1
    s_waitcnt vmcnt(0)
    v_cmp_eq_u64 vcc, s[64:65], v[110:111]
    s_cmp_eq_u64 vcc, -1
    s_cbranch_scc1 k1f_kernel_xcc
    s_sub_u32 s61, s61, 1
    s_cbranch_scc0 k1f_kernel_xcl
    s_branch k1f_kernel_xcc
k1f_kernel_k1s:
    s_mov_b32 s61, 0x40000
    s_and_b32 s6, s2, 31
    s_lshl_b32 s6, s6, 7
    s_add_u32 s6, s6, 0x3b88000
    v_and_b32 v125, 7, v118
    v_lshlrev_b32 v125, 12, v125
k1f_kernel_k1l:
    s_sleep 2
    buffer_load_dwordx2 v[110:111], v125, s[24:27], s6 offen sc1
    s_waitcnt vmcnt(0)
    v_cmp_eq_u64 vcc, s[64:65], v[110:111]
    s_and_b32 s7, vcc_lo, 3
    s_cmp_eq_u32 s7, 3
    s_cbranch_scc1 k1f_kernel_k1c
    s_sub_u32 s61, s61, 1
    s_cbranch_scc0 k1f_kernel_k1l
    s_branch k1f_kernel_k1c
k1f_kernel_k2s:
    s_mov_b32 s61, 0x40000
    s_and_b32 s6, s2, 31
    s_lshl_b32 s6, s6, 7
    s_add_u32 s6, s6, 0x3b90000
    v_and_b32 v125, 7, v118
    v_lshlrev_b32 v125, 12, v125
k1f_kernel_k2l:
    s_sleep 2
    buffer_load_dwordx2 v[110:111], v125, s[24:27], s6 offen sc1
    s_waitcnt vmcnt(0)
    v_cmp_eq_u64 vcc, s[64:65], v[110:111]
    s_and_b32 s7, vcc_lo, s49
    s_cmp_eq_u32 s7, s49
    s_cbranch_scc1 k1f_kernel_k2c
    s_sub_u32 s61, s61, 1
    s_cbranch_scc0 k1f_kernel_k2l
    s_branch k1f_kernel_k2c
.section .rodata,"a"
.p2align 6
.amdhsa_kernel k1f_kernel
  .amdhsa_next_free_vgpr 256
  .amdhsa_next_free_sgpr 102
  .amdhsa_accum_offset 256
  .amdhsa_group_segment_fixed_size 0
  .amdhsa_kernarg_size 96
  .amdhsa_user_sgpr_count 2
  .amdhsa_user_sgpr_kernarg_segment_ptr 1
  .amdhsa_system_sgpr_workgroup_id_x 1
.end_amdhsa_kernel
```
